```python
import torch

def _softmax(x, axis=-1):
    return torch.softmax(x, dim=axis)
def _gelu(x):
    return torch.nn.functional.gelu(x, approximate="tanh")
def _silu(x):
    return torch.nn.functional.silu(x)
def _sigmoid(x):
    return torch.sigmoid(x)
def _layernorm(x, axis=-1, eps=1e-5):
    m = x.mean(dim=axis, keepdim=True)
    v = x.var(dim=axis, keepdim=True, unbiased=False)
    return (x - m) / torch.sqrt(v + eps)
def _scatter_add(tgt, idx, src, axis=0):
    return tgt.clone().index_add_(axis, idx, src)
def _segment_sum(src, seg, n):
    out = torch.zeros((n,) + src.shape[1:], dtype=src.dtype)
    return out.index_add_(0, seg, src)
def _pad(x, pw):
    flat = tuple(v for pair in reversed(pw) for v in pair)
    return torch.nn.functional.pad(x, flat)

kernel_name = 'standalone__w4a16_gemm_dequant__prompt'

def setup_inputs():

    _w = (lambda a: (lambda t: t.to(torch.bfloat16) if t.is_floating_point() else t)(torch.as_tensor(a)))
    B, S, D, F = 1, 2048, 576, 4608
    G = -1 if -1 > 0 else D
    D = (D // G) * G
    ng = D // G
    qw = torch.randint(0, 16, (D, F)).to(torch.int32)
    return {
        "x": _w((lambda *s: torch.randn(*s, dtype=torch.bfloat16) * 0.05)(B, S, D)),
        "qw": _w(qw),
        "scales": _w(torch.abs((lambda *s: torch.randn(*s, dtype=torch.bfloat16) * 0.05)(ng, F)) + 0.01),
        "zeros": _w(torch.full((ng, F), 8.0, dtype=float)),
    }

def reference(x, qw, scales, zeros):
    B, S, D = x.shape
    ng, F = scales.shape
    G = D // ng
    s = (lambda x, n, axis: torch.repeat_interleave(x, n, dim=axis))(scales, G, axis=0)
    z = (lambda x, n, axis: torch.repeat_interleave(x, n, dim=axis))(zeros, G, axis=0)
    w = ((lambda x, dt: x.to(dt))(qw, x.dtype) - z) * s
    return x @ w
```

```asm
; @launch grid=(252,1,1) block=(256,1,1) lds=163840
.amdgcn_target "amdgcn-amd-amdhsa--gfx950"
.text
.globl standalone__w4a16_gemm_dequant__prompt_kernel
.p2align 12
.p2align 8
.type standalone__w4a16_gemm_dequant__prompt_kernel,@function
standalone__w4a16_gemm_dequant__prompt_kernel:
    s_cmp_ge_u32 s2, 252
    s_cbranch_scc1 L_done
    s_load_dwordx8 s[24:31], s[0:1], 0
    s_load_dwordx2 s[32:33], s[0:1], 32

    v_lshrrev_b32 v47, 6, v0
    v_and_b32 v1, 63, v0
    v_readfirstlane_b32 s37, v47
    v_and_b32 v2, 15, v0
    v_lshrrev_b32 v3, 4, v1

    s_and_b32 s88, s2, 3
    s_mul_i32 s89, s88, 63
    s_lshl_b32 s88, s2, 3
    s_and_b32 s88, s88, 32
    s_add_u32 s89, s89, s88
    s_lshr_b32 s88, s2, 3
    s_add_u32 s89, s89, s88
    s_mul_i32 s34, s89, 9363
    s_lshr_b32 s34, s34, 16
    s_mul_i32 s88, s34, 7
    s_sub_u32 s35, s89, s88
    s_mul_i32 s88, s35, 1
    s_mul_i32 s89, s34, 1
    s_add_u32 s100, s88, s89
    s_mul_i32 s89, s100, 21846
    s_lshr_b32 s89, s89, 16
    s_mul_i32 s89, s89, 3
    s_sub_u32 s3, s100, s89
    s_mul_i32 s49, s3, 1179648
    s_lshl_b32 s88, s34, 9
    s_lshl_b32 s89, s37, 7
    s_add_u32 s90, s88, s89
    v_lshrrev_b32 v48, 3, v2
    v_lshl_add_u32 v48, v48, 2, v3
    v_and_b32 v49, 7, v1
    v_mul_u32_u24 v4, 147456, v48
    v_lshl_add_u32 v50, v49, 4, s90
    v_lshrrev_b32 v51, 1, v50
    v_add_u32 v4, v4, v50
    s_mov_b32 s18, 9216
    s_mov_b32 s19, 0x00020000
    s_mov_b32 s22, 9216
    s_mov_b32 s23, 0x00020000
    s_mov_b32 s10, 10616832
    s_mov_b32 s11, 0x00020000
    v_add_u32 v5, 18432, v4
    v_add_u32 v6, 36864, v4
    v_add_u32 v7, 55296, v4
    v_add_u32 v8, 73728, v4
    v_add_u32 v9, 92160, v4
    v_add_u32 v10, 110592, v4
    v_add_u32 v11, 129024, v4
    s_waitcnt lgkmcnt(0)

    s_mov_b32 s16, s28
    s_mov_b32 s17, s29
    s_mov_b32 s20, s30
    s_mov_b32 s21, s31
    s_mov_b32 s8, s26
    s_mov_b32 s9, s27
    buffer_load_dwordx2 v[56:57], v51, s[16:19], 0 offen
    buffer_load_dwordx2 v[58:59], v51, s[20:23], 0 offen
    buffer_load_dwordx4 v[64:67], v4, s[8:11], s49 offen
    s_mov_b32 s4, s24
    s_mov_b32 s5, s25
    s_mov_b32 s12, s32
    s_mov_b32 s13, s33
    s_mov_b32 s6, 2359296
    s_mov_b32 s7, 0x00020000
    s_mul_i32 s36, s35, 1163
    s_lshr_b32 s36, s36, 6
    s_lshl_b32 s58, s3, 7
    s_and_b32 s88, s37, 1
    buffer_load_dwordx4 v[68:71], v5, s[8:11], s49 offen
    s_lshr_b32 s89, s37, 1
    v_lshrrev_b32 v52, 3, v1
    s_lshl_b32 s88, s88, 3
    v_add_u32 v53, s88, v52
    v_lshrrev_b32 v54, 1, v53
    v_xor_b32 v54, v54, v1
    v_and_b32 v54, 7, v54
    v_lshlrev_b32 v54, 4, v54
    v_mul_u32_u24 v12, 1152, v53
    s_add_u32 s88, s36, s89
    buffer_load_dwordx4 v[72:75], v6, s[8:11], s49 offen
    s_mul_i32 s88, s88, 18432
    v_add3_u32 v12, v12, v54, s88
    s_lshl_b32 s67, s37, 12
    s_mov_b32 s38, 0
    s_mov_b32 s39, 35840
    s_mov_b32 s40, 71680
    s_mov_b32 s41, 107520
    s_mov_b32 s42, 147456
    s_mov_b32 s43, 183296
    s_mov_b32 s44, 219136
    buffer_load_dwordx4 v[76:79], v7, s[8:11], s49 offen
    v_and_b32 v53, 3, v52
    s_lshl_b32 s88, s37, 2
    v_add_u32 v53, s88, v53
    v_lshrrev_b32 v54, 1, v53
    v_xor_b32 v54, v54, v1
    v_and_b32 v54, 7, v54
    v_lshlrev_b32 v54, 4, v54
    v_mul_u32_u24 v13, 1152, v53
    s_mul_i32 s88, s36, 18432
    v_add3_u32 v13, v13, v54, s88
    buffer_load_dwordx4 v[80:83], v8, s[8:11], s49 offen
    s_mul_i32 s30, s100, 9363
    s_lshr_b32 s30, s30, 16
    s_mul_i32 s30, s30, 7
    s_sub_u32 s30, s100, s30
    s_add_u32 s28, s30, 3
    s_sub_u32 s29, s28, 2
    s_cmp_gt_u32 s28, 8
    s_cselect_b32 s29, 100, s29
    s_mov_b32 s24, s3
    s_add_u32 s25, s24, 1
    s_cmp_eq_u32 s25, 3
    s_cselect_b32 s25, 0, s25
    buffer_load_dwordx4 v[84:87], v9, s[8:11], s49 offen
    s_add_u32 s26, s25, 1
    s_cmp_eq_u32 s26, 3
    s_cselect_b32 s26, 0, s26
    s_sub_u32 s30, 0, s29
    s_cmp_lt_u32 s30, 2
    s_cselect_b32 s31, s24, s25
    s_cmp_eq_u32 s29, 1
    s_cselect_b32 s31, s28, s31
    s_lshl_b32 s59, s31, 7
    s_mul_i32 s50, s31, 1179648
    s_sub_u32 s30, 1, s29
    s_cmp_lt_u32 s30, 2
    s_cselect_b32 s31, s25, s26
    s_cmp_eq_u32 s29, 2
    s_cselect_b32 s31, s28, s31
    buffer_load_dwordx4 v[88:91], v10, s[8:11], s49 offen
    s_lshl_b32 s60, s31, 7
    s_mul_i32 s51, s31, 1179648
    s_sub_u32 s30, 2, s29
    s_cmp_lt_u32 s30, 2
    s_cselect_b32 s31, s26, 3
    s_cmp_eq_u32 s29, 3
    s_cselect_b32 s31, s28, s31
    s_lshl_b32 s61, s31, 7
    s_mul_i32 s52, s31, 1179648
    s_sub_u32 s30, 3, s29
    s_cmp_lt_u32 s30, 2
    s_cselect_b32 s31, 3, 4
    s_cmp_eq_u32 s29, 4
    s_cselect_b32 s31, s28, s31
    buffer_load_dwordx4 v[92:95], v11, s[8:11], s49 offen
    s_lshl_b32 s62, s31, 7
    s_mul_i32 s53, s31, 1179648
    s_sub_u32 s30, 4, s29
    s_cmp_lt_u32 s30, 2
    s_cselect_b32 s31, 4, 5
    s_cmp_eq_u32 s29, 5
    s_cselect_b32 s31, s28, s31
    s_lshl_b32 s63, s31, 7
    s_mul_i32 s54, s31, 1179648
    s_sub_u32 s30, 5, s29
    s_cmp_lt_u32 s30, 2
    s_cselect_b32 s31, 5, 6
    s_cmp_eq_u32 s29, 6
    s_cselect_b32 s31, s28, s31
    s_add_u32 m0, s67, 0
    v_add_u32 v14, s58, v12
    buffer_load_dwordx4 v14, s[4:7], s38 offen offset:0 lds
    s_lshl_b32 s64, s31, 7
    s_mul_i32 s55, s31, 1179648
    s_sub_u32 s30, 6, s29
    s_cmp_lt_u32 s30, 2
    s_cselect_b32 s31, 6, 7
    s_cmp_eq_u32 s29, 7
    s_cselect_b32 s31, s28, s31
    s_lshl_b32 s65, s31, 7
    s_mul_i32 s56, s31, 1179648
    s_sub_u32 s30, 7, s29
    s_cmp_lt_u32 s30, 2
    s_cselect_b32 s31, 7, 8
    s_cmp_eq_u32 s29, 8
    s_cselect_b32 s31, s28, s31
    buffer_load_dwordx4 v14, s[4:7], s39 offen offset:1024 lds
    s_lshl_b32 s66, s31, 7
    s_mul_i32 s57, s31, 1179648
    s_mov_b32 s14, 18874368
    s_mov_b32 s15, 0x00020000
    v_lshrrev_b32 v52, 1, v2
    v_xor_b32 v52, v52, v3
    v_lshlrev_b32 v52, 4, v52
    v_lshrrev_b32 v53, 3, v2
    v_lshlrev_b32 v53, 12, v53
    v_and_b32 v54, 7, v2
    buffer_load_dwordx4 v14, s[4:7], s40 offen offset:2048 lds
    v_lshlrev_b32 v54, 7, v54
    v_add3_u32 v60, v52, v53, v54
    v_lshrrev_b32 v53, 2, v2
    v_lshlrev_b32 v53, 12, v53
    v_and_b32 v54, 3, v2
    v_lshlrev_b32 v55, 7, v54
    v_add3_u32 v61, v52, v53, v55
    v_and_b32 v52, 1, v3
    v_lshlrev_b32 v52, 1, v52
    v_lshrrev_b32 v55, 1, v3
    buffer_load_dwordx4 v14, s[4:7], s41 offen offset:3072 lds
    s_bfe_u32 s45, s2, 0x40003
    s_lshl_b32 s48, s37, 4
    s_add_u32 s45, s45, s48
    s_getpc_b64 s[46:47]
L_pc:
    s_lshl_b32 s48, s45, 8
    s_add_u32 s48, s48, 1280-(L_pc-standalone__w4a16_gemm_dequant__prompt_kernel)
    s_add_u32 s46, s46, s48
    s_addc_u32 s47, s47, 0
    s_mov_b64 exec, 0
L_again:
    s_cmpk_ge_u32 s45, 73
    s_cbranch_scc1 L_vdone
    s_setpc_b64 s[46:47]
L_ret:
    s_add_u32 s46, s46, 16384
    s_addc_u32 s47, s47, 0
    s_addk_i32 s45, 64
    s_branch L_again
L_vdone:
    s_mov_b64 exec, -1
    v_add_u32 v52, v52, v55
    s_lshl_b32 s24, s37, 2
    v_add_u32 v52, s24, v52
    v_and_b32 v55, 7, v2
    v_xor_b32 v52, v52, v55
    v_lshlrev_b32 v52, 4, v52
    v_lshlrev_b32 v55, 8, v54
    v_add3_u32 v62, v52, v53, v55
    v_add_u32 v52, s24, v3
    v_and_b32 v53, 7, v52
    s_add_u32 m0, s67, 16384
    s_nop 0
    buffer_load_dwordx4 v14, s[4:7], s42 offen offset:0 lds
    v_xor_b32 v53, v53, v2
    v_lshlrev_b32 v53, 4, v53
    v_lshlrev_b32 v54, 8, v3
    v_add3_u32 v63, v53, v54, s67
    v_mul_u32_u24 v28, 9216, v52
    v_lshlrev_b32 v53, 4, v2
    s_mul_i32 s24, s36, 147456
    s_lshl_b32 s25, s34, 8
    s_add_u32 s24, s24, s25
    v_add3_u32 v28, v28, v53, s24
    buffer_load_dwordx4 v14, s[4:7], s43 offen offset:1024 lds
    s_cbranch_execz L_ret
    v_mov_b32 v29, v60
    v_xor_b32 v30, 64, v60
    v_add_u32 v31, 65536, v60
    v_xor_b32 v32, 64, v60
    v_add_u32 v32, 65536, v32
    v_add_u32 v33, 65536, v61
    v_xor_b32 v34, 64, v61
    v_add_u32 v34, 65536, v34
    v_mov_b32 v35, v61
    v_xor_b32 v36, 64, v61
    buffer_load_dwordx4 v14, s[4:7], s44 offen offset:2048 lds
    v_add_u32 v37, 131072, v62
    v_add_u32 v38, 131072, v63
    s_mov_b32 s68, 0
    s_mov_b32 s69, 147456
    s_mov_b32 s70, 294912
    s_mov_b32 s71, 442368
    s_mov_b32 s72, 589824
    s_mov_b32 s73, 737280
    s_mov_b32 s74, 884736
    s_mov_b32 s75, 1032192
    s_mov_b32 s76, 1179648
    s_mov_b32 s77, 1327104
    s_mov_b32 s78, 1474560
    s_mov_b32 s79, 1622016
    s_mov_b32 s80, 1769472
    s_mov_b32 s81, 1916928
    s_mov_b32 s82, 2064384
    s_mov_b32 s83, 2211840
    s_mov_b32 s84, 2359296
    s_mov_b32 s85, 2506752
    s_mov_b32 s86, 2654208
    s_waitcnt vmcnt(15)
    v_lshlrev_b32 v20, 16, v56
    v_and_b32 v21, 0xffff0000, v56
    v_lshlrev_b32 v22, 16, v57
    s_nop 0
    s_cbranch_execz L_ret
    v_and_b32 v23, 0xffff0000, v57
    v_lshlrev_b32 v24, 16, v58
    v_and_b32 v25, 0xffff0000, v58
    v_lshlrev_b32 v26, 16, v59
    v_and_b32 v27, 0xffff0000, v59
    v_mul_f32 v48, 8.0, v24
    v_rndne_f32 v52, v48
    v_sub_f32 v48, v48, v52
    v_mul_f32 v49, 8.0, v25
    v_rndne_f32 v53, v49
    v_sub_f32 v49, v49, v53
    v_mul_f32 v50, 8.0, v26
    v_rndne_f32 v54, v50
    v_sub_f32 v50, v50, v54
    v_mul_f32 v51, 8.0, v27
    v_rndne_f32 v55, v51
    v_sub_f32 v51, v51, v55
    v_or3_b32 v48, v48, v49, v50
    v_or_b32 v48, v48, v51
    v_cmp_eq_u32 s[26:27], 0, v48
    v_max3_f32 v49, |v24|, |v25|, |v26|
    v_max_f32 v49, v49, |v27|
    v_mov_b32 v52, 0x41800000
    v_cmp_le_f32 vcc, v49, v52
    s_and_b64 s[26:27], s[26:27], vcc
    v_max3_f32 v49, |v20|, |v21|, |v22|
    v_max_f32 v49, v49, |v23|
    v_mov_b32 v52, 0x71800000
    v_cmp_le_f32 vcc, v49, v52
    s_and_b64 s[26:27], s[26:27], vcc
    v_min3_f32 v49, |v20|, |v21|, |v22|
    v_min_f32 v49, v49, |v23|
    v_mov_b32 v52, 0x0d800000
    v_cmp_ge_f32 vcc, v49, v52
    s_and_b64 s[26:27], s[26:27], vcc
    v_xor_b32 v24, 0x80000000, v24
    v_xor_b32 v25, 0x80000000, v25
    v_xor_b32 v26, 0x80000000, v26
    v_xor_b32 v27, 0x80000000, v27
    s_mov_b32 vcc_lo, 0xff00ff00
    s_cbranch_execz L_ret
    s_mov_b32 vcc_hi, 0xff00ff00
    s_cmp_eq_u64 s[26:27], -1
    s_cbranch_scc0 L_general
    v_mul_f32 v24, v24, v20
    v_mul_f32 v25, v25, v21
    v_mul_f32 v26, v26, v22
    v_mul_f32 v27, v27, v23
    v_mul_f32 v20, 0x4b800000, v20
    v_mul_f32 v21, 0x4b800000, v21
    v_mul_f32 v22, 0x4b800000, v22
    v_mul_f32 v23, 0x4b800000, v23
    s_waitcnt vmcnt(13)
    v_fma_mix_f32 v64, v64, v20, v24 op_sel_hi:[1,0,0]
    v_fma_mix_f32 v68, v68, v20, v24 op_sel_hi:[1,0,0]
    v_cvt_pk_bf16_f32 v64, v64, v68
    v_fma_mix_f32 v65, v65, v21, v25 op_sel_hi:[1,0,0]
    buffer_load_dwordx4 v[96:99], v4, s[8:11], s50 offen
    v_fma_mix_f32 v69, v69, v21, v25 op_sel_hi:[1,0,0]
    v_cvt_pk_bf16_f32 v65, v65, v69
    v_fma_mix_f32 v66, v66, v22, v26 op_sel_hi:[1,0,0]
    v_fma_mix_f32 v70, v70, v22, v26 op_sel_hi:[1,0,0]
    v_cvt_pk_bf16_f32 v66, v66, v70
    v_fma_mix_f32 v67, v67, v23, v27 op_sel_hi:[1,0,0]
    v_fma_mix_f32 v71, v71, v23, v27 op_sel_hi:[1,0,0]
    v_cvt_pk_bf16_f32 v67, v67, v71
    buffer_load_dwordx4 v[100:103], v5, s[8:11], s50 offen
    s_waitcnt vmcnt(13)
    v_fma_mix_f32 v72, v72, v20, v24 op_sel_hi:[1,0,0]
    v_fma_mix_f32 v76, v76, v20, v24 op_sel_hi:[1,0,0]
    v_cvt_pk_bf16_f32 v72, v72, v76
    v_fma_mix_f32 v73, v73, v21, v25 op_sel_hi:[1,0,0]
    v_fma_mix_f32 v77, v77, v21, v25 op_sel_hi:[1,0,0]
    v_cvt_pk_bf16_f32 v73, v73, v77
    v_fma_mix_f32 v74, v74, v22, v26 op_sel_hi:[1,0,0]
    v_fma_mix_f32 v78, v78, v22, v26 op_sel_hi:[1,0,0]
    s_nop 0
    s_cbranch_execz L_ret
    buffer_load_dwordx4 v[104:107], v6, s[8:11], s50 offen
    v_cvt_pk_bf16_f32 v74, v74, v78
    v_fma_mix_f32 v75, v75, v23, v27 op_sel_hi:[1,0,0]
    v_fma_mix_f32 v79, v79, v23, v27 op_sel_hi:[1,0,0]
    v_cvt_pk_bf16_f32 v75, v75, v79
    s_waitcnt vmcnt(12)
    v_fma_mix_f32 v80, v80, v20, v24 op_sel_hi:[1,0,0]
    v_fma_mix_f32 v84, v84, v20, v24 op_sel_hi:[1,0,0]
    v_cvt_pk_bf16_f32 v80, v80, v84
    v_fma_mix_f32 v81, v81, v21, v25 op_sel_hi:[1,0,0]
    buffer_load_dwordx4 v[108:111], v7, s[8:11], s50 offen
    v_fma_mix_f32 v85, v85, v21, v25 op_sel_hi:[1,0,0]
    v_cvt_pk_bf16_f32 v81, v81, v85
    v_fma_mix_f32 v82, v82, v22, v26 op_sel_hi:[1,0,0]
    v_fma_mix_f32 v86, v86, v22, v26 op_sel_hi:[1,0,0]
    v_cvt_pk_bf16_f32 v82, v82, v86
    v_fma_mix_f32 v83, v83, v23, v27 op_sel_hi:[1,0,0]
    v_fma_mix_f32 v87, v87, v23, v27 op_sel_hi:[1,0,0]
    v_cvt_pk_bf16_f32 v83, v83, v87
    buffer_load_dwordx4 v[112:115], v8, s[8:11], s50 offen
    s_waitcnt vmcnt(12)
    v_fma_mix_f32 v88, v88, v20, v24 op_sel_hi:[1,0,0]
    v_fma_mix_f32 v92, v92, v20, v24 op_sel_hi:[1,0,0]
    v_cvt_pk_bf16_f32 v88, v88, v92
    v_fma_mix_f32 v89, v89, v21, v25 op_sel_hi:[1,0,0]
    v_fma_mix_f32 v93, v93, v21, v25 op_sel_hi:[1,0,0]
    v_cvt_pk_bf16_f32 v89, v89, v93
    v_fma_mix_f32 v90, v90, v22, v26 op_sel_hi:[1,0,0]
    v_fma_mix_f32 v94, v94, v22, v26 op_sel_hi:[1,0,0]
    buffer_load_dwordx4 v[116:119], v9, s[8:11], s50 offen
    v_cvt_pk_bf16_f32 v90, v90, v94
    v_fma_mix_f32 v91, v91, v23, v27 op_sel_hi:[1,0,0]
    s_nop 0
    s_cbranch_execz L_ret
    v_fma_mix_f32 v95, v95, v23, v27 op_sel_hi:[1,0,0]
    v_cvt_pk_bf16_f32 v91, v91, v95
    s_not_b64 vcc, vcc
    v_cndmask_b32_dpp v48, v66, v64, vcc row_ror:8 row_mask:0xf bank_mask:0xf
    v_cndmask_b32_dpp v49, v74, v72, vcc row_ror:8 row_mask:0xf bank_mask:0xf
    v_cndmask_b32_dpp v50, v82, v80, vcc row_ror:8 row_mask:0xf bank_mask:0xf
    v_cndmask_b32_dpp v51, v90, v88, vcc row_ror:8 row_mask:0xf bank_mask:0xf
    buffer_load_dwordx4 v[120:123], v10, s[8:11], s50 offen
    v_cndmask_b32_dpp v52, v67, v65, vcc row_ror:8 row_mask:0xf bank_mask:0xf
    v_cndmask_b32_dpp v53, v75, v73, vcc row_ror:8 row_mask:0xf bank_mask:0xf
    v_cndmask_b32_dpp v54, v83, v81, vcc row_ror:8 row_mask:0xf bank_mask:0xf
    v_cndmask_b32_dpp v55, v91, v89, vcc row_ror:8 row_mask:0xf bank_mask:0xf
    s_not_b64 vcc, vcc
    v_cndmask_b32_dpp v56, v64, v66, vcc row_ror:8 row_mask:0xf bank_mask:0xf
    v_cndmask_b32_dpp v57, v72, v74, vcc row_ror:8 row_mask:0xf bank_mask:0xf
    v_cndmask_b32_dpp v58, v80, v82, vcc row_ror:8 row_mask:0xf bank_mask:0xf
    v_cndmask_b32_dpp v59, v88, v90, vcc row_ror:8 row_mask:0xf bank_mask:0xf
    buffer_load_dwordx4 v[124:127], v11, s[8:11], s50 offen
    v_cndmask_b32_dpp v60, v65, v67, vcc row_ror:8 row_mask:0xf bank_mask:0xf
    v_cndmask_b32_dpp v61, v73, v75, vcc row_ror:8 row_mask:0xf bank_mask:0xf
    v_cndmask_b32_dpp v62, v81, v83, vcc row_ror:8 row_mask:0xf bank_mask:0xf
    v_cndmask_b32_dpp v63, v89, v91, vcc row_ror:8 row_mask:0xf bank_mask:0xf
    s_waitcnt vmcnt(8)
    s_barrier
    ds_read_b128 a[152:155], v29 offset:0
    ds_read_b128 a[156:159], v29 offset:8192
    ds_read_b128 a[160:163], v29 offset:1024
    ds_read_b128 a[164:167], v29 offset:9216
    ds_read_b128 a[168:171], v29 offset:2048
    ds_read_b128 a[172:175], v29 offset:10240
    s_waitcnt lgkmcnt(4)
    s_waitcnt vmcnt(6)
    v_fma_mix_f32 v96, v96, v20, v24 op_sel_hi:[1,0,0]
    s_add_u32 m0, s67, 32768
    v_add_u32 v14, s59, v12
    s_cbranch_execz L_ret
    buffer_load_dwordx4 v14, s[4:7], s38 offen offset:0 lds
    v_mfma_f32_16x16x32_bf16 a[0:3], v[48:51], a[152:155], 0
    ds_read_b128 a[176:179], v29 offset:3072
    buffer_load_dwordx4 v14, s[4:7], s39 offen offset:1024 lds
    buffer_load_dwordx4 v14, s[4:7], s40 offen offset:2048 lds
    v_mfma_f32_16x16x32_bf16 a[4:7], v[52:55], a[152:155], 0
    buffer_load_dwordx4 v14, s[4:7], s41 offen offset:3072 lds
    s_add_u32 m0, s67, 49152
    s_nop 0
    buffer_load_dwordx4 v14, s[4:7], s42 offen offset:0 lds
    v_mfma_f32_16x16x32_bf16 a[8:11], v[48:51], a[156:159], 0
    ds_read_b128 a[180:183], v29 offset:11264
    buffer_load_dwordx4 v14, s[4:7], s43 offen offset:1024 lds
    buffer_load_dwordx4 v14, s[4:7], s44 offen offset:2048 lds
    v_mfma_f32_16x16x32_bf16 a[12:15], v[52:55], a[156:159], 0
    s_waitcnt lgkmcnt(4)
    v_fma_mix_f32 v100, v100, v20, v24 op_sel_hi:[1,0,0]
    s_add_u32 m0, s67, 65536
    v_add_u32 v14, s60, v12
    buffer_load_dwordx4 v14, s[4:7], s38 offen offset:0 lds
    v_mfma_f32_16x16x32_bf16 a[16:19], v[48:51], a[160:163], 0
    ds_read_b128 a[184:187], v29 offset:16384
    v_cvt_pk_bf16_f32 v96, v96, v100
    v_fma_mix_f32 v97, v97, v21, v25 op_sel_hi:[1,0,0]
    v_mfma_f32_16x16x32_bf16 a[20:23], v[52:55], a[160:163], 0
    v_fma_mix_f32 v101, v101, v21, v25 op_sel_hi:[1,0,0]
    buffer_load_dwordx4 v[128:131], v4, s[8:11], s51 offen
    v_mfma_f32_16x16x32_bf16 a[24:27], v[48:51], a[164:167], 0
    ds_read_b128 a[188:191], v29 offset:24576
    v_cvt_pk_bf16_f32 v97, v97, v101
    v_mfma_f32_16x16x32_bf16 a[28:31], v[52:55], a[164:167], 0
    s_waitcnt lgkmcnt(4)
    v_fma_mix_f32 v98, v98, v22, v26 op_sel_hi:[1,0,0]
    s_nop 0
    s_cbranch_execz L_ret
    v_mfma_f32_16x16x32_bf16 a[32:35], v[48:51], a[168:171], 0
    ds_read_b128 a[192:195], v29 offset:17408
    v_fma_mix_f32 v102, v102, v22, v26 op_sel_hi:[1,0,0]
    v_cvt_pk_bf16_f32 v98, v98, v102
    v_mfma_f32_16x16x32_bf16 a[36:39], v[52:55], a[168:171], 0
    v_fma_mix_f32 v99, v99, v23, v27 op_sel_hi:[1,0,0]
    v_fma_mix_f32 v103, v103, v23, v27 op_sel_hi:[1,0,0]
    v_mfma_f32_16x16x32_bf16 a[40:43], v[48:51], a[172:175], 0
    ds_read_b128 a[196:199], v29 offset:25600
    buffer_load_dwordx4 v14, s[4:7], s39 offen offset:1024 lds
    v_cvt_pk_bf16_f32 v99, v99, v103
    v_mfma_f32_16x16x32_bf16 a[44:47], v[52:55], a[172:175], 0
    s_waitcnt lgkmcnt(4)
    s_waitcnt vmcnt(14)
    v_fma_mix_f32 v104, v104, v20, v24 op_sel_hi:[1,0,0]
    v_mfma_f32_16x16x32_bf16 a[48:51], v[48:51], a[176:179], 0
    ds_read_b128 a[152:155], v29 offset:18432
    buffer_load_dwordx4 v[132:135], v5, s[8:11], s51 offen
    v_mfma_f32_16x16x32_bf16 a[52:55], v[52:55], a[176:179], 0
    v_fma_mix_f32 v108, v108, v20, v24 op_sel_hi:[1,0,0]
    v_cvt_pk_bf16_f32 v104, v104, v108
    v_mfma_f32_16x16x32_bf16 a[56:59], v[48:51], a[180:183], 0
    ds_read_b128 a[156:159], v29 offset:26624
    v_fma_mix_f32 v105, v105, v21, v25 op_sel_hi:[1,0,0]
    v_mfma_f32_16x16x32_bf16 a[60:63], v[52:55], a[180:183], 0
    s_waitcnt lgkmcnt(4)
    v_fma_mix_f32 v109, v109, v21, v25 op_sel_hi:[1,0,0]
    v_mfma_f32_16x16x32_bf16 a[64:67], v[48:51], a[184:187], 0
    ds_read_b128 a[160:163], v30 offset:0
    v_cvt_pk_bf16_f32 v105, v105, v109
    v_fma_mix_f32 v106, v106, v22, v26 op_sel_hi:[1,0,0]
    v_mfma_f32_16x16x32_bf16 a[68:71], v[52:55], a[184:187], 0
    v_fma_mix_f32 v110, v110, v22, v26 op_sel_hi:[1,0,0]
    s_cbranch_execz L_ret
    v_cvt_pk_bf16_f32 v106, v106, v110
    v_mfma_f32_16x16x32_bf16 a[72:75], v[48:51], a[188:191], 0
    ds_read_b128 a[164:167], v30 offset:8192
    buffer_load_dwordx4 v14, s[4:7], s40 offen offset:2048 lds
    v_mfma_f32_16x16x32_bf16 a[76:79], v[52:55], a[188:191], 0
    s_waitcnt lgkmcnt(4)
    v_fma_mix_f32 v107, v107, v23, v27 op_sel_hi:[1,0,0]
    buffer_load_dwordx4 v[136:139], v6, s[8:11], s51 offen
    v_mfma_f32_16x16x32_bf16 a[80:83], v[48:51], a[192:195], 0
    ds_read_b128 a[168:171], v30 offset:1024
    v_fma_mix_f32 v111, v111, v23, v27 op_sel_hi:[1,0,0]
    v_mfma_f32_16x16x32_bf16 a[84:87], v[52:55], a[192:195], 0
    v_cvt_pk_bf16_f32 v107, v107, v111
    s_waitcnt vmcnt(15)
    v_fma_mix_f32 v112, v112, v20, v24 op_sel_hi:[1,0,0]
    v_mfma_f32_16x16x32_bf16 a[88:91], v[48:51], a[196:199], 0
    ds_read_b128 a[172:175], v30 offset:9216
    v_fma_mix_f32 v116, v116, v20, v24 op_sel_hi:[1,0,0]
    v_mfma_f32_16x16x32_bf16 a[92:95], v[52:55], a[196:199], 0
    s_waitcnt lgkmcnt(4)
    v_cvt_pk_bf16_f32 v112, v112, v116
    v_mfma_f32_16x16x32_bf16 a[96:99], v[48:51], a[152:155], 0
    ds_read_b128 a[176:179], v30 offset:2048
    v_fma_mix_f32 v113, v113, v21, v25 op_sel_hi:[1,0,0]
    v_fma_mix_f32 v117, v117, v21, v25 op_sel_hi:[1,0,0]
    v_mfma_f32_16x16x32_bf16 a[100:103], v[52:55], a[152:155], 0
    v_cvt_pk_bf16_f32 v113, v113, v117
    buffer_load_dwordx4 v[140:143], v7, s[8:11], s51 offen
    v_mfma_f32_16x16x32_bf16 a[104:107], v[48:51], a[156:159], 0
    ds_read_b128 a[180:183], v30 offset:10240
    v_fma_mix_f32 v114, v114, v22, v26 op_sel_hi:[1,0,0]
    v_mfma_f32_16x16x32_bf16 a[108:111], v[52:55], a[156:159], 0
    s_waitcnt lgkmcnt(4)
    s_nop 0
    s_cbranch_execz L_ret
    buffer_load_dwordx4 v14, s[4:7], s41 offen offset:3072 lds
    v_mfma_f32_16x16x32_bf16 a[0:3], v[56:59], a[160:163], a[0:3]
    ds_read_b128 a[184:187], v30 offset:3072
    v_fma_mix_f32 v118, v118, v22, v26 op_sel_hi:[1,0,0]
    v_cvt_pk_bf16_f32 v114, v114, v118
    v_mfma_f32_16x16x32_bf16 a[4:7], v[60:63], a[160:163], a[4:7]
    v_fma_mix_f32 v115, v115, v23, v27 op_sel_hi:[1,0,0]
    v_fma_mix_f32 v119, v119, v23, v27 op_sel_hi:[1,0,0]
    v_mfma_f32_16x16x32_bf16 a[8:11], v[56:59], a[164:167], a[8:11]
    ds_read_b128 a[188:191], v30 offset:11264
    v_cvt_pk_bf16_f32 v115, v115, v119
    v_mfma_f32_16x16x32_bf16 a[12:15], v[60:63], a[164:167], a[12:15]
    s_waitcnt lgkmcnt(4)
    s_waitcnt vmcnt(15)
    v_fma_mix_f32 v120, v120, v20, v24 op_sel_hi:[1,0,0]
    v_mfma_f32_16x16x32_bf16 a[16:19], v[56:59], a[168:171], a[16:19]
    ds_read_b128 a[192:195], v30 offset:16384
    v_fma_mix_f32 v124, v124, v20, v24 op_sel_hi:[1,0,0]
    v_cvt_pk_bf16_f32 v120, v120, v124
    v_mfma_f32_16x16x32_bf16 a[20:23], v[60:63], a[168:171], a[20:23]
    buffer_load_dwordx4 v[144:147], v8, s[8:11], s51 offen
    v_fma_mix_f32 v121, v121, v21, v25 op_sel_hi:[1,0,0]
    v_mfma_f32_16x16x32_bf16 a[24:27], v[56:59], a[172:175], a[24:27]
    ds_read_b128 a[196:199], v30 offset:24576
    s_add_u32 m0, s67, 81920
    s_nop 0
    buffer_load_dwordx4 v14, s[4:7], s42 offen offset:0 lds
    v_mfma_f32_16x16x32_bf16 a[28:31], v[60:63], a[172:175], a[28:31]
    s_waitcnt lgkmcnt(4)
    v_fma_mix_f32 v125, v125, v21, v25 op_sel_hi:[1,0,0]
    v_mfma_f32_16x16x32_bf16 a[32:35], v[56:59], a[176:179], a[32:35]
    ds_read_b128 a[152:155], v30 offset:17408
    v_cvt_pk_bf16_f32 v121, v121, v125
    s_nop 0
    s_cbranch_execz L_ret
    v_mfma_f32_16x16x32_bf16 a[36:39], v[60:63], a[176:179], a[36:39]
    v_fma_mix_f32 v122, v122, v22, v26 op_sel_hi:[1,0,0]
    v_fma_mix_f32 v126, v126, v22, v26 op_sel_hi:[1,0,0]
    v_mfma_f32_16x16x32_bf16 a[40:43], v[56:59], a[180:183], a[40:43]
    ds_read_b128 a[156:159], v30 offset:25600
    v_cvt_pk_bf16_f32 v122, v122, v126
    v_fma_mix_f32 v123, v123, v23, v27 op_sel_hi:[1,0,0]
    v_mfma_f32_16x16x32_bf16 a[44:47], v[60:63], a[180:183], a[44:47]
    s_waitcnt lgkmcnt(4)
    v_fma_mix_f32 v127, v127, v23, v27 op_sel_hi:[1,0,0]
    v_mfma_f32_16x16x32_bf16 a[48:51], v[56:59], a[184:187], a[48:51]
    ds_read_b128 a[160:163], v30 offset:18432
    buffer_load_dwordx4 v[148:151], v9, s[8:11], s51 offen
    v_cvt_pk_bf16_f32 v123, v123, v127
    v_mfma_f32_16x16x32_bf16 a[52:55], v[60:63], a[184:187], a[52:55]
    s_not_b64 vcc, vcc
    v_cndmask_b32_dpp v64, v98, v96, vcc row_ror:8 row_mask:0xf bank_mask:0xf
    v_mfma_f32_16x16x32_bf16 a[56:59], v[56:59], a[188:191], a[56:59]
    ds_read_b128 a[164:167], v30 offset:26624
    v_cndmask_b32_dpp v65, v106, v104, vcc row_ror:8 row_mask:0xf bank_mask:0xf
    v_mfma_f32_16x16x32_bf16 a[60:63], v[60:63], a[188:191], a[60:63]
    s_waitcnt lgkmcnt(4)
    buffer_load_dwordx4 v14, s[4:7], s43 offen offset:1024 lds
    v_cndmask_b32_dpp v66, v114, v112, vcc row_ror:8 row_mask:0xf bank_mask:0xf
    v_mfma_f32_16x16x32_bf16 a[64:67], v[56:59], a[192:195], a[64:67]
    s_waitcnt vmcnt(12)
    s_barrier
    ds_read_b128 a[168:171], v29 offset:32768
    v_mfma_f32_16x16x32_bf16 a[68:71], v[60:63], a[192:195], a[68:71]
    v_cndmask_b32_dpp v67, v122, v120, vcc row_ror:8 row_mask:0xf bank_mask:0xf
    v_cndmask_b32_dpp v68, v99, v97, vcc row_ror:8 row_mask:0xf bank_mask:0xf
    v_cndmask_b32_dpp v69, v107, v105, vcc row_ror:8 row_mask:0xf bank_mask:0xf
    v_mfma_f32_16x16x32_bf16 a[72:75], v[56:59], a[196:199], a[72:75]
    ds_read_b128 a[172:175], v29 offset:40960
    s_cbranch_execz L_ret
    v_cndmask_b32_dpp v70, v115, v113, vcc row_ror:8 row_mask:0xf bank_mask:0xf
    v_mfma_f32_16x16x32_bf16 a[76:79], v[60:63], a[196:199], a[76:79]
    s_waitcnt lgkmcnt(4)
    buffer_load_dwordx4 v[152:155], v10, s[8:11], s51 offen
    v_mfma_f32_16x16x32_bf16 a[80:83], v[56:59], a[152:155], a[80:83]
    ds_read_b128 a[176:179], v29 offset:33792
    v_cndmask_b32_dpp v71, v123, v121, vcc row_ror:8 row_mask:0xf bank_mask:0xf
    s_not_b64 vcc, vcc
    v_cndmask_b32_dpp v72, v96, v98, vcc row_ror:8 row_mask:0xf bank_mask:0xf
    v_mfma_f32_16x16x32_bf16 a[84:87], v[60:63], a[152:155], a[84:87]
    v_cndmask_b32_dpp v73, v104, v106, vcc row_ror:8 row_mask:0xf bank_mask:0xf
    v_cndmask_b32_dpp v74, v112, v114, vcc row_ror:8 row_mask:0xf bank_mask:0xf
    v_mfma_f32_16x16x32_bf16 a[88:91], v[56:59], a[156:159], a[88:91]
    ds_read_b128 a[180:183], v29 offset:41984
    v_cndmask_b32_dpp v75, v120, v122, vcc row_ror:8 row_mask:0xf bank_mask:0xf
    v_mfma_f32_16x16x32_bf16 a[92:95], v[60:63], a[156:159], a[92:95]
    s_waitcnt lgkmcnt(4)
    buffer_load_dwordx4 v14, s[4:7], s44 offen offset:2048 lds
    v_mfma_f32_16x16x32_bf16 a[96:99], v[56:59], a[160:163], a[96:99]
    ds_read_b128 a[184:187], v29 offset:34816
    v_cndmask_b32_dpp v76, v97, v99, vcc row_ror:8 row_mask:0xf bank_mask:0xf
    v_cndmask_b32_dpp v77, v105, v107, vcc row_ror:8 row_mask:0xf bank_mask:0xf
    v_mfma_f32_16x16x32_bf16 a[100:103], v[60:63], a[160:163], a[100:103]
    v_cndmask_b32_dpp v78, v113, v115, vcc row_ror:8 row_mask:0xf bank_mask:0xf
    v_cndmask_b32_dpp v79, v121, v123, vcc row_ror:8 row_mask:0xf bank_mask:0xf
    v_mfma_f32_16x16x32_bf16 a[104:107], v[56:59], a[164:167], a[104:107]
    ds_read_b128 a[188:191], v29 offset:43008
    buffer_load_dwordx4 v[156:159], v11, s[8:11], s51 offen
    v_mfma_f32_16x16x32_bf16 a[108:111], v[60:63], a[164:167], a[108:111]
    s_waitcnt lgkmcnt(4)
    s_waitcnt vmcnt(11)
    v_fma_mix_f32 v128, v128, v20, v24 op_sel_hi:[1,0,0]
    v_mfma_f32_16x16x32_bf16 a[0:3], v[64:67], a[168:171], a[0:3]
    ds_read_b128 a[192:195], v29 offset:35840
    s_cbranch_execz L_ret
    v_fma_mix_f32 v132, v132, v20, v24 op_sel_hi:[1,0,0]
    v_mfma_f32_16x16x32_bf16 a[4:7], v[68:71], a[168:171], a[4:7]
    s_add_u32 m0, s67, 98304
    v_add_u32 v14, s61, v12
    buffer_load_dwordx4 v14, s[4:7], s38 offen offset:0 lds
    v_mfma_f32_16x16x32_bf16 a[8:11], v[64:67], a[172:175], a[8:11]
    ds_read_b128 a[196:199], v29 offset:44032
    v_cvt_pk_bf16_f32 v128, v128, v132
    v_mfma_f32_16x16x32_bf16 a[12:15], v[68:71], a[172:175], a[12:15]
    s_waitcnt lgkmcnt(4)
    v_fma_mix_f32 v129, v129, v21, v25 op_sel_hi:[1,0,0]
    v_mfma_f32_16x16x32_bf16 a[16:19], v[64:67], a[176:179], a[16:19]
    ds_read_b128 a[152:155], v29 offset:49152
    v_fma_mix_f32 v133, v133, v21, v25 op_sel_hi:[1,0,0]
    v_mfma_f32_16x16x32_bf16 a[20:23], v[68:71], a[176:179], a[20:23]
    buffer_load_dwordx4 v[160:163], v4, s[8:11], s52 offen
    v_cvt_pk_bf16_f32 v129, v129, v133
    v_mfma_f32_16x16x32_bf16 a[24:27], v[64:67], a[180:183], a[24:27]
    ds_read_b128 a[156:159], v29 offset:57344
    v_fma_mix_f32 v130, v130, v22, v26 op_sel_hi:[1,0,0]
    v_mfma_f32_16x16x32_bf16 a[28:31], v[68:71], a[180:183], a[28:31]
    s_waitcnt lgkmcnt(4)
    v_fma_mix_f32 v134, v134, v22, v26 op_sel_hi:[1,0,0]
    v_mfma_f32_16x16x32_bf16 a[32:35], v[64:67], a[184:187], a[32:35]
    ds_read_b128 a[160:163], v29 offset:50176
    v_cvt_pk_bf16_f32 v130, v130, v134
    v_mfma_f32_16x16x32_bf16 a[36:39], v[68:71], a[184:187], a[36:39]
    v_fma_mix_f32 v131, v131, v23, v27 op_sel_hi:[1,0,0]
    v_fma_mix_f32 v135, v135, v23, v27 op_sel_hi:[1,0,0]
    v_mfma_f32_16x16x32_bf16 a[40:43], v[64:67], a[188:191], a[40:43]
    ds_read_b128 a[164:167], v29 offset:58368
    buffer_load_dwordx4 v14, s[4:7], s39 offen offset:1024 lds
    v_cvt_pk_bf16_f32 v131, v131, v135
    s_cbranch_execz L_ret
    v_mfma_f32_16x16x32_bf16 a[44:47], v[68:71], a[188:191], a[44:47]
    s_waitcnt lgkmcnt(4)
    s_waitcnt vmcnt(11)
    v_fma_mix_f32 v136, v136, v20, v24 op_sel_hi:[1,0,0]
    v_mfma_f32_16x16x32_bf16 a[48:51], v[64:67], a[192:195], a[48:51]
    ds_read_b128 a[168:171], v29 offset:51200
    buffer_load_dwordx4 v[164:167], v5, s[8:11], s52 offen
    v_mfma_f32_16x16x32_bf16 a[52:55], v[68:71], a[192:195], a[52:55]
    v_fma_mix_f32 v140, v140, v20, v24 op_sel_hi:[1,0,0]
    v_cvt_pk_bf16_f32 v136, v136, v140
    v_mfma_f32_16x16x32_bf16 a[56:59], v[64:67], a[196:199], a[56:59]
    ds_read_b128 a[172:175], v29 offset:59392
    v_fma_mix_f32 v137, v137, v21, v25 op_sel_hi:[1,0,0]
    v_mfma_f32_16x16x32_bf16 a[60:63], v[68:71], a[196:199], a[60:63]
    s_waitcnt lgkmcnt(4)
    v_fma_mix_f32 v141, v141, v21, v25 op_sel_hi:[1,0,0]
    v_mfma_f32_16x16x32_bf16 a[64:67], v[64:67], a[152:155], a[64:67]
    ds_read_b128 a[176:179], v30 offset:32768
    v_cvt_pk_bf16_f32 v137, v137, v141
    v_fma_mix_f32 v138, v138, v22, v26 op_sel_hi:[1,0,0]
    v_mfma_f32_16x16x32_bf16 a[68:71], v[68:71], a[152:155], a[68:71]
    v_fma_mix_f32 v142, v142, v22, v26 op_sel_hi:[1,0,0]
    v_cvt_pk_bf16_f32 v138, v138, v142
    v_mfma_f32_16x16x32_bf16 a[72:75], v[64:67], a[156:159], a[72:75]
    ds_read_b128 a[180:183], v30 offset:40960
    buffer_load_dwordx4 v14, s[4:7], s40 offen offset:2048 lds
    v_mfma_f32_16x16x32_bf16 a[76:79], v[68:71], a[156:159], a[76:79]
    s_waitcnt lgkmcnt(4)
    v_fma_mix_f32 v139, v139, v23, v27 op_sel_hi:[1,0,0]
    buffer_load_dwordx4 v[168:171], v6, s[8:11], s52 offen
    v_mfma_f32_16x16x32_bf16 a[80:83], v[64:67], a[160:163], a[80:83]
    ds_read_b128 a[184:187], v30 offset:33792
    v_fma_mix_f32 v143, v143, v23, v27 op_sel_hi:[1,0,0]
    s_nop 0
    s_cbranch_execz L_ret
    v_mfma_f32_16x16x32_bf16 a[84:87], v[68:71], a[160:163], a[84:87]
    v_cvt_pk_bf16_f32 v139, v139, v143
    s_waitcnt vmcnt(10)
    v_fma_mix_f32 v144, v144, v20, v24 op_sel_hi:[1,0,0]
    v_mfma_f32_16x16x32_bf16 a[88:91], v[64:67], a[164:167], a[88:91]
    ds_read_b128 a[188:191], v30 offset:41984
    v_fma_mix_f32 v148, v148, v20, v24 op_sel_hi:[1,0,0]
    v_mfma_f32_16x16x32_bf16 a[92:95], v[68:71], a[164:167], a[92:95]
    s_waitcnt lgkmcnt(4)
    v_cvt_pk_bf16_f32 v144, v144, v148
    v_mfma_f32_16x16x32_bf16 a[96:99], v[64:67], a[168:171], a[96:99]
    ds_read_b128 a[192:195], v30 offset:34816
    v_fma_mix_f32 v145, v145, v21, v25 op_sel_hi:[1,0,0]
    v_fma_mix_f32 v149, v149, v21, v25 op_sel_hi:[1,0,0]
    v_mfma_f32_16x16x32_bf16 a[100:103], v[68:71], a[168:171], a[100:103]
    v_cvt_pk_bf16_f32 v145, v145, v149
    buffer_load_dwordx4 v[172:175], v7, s[8:11], s52 offen
    v_mfma_f32_16x16x32_bf16 a[104:107], v[64:67], a[172:175], a[104:107]
    ds_read_b128 a[196:199], v30 offset:43008
    v_fma_mix_f32 v146, v146, v22, v26 op_sel_hi:[1,0,0]
    v_mfma_f32_16x16x32_bf16 a[108:111], v[68:71], a[172:175], a[108:111]
    s_waitcnt lgkmcnt(4)
    buffer_load_dwordx4 v14, s[4:7], s41 offen offset:3072 lds
    v_mfma_f32_16x16x32_bf16 a[0:3], v[72:75], a[176:179], a[0:3]
    ds_read_b128 a[152:155], v30 offset:35840
    v_fma_mix_f32 v150, v150, v22, v26 op_sel_hi:[1,0,0]
    v_cvt_pk_bf16_f32 v146, v146, v150
    v_mfma_f32_16x16x32_bf16 a[4:7], v[76:79], a[176:179], a[4:7]
    v_fma_mix_f32 v147, v147, v23, v27 op_sel_hi:[1,0,0]
    v_fma_mix_f32 v151, v151, v23, v27 op_sel_hi:[1,0,0]
    v_mfma_f32_16x16x32_bf16 a[8:11], v[72:75], a[180:183], a[8:11]
    ds_read_b128 a[156:159], v30 offset:44032
    v_cvt_pk_bf16_f32 v147, v147, v151
    s_cbranch_execz L_ret
    v_mfma_f32_16x16x32_bf16 a[12:15], v[76:79], a[180:183], a[12:15]
    s_waitcnt lgkmcnt(4)
    s_waitcnt vmcnt(8)
    v_fma_mix_f32 v152, v152, v20, v24 op_sel_hi:[1,0,0]
    v_mfma_f32_16x16x32_bf16 a[16:19], v[72:75], a[184:187], a[16:19]
    ds_read_b128 a[160:163], v30 offset:49152
    v_fma_mix_f32 v156, v156, v20, v24 op_sel_hi:[1,0,0]
    v_cvt_pk_bf16_f32 v152, v152, v156
    v_mfma_f32_16x16x32_bf16 a[20:23], v[76:79], a[184:187], a[20:23]
    buffer_load_dwordx4 v[176:179], v8, s[8:11], s52 offen
    v_fma_mix_f32 v153, v153, v21, v25 op_sel_hi:[1,0,0]
    v_mfma_f32_16x16x32_bf16 a[24:27], v[72:75], a[188:191], a[24:27]
    ds_read_b128 a[164:167], v30 offset:57344
    s_add_u32 m0, s67, 114688
    s_nop 0
    buffer_load_dwordx4 v14, s[4:7], s42 offen offset:0 lds
    v_mfma_f32_16x16x32_bf16 a[28:31], v[76:79], a[188:191], a[28:31]
    s_waitcnt lgkmcnt(4)
    v_fma_mix_f32 v157, v157, v21, v25 op_sel_hi:[1,0,0]
    v_mfma_f32_16x16x32_bf16 a[32:35], v[72:75], a[192:195], a[32:35]
    ds_read_b128 a[168:171], v30 offset:50176
    v_cvt_pk_bf16_f32 v153, v153, v157
    v_mfma_f32_16x16x32_bf16 a[36:39], v[76:79], a[192:195], a[36:39]
    v_fma_mix_f32 v154, v154, v22, v26 op_sel_hi:[1,0,0]
    v_fma_mix_f32 v158, v158, v22, v26 op_sel_hi:[1,0,0]
    v_mfma_f32_16x16x32_bf16 a[40:43], v[72:75], a[196:199], a[40:43]
    ds_read_b128 a[172:175], v30 offset:58368
    v_cvt_pk_bf16_f32 v154, v154, v158
    v_fma_mix_f32 v155, v155, v23, v27 op_sel_hi:[1,0,0]
    v_mfma_f32_16x16x32_bf16 a[44:47], v[76:79], a[196:199], a[44:47]
    s_waitcnt lgkmcnt(4)
    v_fma_mix_f32 v159, v159, v23, v27 op_sel_hi:[1,0,0]
    v_mfma_f32_16x16x32_bf16 a[48:51], v[72:75], a[152:155], a[48:51]
    ds_read_b128 a[176:179], v30 offset:51200
    s_cbranch_execz L_ret
    buffer_load_dwordx4 v[180:183], v9, s[8:11], s52 offen
    v_cvt_pk_bf16_f32 v155, v155, v159
    v_mfma_f32_16x16x32_bf16 a[52:55], v[76:79], a[152:155], a[52:55]
    s_not_b64 vcc, vcc
    v_cndmask_b32_dpp v80, v130, v128, vcc row_ror:8 row_mask:0xf bank_mask:0xf
    v_mfma_f32_16x16x32_bf16 a[56:59], v[72:75], a[156:159], a[56:59]
    ds_read_b128 a[180:183], v30 offset:59392
    v_cndmask_b32_dpp v81, v138, v136, vcc row_ror:8 row_mask:0xf bank_mask:0xf
    v_mfma_f32_16x16x32_bf16 a[60:63], v[76:79], a[156:159], a[60:63]
    s_waitcnt lgkmcnt(4)
    buffer_load_dwordx4 v14, s[4:7], s43 offen offset:1024 lds
    v_cndmask_b32_dpp v82, v146, v144, vcc row_ror:8 row_mask:0xf bank_mask:0xf
    v_mfma_f32_16x16x32_bf16 a[64:67], v[72:75], a[160:163], a[64:67]
    s_barrier
    ds_read_b128 a[184:187], v31 offset:0
    v_mfma_f32_16x16x32_bf16 a[68:71], v[76:79], a[160:163], a[68:71]
    v_cndmask_b32_dpp v83, v154, v152, vcc row_ror:8 row_mask:0xf bank_mask:0xf
    v_cndmask_b32_dpp v84, v131, v129, vcc row_ror:8 row_mask:0xf bank_mask:0xf
    v_cndmask_b32_dpp v85, v139, v137, vcc row_ror:8 row_mask:0xf bank_mask:0xf
    v_mfma_f32_16x16x32_bf16 a[72:75], v[72:75], a[164:167], a[72:75]
    ds_read_b128 a[188:191], v31 offset:8192
    v_cndmask_b32_dpp v86, v147, v145, vcc row_ror:8 row_mask:0xf bank_mask:0xf
    v_mfma_f32_16x16x32_bf16 a[76:79], v[76:79], a[164:167], a[76:79]
    s_waitcnt lgkmcnt(4)
    buffer_load_dwordx4 v[184:187], v10, s[8:11], s52 offen
    v_mfma_f32_16x16x32_bf16 a[80:83], v[72:75], a[168:171], a[80:83]
    ds_read_b128 a[192:195], v31 offset:1024
    v_cndmask_b32_dpp v87, v155, v153, vcc row_ror:8 row_mask:0xf bank_mask:0xf
    s_not_b64 vcc, vcc
    v_cndmask_b32_dpp v88, v128, v130, vcc row_ror:8 row_mask:0xf bank_mask:0xf
    v_mfma_f32_16x16x32_bf16 a[84:87], v[76:79], a[168:171], a[84:87]
    v_cndmask_b32_dpp v89, v136, v138, vcc row_ror:8 row_mask:0xf bank_mask:0xf
    v_cndmask_b32_dpp v90, v144, v146, vcc row_ror:8 row_mask:0xf bank_mask:0xf
    v_mfma_f32_16x16x32_bf16 a[88:91], v[72:75], a[172:175], a[88:91]
    s_cbranch_execz L_ret
    ds_read_b128 a[196:199], v31 offset:9216
    v_cndmask_b32_dpp v91, v152, v154, vcc row_ror:8 row_mask:0xf bank_mask:0xf
    v_mfma_f32_16x16x32_bf16 a[92:95], v[76:79], a[172:175], a[92:95]
    s_waitcnt lgkmcnt(4)
    buffer_load_dwordx4 v14, s[4:7], s44 offen offset:2048 lds
    v_mfma_f32_16x16x32_bf16 a[96:99], v[72:75], a[176:179], a[96:99]
    ds_read_b128 a[152:155], v31 offset:2048
    v_cndmask_b32_dpp v92, v129, v131, vcc row_ror:8 row_mask:0xf bank_mask:0xf
    v_cndmask_b32_dpp v93, v137, v139, vcc row_ror:8 row_mask:0xf bank_mask:0xf
    v_mfma_f32_16x16x32_bf16 a[100:103], v[76:79], a[176:179], a[100:103]
    v_cndmask_b32_dpp v94, v145, v147, vcc row_ror:8 row_mask:0xf bank_mask:0xf
    v_cndmask_b32_dpp v95, v153, v155, vcc row_ror:8 row_mask:0xf bank_mask:0xf
    v_mfma_f32_16x16x32_bf16 a[104:107], v[72:75], a[180:183], a[104:107]
    ds_read_b128 a[156:159], v31 offset:10240
    buffer_load_dwordx4 v[188:191], v11, s[8:11], s52 offen
    v_mfma_f32_16x16x32_bf16 a[108:111], v[76:79], a[180:183], a[108:111]
    s_waitcnt lgkmcnt(4)
    s_waitcnt vmcnt(11)
    v_fma_mix_f32 v160, v160, v20, v24 op_sel_hi:[1,0,0]
    v_mfma_f32_16x16x32_bf16 a[0:3], v[80:83], a[184:187], a[0:3]
    ds_read_b128 a[160:163], v31 offset:3072
    v_fma_mix_f32 v164, v164, v20, v24 op_sel_hi:[1,0,0]
    v_mfma_f32_16x16x32_bf16 a[4:7], v[84:87], a[184:187], a[4:7]
    s_add_u32 m0, s67, 0
    v_add_u32 v14, s62, v12
    buffer_load_dwordx4 v14, s[4:7], s38 offen offset:0 lds
    v_mfma_f32_16x16x32_bf16 a[8:11], v[80:83], a[188:191], a[8:11]
    ds_read_b128 a[164:167], v31 offset:11264
    v_cvt_pk_bf16_f32 v160, v160, v164
    v_mfma_f32_16x16x32_bf16 a[12:15], v[84:87], a[188:191], a[12:15]
    s_waitcnt lgkmcnt(4)
    v_fma_mix_f32 v161, v161, v21, v25 op_sel_hi:[1,0,0]
    v_mfma_f32_16x16x32_bf16 a[16:19], v[80:83], a[192:195], a[16:19]
    ds_read_b128 a[168:171], v31 offset:16384
    s_nop 0
    s_cbranch_execz L_ret
    v_fma_mix_f32 v165, v165, v21, v25 op_sel_hi:[1,0,0]
    v_mfma_f32_16x16x32_bf16 a[20:23], v[84:87], a[192:195], a[20:23]
    buffer_load_dwordx4 v[192:195], v4, s[8:11], s53 offen
    v_cvt_pk_bf16_f32 v161, v161, v165
    v_mfma_f32_16x16x32_bf16 a[24:27], v[80:83], a[196:199], a[24:27]
    ds_read_b128 a[172:175], v31 offset:24576
    v_fma_mix_f32 v162, v162, v22, v26 op_sel_hi:[1,0,0]
    v_mfma_f32_16x16x32_bf16 a[28:31], v[84:87], a[196:199], a[28:31]
    s_waitcnt lgkmcnt(4)
    v_fma_mix_f32 v166, v166, v22, v26 op_sel_hi:[1,0,0]
    v_mfma_f32_16x16x32_bf16 a[32:35], v[80:83], a[152:155], a[32:35]
    ds_read_b128 a[176:179], v31 offset:17408
    v_cvt_pk_bf16_f32 v162, v162, v166
    v_mfma_f32_16x16x32_bf16 a[36:39], v[84:87], a[152:155], a[36:39]
    v_fma_mix_f32 v163, v163, v23, v27 op_sel_hi:[1,0,0]
    v_fma_mix_f32 v167, v167, v23, v27 op_sel_hi:[1,0,0]
    v_mfma_f32_16x16x32_bf16 a[40:43], v[80:83], a[156:159], a[40:43]
    ds_read_b128 a[180:183], v31 offset:25600
    buffer_load_dwordx4 v14, s[4:7], s39 offen offset:1024 lds
    v_cvt_pk_bf16_f32 v163, v163, v167
    v_mfma_f32_16x16x32_bf16 a[44:47], v[84:87], a[156:159], a[44:47]
    s_waitcnt lgkmcnt(4)
    s_waitcnt vmcnt(11)
    v_fma_mix_f32 v168, v168, v20, v24 op_sel_hi:[1,0,0]
    v_mfma_f32_16x16x32_bf16 a[48:51], v[80:83], a[160:163], a[48:51]
    ds_read_b128 a[184:187], v31 offset:18432
    buffer_load_dwordx4 v[196:199], v5, s[8:11], s53 offen
    v_mfma_f32_16x16x32_bf16 a[52:55], v[84:87], a[160:163], a[52:55]
    v_fma_mix_f32 v172, v172, v20, v24 op_sel_hi:[1,0,0]
    v_cvt_pk_bf16_f32 v168, v168, v172
    v_mfma_f32_16x16x32_bf16 a[56:59], v[80:83], a[164:167], a[56:59]
    ds_read_b128 a[188:191], v31 offset:26624
    v_fma_mix_f32 v169, v169, v21, v25 op_sel_hi:[1,0,0]
    s_cbranch_execz L_ret
    v_mfma_f32_16x16x32_bf16 a[60:63], v[84:87], a[164:167], a[60:63]
    s_waitcnt lgkmcnt(4)
    v_fma_mix_f32 v173, v173, v21, v25 op_sel_hi:[1,0,0]
    v_mfma_f32_16x16x32_bf16 a[64:67], v[80:83], a[168:171], a[64:67]
    ds_read_b128 a[192:195], v32 offset:0
    v_cvt_pk_bf16_f32 v169, v169, v173
    v_fma_mix_f32 v170, v170, v22, v26 op_sel_hi:[1,0,0]
    v_mfma_f32_16x16x32_bf16 a[68:71], v[84:87], a[168:171], a[68:71]
    v_fma_mix_f32 v174, v174, v22, v26 op_sel_hi:[1,0,0]
    v_cvt_pk_bf16_f32 v170, v170, v174
    v_mfma_f32_16x16x32_bf16 a[72:75], v[80:83], a[172:175], a[72:75]
    ds_read_b128 a[196:199], v32 offset:8192
    buffer_load_dwordx4 v14, s[4:7], s40 offen offset:2048 lds
    v_mfma_f32_16x16x32_bf16 a[76:79], v[84:87], a[172:175], a[76:79]
    s_waitcnt lgkmcnt(4)
    v_fma_mix_f32 v171, v171, v23, v27 op_sel_hi:[1,0,0]
    buffer_load_dwordx4 v[200:203], v6, s[8:11], s53 offen
    v_mfma_f32_16x16x32_bf16 a[80:83], v[80:83], a[176:179], a[80:83]
    ds_read_b128 a[152:155], v32 offset:1024
    v_fma_mix_f32 v175, v175, v23, v27 op_sel_hi:[1,0,0]
    v_mfma_f32_16x16x32_bf16 a[84:87], v[84:87], a[176:179], a[84:87]
    v_cvt_pk_bf16_f32 v171, v171, v175
    s_waitcnt vmcnt(10)
    v_fma_mix_f32 v176, v176, v20, v24 op_sel_hi:[1,0,0]
    v_mfma_f32_16x16x32_bf16 a[88:91], v[80:83], a[180:183], a[88:91]
    ds_read_b128 a[156:159], v32 offset:9216
    v_fma_mix_f32 v180, v180, v20, v24 op_sel_hi:[1,0,0]
    v_mfma_f32_16x16x32_bf16 a[92:95], v[84:87], a[180:183], a[92:95]
    s_waitcnt lgkmcnt(4)
    v_cvt_pk_bf16_f32 v176, v176, v180
    v_mfma_f32_16x16x32_bf16 a[96:99], v[80:83], a[184:187], a[96:99]
    ds_read_b128 a[160:163], v32 offset:2048
    v_fma_mix_f32 v177, v177, v21, v25 op_sel_hi:[1,0,0]
    s_nop 0
    s_cbranch_execz L_ret
    v_fma_mix_f32 v181, v181, v21, v25 op_sel_hi:[1,0,0]
    v_mfma_f32_16x16x32_bf16 a[100:103], v[84:87], a[184:187], a[100:103]
    v_cvt_pk_bf16_f32 v177, v177, v181
    buffer_load_dwordx4 v[204:207], v7, s[8:11], s53 offen
    v_mfma_f32_16x16x32_bf16 a[104:107], v[80:83], a[188:191], a[104:107]
    ds_read_b128 a[164:167], v32 offset:10240
    v_fma_mix_f32 v178, v178, v22, v26 op_sel_hi:[1,0,0]
    v_mfma_f32_16x16x32_bf16 a[108:111], v[84:87], a[188:191], a[108:111]
    s_waitcnt lgkmcnt(4)
    buffer_load_dwordx4 v14, s[4:7], s41 offen offset:3072 lds
    v_mfma_f32_16x16x32_bf16 a[0:3], v[88:91], a[192:195], a[0:3]
    ds_read_b128 a[168:171], v32 offset:3072
    v_fma_mix_f32 v182, v182, v22, v26 op_sel_hi:[1,0,0]
    v_cvt_pk_bf16_f32 v178, v178, v182
    v_mfma_f32_16x16x32_bf16 a[4:7], v[92:95], a[192:195], a[4:7]
    v_fma_mix_f32 v179, v179, v23, v27 op_sel_hi:[1,0,0]
    v_fma_mix_f32 v183, v183, v23, v27 op_sel_hi:[1,0,0]
    v_mfma_f32_16x16x32_bf16 a[8:11], v[88:91], a[196:199], a[8:11]
    ds_read_b128 a[172:175], v32 offset:11264
    v_cvt_pk_bf16_f32 v179, v179, v183
    v_mfma_f32_16x16x32_bf16 a[12:15], v[92:95], a[196:199], a[12:15]
    s_waitcnt lgkmcnt(4)
    s_waitcnt vmcnt(8)
    v_fma_mix_f32 v184, v184, v20, v24 op_sel_hi:[1,0,0]
    v_mfma_f32_16x16x32_bf16 a[16:19], v[88:91], a[152:155], a[16:19]
    ds_read_b128 a[176:179], v32 offset:16384
    v_fma_mix_f32 v188, v188, v20, v24 op_sel_hi:[1,0,0]
    v_cvt_pk_bf16_f32 v184, v184, v188
    v_mfma_f32_16x16x32_bf16 a[20:23], v[92:95], a[152:155], a[20:23]
    buffer_load_dwordx4 v[208:211], v8, s[8:11], s53 offen
    v_fma_mix_f32 v185, v185, v21, v25 op_sel_hi:[1,0,0]
    v_mfma_f32_16x16x32_bf16 a[24:27], v[88:91], a[156:159], a[24:27]
    ds_read_b128 a[180:183], v32 offset:24576
    s_cbranch_execz L_ret
    s_add_u32 m0, s67, 16384
    s_nop 0
    buffer_load_dwordx4 v14, s[4:7], s42 offen offset:0 lds
    v_mfma_f32_16x16x32_bf16 a[28:31], v[92:95], a[156:159], a[28:31]
    s_waitcnt lgkmcnt(4)
    v_fma_mix_f32 v189, v189, v21, v25 op_sel_hi:[1,0,0]
    v_mfma_f32_16x16x32_bf16 a[32:35], v[88:91], a[160:163], a[32:35]
    ds_read_b128 a[184:187], v32 offset:17408
    v_cvt_pk_bf16_f32 v185, v185, v189
    v_mfma_f32_16x16x32_bf16 a[36:39], v[92:95], a[160:163], a[36:39]
    v_fma_mix_f32 v186, v186, v22, v26 op_sel_hi:[1,0,0]
    v_fma_mix_f32 v190, v190, v22, v26 op_sel_hi:[1,0,0]
    v_mfma_f32_16x16x32_bf16 a[40:43], v[88:91], a[164:167], a[40:43]
    ds_read_b128 a[188:191], v32 offset:25600
    v_cvt_pk_bf16_f32 v186, v186, v190
    v_fma_mix_f32 v187, v187, v23, v27 op_sel_hi:[1,0,0]
    v_mfma_f32_16x16x32_bf16 a[44:47], v[92:95], a[164:167], a[44:47]
    s_waitcnt lgkmcnt(4)
    v_fma_mix_f32 v191, v191, v23, v27 op_sel_hi:[1,0,0]
    v_mfma_f32_16x16x32_bf16 a[48:51], v[88:91], a[168:171], a[48:51]
    ds_read_b128 a[192:195], v32 offset:18432
    buffer_load_dwordx4 v[212:215], v9, s[8:11], s53 offen
    v_cvt_pk_bf16_f32 v187, v187, v191
    v_mfma_f32_16x16x32_bf16 a[52:55], v[92:95], a[168:171], a[52:55]
    s_not_b64 vcc, vcc
    v_cndmask_b32_dpp v96, v162, v160, vcc row_ror:8 row_mask:0xf bank_mask:0xf
    v_mfma_f32_16x16x32_bf16 a[56:59], v[88:91], a[172:175], a[56:59]
    ds_read_b128 a[196:199], v32 offset:26624
    v_cndmask_b32_dpp v97, v170, v168, vcc row_ror:8 row_mask:0xf bank_mask:0xf
    v_mfma_f32_16x16x32_bf16 a[60:63], v[92:95], a[172:175], a[60:63]
    s_waitcnt lgkmcnt(4)
    buffer_load_dwordx4 v14, s[4:7], s43 offen offset:1024 lds
    v_cndmask_b32_dpp v98, v178, v176, vcc row_ror:8 row_mask:0xf bank_mask:0xf
    v_mfma_f32_16x16x32_bf16 a[64:67], v[88:91], a[176:179], a[64:67]
    s_cbranch_execz L_ret
    s_barrier
    ds_read_b128 a[152:155], v31 offset:32768
    v_mfma_f32_16x16x32_bf16 a[68:71], v[92:95], a[176:179], a[68:71]
    v_cndmask_b32_dpp v99, v186, v184, vcc row_ror:8 row_mask:0xf bank_mask:0xf
    v_cndmask_b32_dpp v100, v163, v161, vcc row_ror:8 row_mask:0xf bank_mask:0xf
    v_cndmask_b32_dpp v101, v171, v169, vcc row_ror:8 row_mask:0xf bank_mask:0xf
    v_mfma_f32_16x16x32_bf16 a[72:75], v[88:91], a[180:183], a[72:75]
    ds_read_b128 a[156:159], v31 offset:40960
    v_cndmask_b32_dpp v102, v179, v177, vcc row_ror:8 row_mask:0xf bank_mask:0xf
    v_mfma_f32_16x16x32_bf16 a[76:79], v[92:95], a[180:183], a[76:79]
    s_waitcnt lgkmcnt(4)
    buffer_load_dwordx4 v[216:219], v10, s[8:11], s53 offen
    v_mfma_f32_16x16x32_bf16 a[80:83], v[88:91], a[184:187], a[80:83]
    ds_read_b128 a[160:163], v31 offset:33792
    v_cndmask_b32_dpp v103, v187, v185, vcc row_ror:8 row_mask:0xf bank_mask:0xf
    s_not_b64 vcc, vcc
    v_cndmask_b32_dpp v104, v160, v162, vcc row_ror:8 row_mask:0xf bank_mask:0xf
    v_mfma_f32_16x16x32_bf16 a[84:87], v[92:95], a[184:187], a[84:87]
    v_cndmask_b32_dpp v105, v168, v170, vcc row_ror:8 row_mask:0xf bank_mask:0xf
    v_cndmask_b32_dpp v106, v176, v178, vcc row_ror:8 row_mask:0xf bank_mask:0xf
    v_mfma_f32_16x16x32_bf16 a[88:91], v[88:91], a[188:191], a[88:91]
    ds_read_b128 a[164:167], v31 offset:41984
    v_cndmask_b32_dpp v107, v184, v186, vcc row_ror:8 row_mask:0xf bank_mask:0xf
    v_mfma_f32_16x16x32_bf16 a[92:95], v[92:95], a[188:191], a[92:95]
    s_waitcnt lgkmcnt(4)
    buffer_load_dwordx4 v14, s[4:7], s44 offen offset:2048 lds
    v_mfma_f32_16x16x32_bf16 a[96:99], v[88:91], a[192:195], a[96:99]
    ds_read_b128 a[168:171], v31 offset:34816
    v_cndmask_b32_dpp v108, v161, v163, vcc row_ror:8 row_mask:0xf bank_mask:0xf
    v_cndmask_b32_dpp v109, v169, v171, vcc row_ror:8 row_mask:0xf bank_mask:0xf
    v_mfma_f32_16x16x32_bf16 a[100:103], v[92:95], a[192:195], a[100:103]
    v_cndmask_b32_dpp v110, v177, v179, vcc row_ror:8 row_mask:0xf bank_mask:0xf
    v_cndmask_b32_dpp v111, v185, v187, vcc row_ror:8 row_mask:0xf bank_mask:0xf
    s_nop 0
    s_cbranch_execz L_ret
    v_mfma_f32_16x16x32_bf16 a[104:107], v[88:91], a[196:199], a[104:107]
    ds_read_b128 a[172:175], v31 offset:43008
    buffer_load_dwordx4 v[220:223], v11, s[8:11], s53 offen
    v_mfma_f32_16x16x32_bf16 a[108:111], v[92:95], a[196:199], a[108:111]
    s_waitcnt lgkmcnt(4)
    s_waitcnt vmcnt(11)
    v_fma_mix_f32 v192, v192, v20, v24 op_sel_hi:[1,0,0]
    v_mfma_f32_16x16x32_bf16 a[0:3], v[96:99], a[152:155], a[0:3]
    ds_read_b128 a[176:179], v31 offset:35840
    v_fma_mix_f32 v196, v196, v20, v24 op_sel_hi:[1,0,0]
    v_mfma_f32_16x16x32_bf16 a[4:7], v[100:103], a[152:155], a[4:7]
    s_add_u32 m0, s67, 32768
    v_add_u32 v14, s63, v12
    buffer_load_dwordx4 v14, s[4:7], s38 offen offset:0 lds
    v_mfma_f32_16x16x32_bf16 a[8:11], v[96:99], a[156:159], a[8:11]
    ds_read_b128 a[180:183], v31 offset:44032
    v_cvt_pk_bf16_f32 v192, v192, v196
    v_mfma_f32_16x16x32_bf16 a[12:15], v[100:103], a[156:159], a[12:15]
    s_waitcnt lgkmcnt(4)
    v_fma_mix_f32 v193, v193, v21, v25 op_sel_hi:[1,0,0]
    v_mfma_f32_16x16x32_bf16 a[16:19], v[96:99], a[160:163], a[16:19]
    ds_read_b128 a[184:187], v31 offset:49152
    v_fma_mix_f32 v197, v197, v21, v25 op_sel_hi:[1,0,0]
    v_mfma_f32_16x16x32_bf16 a[20:23], v[100:103], a[160:163], a[20:23]
    buffer_load_dwordx4 v[224:227], v4, s[8:11], s54 offen
    v_cvt_pk_bf16_f32 v193, v193, v197
    v_mfma_f32_16x16x32_bf16 a[24:27], v[96:99], a[164:167], a[24:27]
    ds_read_b128 a[188:191], v31 offset:57344
    v_fma_mix_f32 v194, v194, v22, v26 op_sel_hi:[1,0,0]
    v_mfma_f32_16x16x32_bf16 a[28:31], v[100:103], a[164:167], a[28:31]
    s_waitcnt lgkmcnt(4)
    v_fma_mix_f32 v198, v198, v22, v26 op_sel_hi:[1,0,0]
    v_mfma_f32_16x16x32_bf16 a[32:35], v[96:99], a[168:171], a[32:35]
    ds_read_b128 a[192:195], v31 offset:50176
    s_cbranch_execz L_ret
    v_cvt_pk_bf16_f32 v194, v194, v198
    v_mfma_f32_16x16x32_bf16 a[36:39], v[100:103], a[168:171], a[36:39]
    v_fma_mix_f32 v195, v195, v23, v27 op_sel_hi:[1,0,0]
    v_fma_mix_f32 v199, v199, v23, v27 op_sel_hi:[1,0,0]
    v_mfma_f32_16x16x32_bf16 a[40:43], v[96:99], a[172:175], a[40:43]
    ds_read_b128 a[196:199], v31 offset:58368
    buffer_load_dwordx4 v14, s[4:7], s39 offen offset:1024 lds
    v_cvt_pk_bf16_f32 v195, v195, v199
    v_mfma_f32_16x16x32_bf16 a[44:47], v[100:103], a[172:175], a[44:47]
    s_waitcnt lgkmcnt(4)
    s_waitcnt vmcnt(11)
    v_fma_mix_f32 v200, v200, v20, v24 op_sel_hi:[1,0,0]
    v_mfma_f32_16x16x32_bf16 a[48:51], v[96:99], a[176:179], a[48:51]
    ds_read_b128 a[152:155], v31 offset:51200
    buffer_load_dwordx4 v[228:231], v5, s[8:11], s54 offen
    v_mfma_f32_16x16x32_bf16 a[52:55], v[100:103], a[176:179], a[52:55]
    v_fma_mix_f32 v204, v204, v20, v24 op_sel_hi:[1,0,0]
    v_cvt_pk_bf16_f32 v200, v200, v204
    v_mfma_f32_16x16x32_bf16 a[56:59], v[96:99], a[180:183], a[56:59]
    ds_read_b128 a[156:159], v31 offset:59392
    v_fma_mix_f32 v201, v201, v21, v25 op_sel_hi:[1,0,0]
    v_mfma_f32_16x16x32_bf16 a[60:63], v[100:103], a[180:183], a[60:63]
    s_waitcnt lgkmcnt(4)
    v_fma_mix_f32 v205, v205, v21, v25 op_sel_hi:[1,0,0]
    v_mfma_f32_16x16x32_bf16 a[64:67], v[96:99], a[184:187], a[64:67]
    ds_read_b128 a[160:163], v32 offset:32768
    v_cvt_pk_bf16_f32 v201, v201, v205
    v_fma_mix_f32 v202, v202, v22, v26 op_sel_hi:[1,0,0]
    v_mfma_f32_16x16x32_bf16 a[68:71], v[100:103], a[184:187], a[68:71]
    v_fma_mix_f32 v206, v206, v22, v26 op_sel_hi:[1,0,0]
    v_cvt_pk_bf16_f32 v202, v202, v206
    v_mfma_f32_16x16x32_bf16 a[72:75], v[96:99], a[188:191], a[72:75]
    ds_read_b128 a[164:167], v32 offset:40960
    s_cbranch_execz L_ret
    buffer_load_dwordx4 v14, s[4:7], s40 offen offset:2048 lds
    v_mfma_f32_16x16x32_bf16 a[76:79], v[100:103], a[188:191], a[76:79]
    s_waitcnt lgkmcnt(4)
    v_fma_mix_f32 v203, v203, v23, v27 op_sel_hi:[1,0,0]
    buffer_load_dwordx4 v[232:235], v6, s[8:11], s54 offen
    v_mfma_f32_16x16x32_bf16 a[80:83], v[96:99], a[192:195], a[80:83]
    ds_read_b128 a[168:171], v32 offset:33792
    v_fma_mix_f32 v207, v207, v23, v27 op_sel_hi:[1,0,0]
    v_mfma_f32_16x16x32_bf16 a[84:87], v[100:103], a[192:195], a[84:87]
    v_cvt_pk_bf16_f32 v203, v203, v207
    s_waitcnt vmcnt(10)
    v_fma_mix_f32 v208, v208, v20, v24 op_sel_hi:[1,0,0]
    v_mfma_f32_16x16x32_bf16 a[88:91], v[96:99], a[196:199], a[88:91]
    ds_read_b128 a[172:175], v32 offset:41984
    v_fma_mix_f32 v212, v212, v20, v24 op_sel_hi:[1,0,0]
    v_mfma_f32_16x16x32_bf16 a[92:95], v[100:103], a[196:199], a[92:95]
    s_waitcnt lgkmcnt(4)
    v_cvt_pk_bf16_f32 v208, v208, v212
    v_mfma_f32_16x16x32_bf16 a[96:99], v[96:99], a[152:155], a[96:99]
    ds_read_b128 a[176:179], v32 offset:34816
    v_fma_mix_f32 v209, v209, v21, v25 op_sel_hi:[1,0,0]
    v_fma_mix_f32 v213, v213, v21, v25 op_sel_hi:[1,0,0]
    v_mfma_f32_16x16x32_bf16 a[100:103], v[100:103], a[152:155], a[100:103]
    v_cvt_pk_bf16_f32 v209, v209, v213
    buffer_load_dwordx4 v[236:239], v7, s[8:11], s54 offen
    v_mfma_f32_16x16x32_bf16 a[104:107], v[96:99], a[156:159], a[104:107]
    ds_read_b128 a[180:183], v32 offset:43008
    v_fma_mix_f32 v210, v210, v22, v26 op_sel_hi:[1,0,0]
    v_mfma_f32_16x16x32_bf16 a[108:111], v[100:103], a[156:159], a[108:111]
    s_waitcnt lgkmcnt(4)
    buffer_load_dwordx4 v14, s[4:7], s41 offen offset:3072 lds
    v_mfma_f32_16x16x32_bf16 a[0:3], v[104:107], a[160:163], a[0:3]
    ds_read_b128 a[184:187], v32 offset:35840
    s_nop 0
    s_cbranch_execz L_ret
    v_fma_mix_f32 v214, v214, v22, v26 op_sel_hi:[1,0,0]
    v_cvt_pk_bf16_f32 v210, v210, v214
    v_mfma_f32_16x16x32_bf16 a[4:7], v[108:111], a[160:163], a[4:7]
    v_fma_mix_f32 v211, v211, v23, v27 op_sel_hi:[1,0,0]
    v_fma_mix_f32 v215, v215, v23, v27 op_sel_hi:[1,0,0]
    v_mfma_f32_16x16x32_bf16 a[8:11], v[104:107], a[164:167], a[8:11]
    ds_read_b128 a[188:191], v32 offset:44032
    v_cvt_pk_bf16_f32 v211, v211, v215
    v_mfma_f32_16x16x32_bf16 a[12:15], v[108:111], a[164:167], a[12:15]
    s_waitcnt lgkmcnt(4)
    s_waitcnt vmcnt(8)
    v_fma_mix_f32 v216, v216, v20, v24 op_sel_hi:[1,0,0]
    v_mfma_f32_16x16x32_bf16 a[16:19], v[104:107], a[168:171], a[16:19]
    ds_read_b128 a[192:195], v32 offset:49152
    v_fma_mix_f32 v220, v220, v20, v24 op_sel_hi:[1,0,0]
    v_cvt_pk_bf16_f32 v216, v216, v220
    v_mfma_f32_16x16x32_bf16 a[20:23], v[108:111], a[168:171], a[20:23]
    buffer_load_dwordx4 v[240:243], v8, s[8:11], s54 offen
    v_fma_mix_f32 v217, v217, v21, v25 op_sel_hi:[1,0,0]
    v_mfma_f32_16x16x32_bf16 a[24:27], v[104:107], a[172:175], a[24:27]
    ds_read_b128 a[196:199], v32 offset:57344
    s_add_u32 m0, s67, 49152
    s_nop 0
    buffer_load_dwordx4 v14, s[4:7], s42 offen offset:0 lds
    v_mfma_f32_16x16x32_bf16 a[28:31], v[108:111], a[172:175], a[28:31]
    s_waitcnt lgkmcnt(4)
    v_fma_mix_f32 v221, v221, v21, v25 op_sel_hi:[1,0,0]
    v_mfma_f32_16x16x32_bf16 a[32:35], v[104:107], a[176:179], a[32:35]
    ds_read_b128 a[152:155], v32 offset:50176
    v_cvt_pk_bf16_f32 v217, v217, v221
    v_mfma_f32_16x16x32_bf16 a[36:39], v[108:111], a[176:179], a[36:39]
    v_fma_mix_f32 v218, v218, v22, v26 op_sel_hi:[1,0,0]
    v_fma_mix_f32 v222, v222, v22, v26 op_sel_hi:[1,0,0]
    s_nop 0
    s_cbranch_execz L_ret
    v_mfma_f32_16x16x32_bf16 a[40:43], v[104:107], a[180:183], a[40:43]
    ds_read_b128 a[156:159], v32 offset:58368
    v_cvt_pk_bf16_f32 v218, v218, v222
    v_fma_mix_f32 v219, v219, v23, v27 op_sel_hi:[1,0,0]
    v_mfma_f32_16x16x32_bf16 a[44:47], v[108:111], a[180:183], a[44:47]
    s_waitcnt lgkmcnt(4)
    v_fma_mix_f32 v223, v223, v23, v27 op_sel_hi:[1,0,0]
    v_mfma_f32_16x16x32_bf16 a[48:51], v[104:107], a[184:187], a[48:51]
    ds_read_b128 a[160:163], v32 offset:51200
    buffer_load_dwordx4 v[244:247], v9, s[8:11], s54 offen
    v_cvt_pk_bf16_f32 v219, v219, v223
    v_mfma_f32_16x16x32_bf16 a[52:55], v[108:111], a[184:187], a[52:55]
    s_not_b64 vcc, vcc
    v_cndmask_b32_dpp v112, v194, v192, vcc row_ror:8 row_mask:0xf bank_mask:0xf
    v_mfma_f32_16x16x32_bf16 a[56:59], v[104:107], a[188:191], a[56:59]
    ds_read_b128 a[164:167], v32 offset:59392
    v_cndmask_b32_dpp v113, v202, v200, vcc row_ror:8 row_mask:0xf bank_mask:0xf
    v_mfma_f32_16x16x32_bf16 a[60:63], v[108:111], a[188:191], a[60:63]
    s_waitcnt lgkmcnt(4)
    buffer_load_dwordx4 v14, s[4:7], s43 offen offset:1024 lds
    v_cndmask_b32_dpp v114, v210, v208, vcc row_ror:8 row_mask:0xf bank_mask:0xf
    v_mfma_f32_16x16x32_bf16 a[64:67], v[104:107], a[192:195], a[64:67]
    s_barrier
    ds_read_b128 a[168:171], v29 offset:0
    v_mfma_f32_16x16x32_bf16 a[68:71], v[108:111], a[192:195], a[68:71]
    v_cndmask_b32_dpp v115, v218, v216, vcc row_ror:8 row_mask:0xf bank_mask:0xf
    v_cndmask_b32_dpp v116, v195, v193, vcc row_ror:8 row_mask:0xf bank_mask:0xf
    v_cndmask_b32_dpp v117, v203, v201, vcc row_ror:8 row_mask:0xf bank_mask:0xf
    v_mfma_f32_16x16x32_bf16 a[72:75], v[104:107], a[196:199], a[72:75]
    ds_read_b128 a[172:175], v29 offset:8192
    v_cndmask_b32_dpp v118, v211, v209, vcc row_ror:8 row_mask:0xf bank_mask:0xf
    v_mfma_f32_16x16x32_bf16 a[76:79], v[108:111], a[196:199], a[76:79]
    s_waitcnt lgkmcnt(4)
    buffer_load_dwordx4 v[248:251], v10, s[8:11], s54 offen
    s_cbranch_execz L_ret
    v_mfma_f32_16x16x32_bf16 a[80:83], v[104:107], a[152:155], a[80:83]
    ds_read_b128 a[176:179], v29 offset:1024
    v_cndmask_b32_dpp v119, v219, v217, vcc row_ror:8 row_mask:0xf bank_mask:0xf
    s_not_b64 vcc, vcc
    v_cndmask_b32_dpp v120, v192, v194, vcc row_ror:8 row_mask:0xf bank_mask:0xf
    v_mfma_f32_16x16x32_bf16 a[84:87], v[108:111], a[152:155], a[84:87]
    v_cndmask_b32_dpp v121, v200, v202, vcc row_ror:8 row_mask:0xf bank_mask:0xf
    v_cndmask_b32_dpp v122, v208, v210, vcc row_ror:8 row_mask:0xf bank_mask:0xf
    v_mfma_f32_16x16x32_bf16 a[88:91], v[104:107], a[156:159], a[88:91]
    ds_read_b128 a[180:183], v29 offset:9216
    v_cndmask_b32_dpp v123, v216, v218, vcc row_ror:8 row_mask:0xf bank_mask:0xf
    v_mfma_f32_16x16x32_bf16 a[92:95], v[108:111], a[156:159], a[92:95]
    s_waitcnt lgkmcnt(4)
    buffer_load_dwordx4 v14, s[4:7], s44 offen offset:2048 lds
    v_mfma_f32_16x16x32_bf16 a[96:99], v[104:107], a[160:163], a[96:99]
    ds_read_b128 a[184:187], v29 offset:2048
    v_cndmask_b32_dpp v124, v193, v195, vcc row_ror:8 row_mask:0xf bank_mask:0xf
    v_cndmask_b32_dpp v125, v201, v203, vcc row_ror:8 row_mask:0xf bank_mask:0xf
    v_mfma_f32_16x16x32_bf16 a[100:103], v[108:111], a[160:163], a[100:103]
    v_cndmask_b32_dpp v126, v209, v211, vcc row_ror:8 row_mask:0xf bank_mask:0xf
    v_cndmask_b32_dpp v127, v217, v219, vcc row_ror:8 row_mask:0xf bank_mask:0xf
    v_mfma_f32_16x16x32_bf16 a[104:107], v[104:107], a[164:167], a[104:107]
    ds_read_b128 a[188:191], v29 offset:10240
    buffer_load_dwordx4 v[252:255], v11, s[8:11], s54 offen
    v_mfma_f32_16x16x32_bf16 a[108:111], v[108:111], a[164:167], a[108:111]
    s_waitcnt lgkmcnt(4)
    s_waitcnt vmcnt(11)
    v_fma_mix_f32 v224, v224, v20, v24 op_sel_hi:[1,0,0]
    v_mfma_f32_16x16x32_bf16 a[0:3], v[112:115], a[168:171], a[0:3]
    ds_read_b128 a[192:195], v29 offset:3072
    v_fma_mix_f32 v228, v228, v20, v24 op_sel_hi:[1,0,0]
    v_mfma_f32_16x16x32_bf16 a[4:7], v[116:119], a[168:171], a[4:7]
    s_add_u32 m0, s67, 65536
    v_add_u32 v14, s64, v12
    s_cbranch_execz L_ret
    buffer_load_dwordx4 v14, s[4:7], s38 offen offset:0 lds
    v_mfma_f32_16x16x32_bf16 a[8:11], v[112:115], a[172:175], a[8:11]
    ds_read_b128 a[196:199], v29 offset:11264
    v_cvt_pk_bf16_f32 v224, v224, v228
    v_mfma_f32_16x16x32_bf16 a[12:15], v[116:119], a[172:175], a[12:15]
    s_waitcnt lgkmcnt(4)
    v_fma_mix_f32 v225, v225, v21, v25 op_sel_hi:[1,0,0]
    v_mfma_f32_16x16x32_bf16 a[16:19], v[112:115], a[176:179], a[16:19]
    ds_read_b128 a[152:155], v29 offset:16384
    v_fma_mix_f32 v229, v229, v21, v25 op_sel_hi:[1,0,0]
    v_mfma_f32_16x16x32_bf16 a[20:23], v[116:119], a[176:179], a[20:23]
    buffer_load_dwordx4 v[160:163], v4, s[8:11], s55 offen
    v_cvt_pk_bf16_f32 v225, v225, v229
    v_mfma_f32_16x16x32_bf16 a[24:27], v[112:115], a[180:183], a[24:27]
    ds_read_b128 a[156:159], v29 offset:24576
    v_fma_mix_f32 v226, v226, v22, v26 op_sel_hi:[1,0,0]
    v_mfma_f32_16x16x32_bf16 a[28:31], v[116:119], a[180:183], a[28:31]
    s_waitcnt lgkmcnt(4)
    v_fma_mix_f32 v230, v230, v22, v26 op_sel_hi:[1,0,0]
    v_mfma_f32_16x16x32_bf16 a[32:35], v[112:115], a[184:187], a[32:35]
    ds_read_b128 a[160:163], v29 offset:17408
    v_cvt_pk_bf16_f32 v226, v226, v230
    v_mfma_f32_16x16x32_bf16 a[36:39], v[116:119], a[184:187], a[36:39]
    v_fma_mix_f32 v227, v227, v23, v27 op_sel_hi:[1,0,0]
    v_fma_mix_f32 v231, v231, v23, v27 op_sel_hi:[1,0,0]
    v_mfma_f32_16x16x32_bf16 a[40:43], v[112:115], a[188:191], a[40:43]
    ds_read_b128 a[164:167], v29 offset:25600
    buffer_load_dwordx4 v14, s[4:7], s39 offen offset:1024 lds
    v_cvt_pk_bf16_f32 v227, v227, v231
    v_mfma_f32_16x16x32_bf16 a[44:47], v[116:119], a[188:191], a[44:47]
    s_waitcnt lgkmcnt(4)
    s_waitcnt vmcnt(11)
    v_fma_mix_f32 v232, v232, v20, v24 op_sel_hi:[1,0,0]
    s_nop 0
    s_cbranch_execz L_ret
    v_mfma_f32_16x16x32_bf16 a[48:51], v[112:115], a[192:195], a[48:51]
    ds_read_b128 a[168:171], v29 offset:18432
    buffer_load_dwordx4 v[164:167], v5, s[8:11], s55 offen
    v_mfma_f32_16x16x32_bf16 a[52:55], v[116:119], a[192:195], a[52:55]
    v_fma_mix_f32 v236, v236, v20, v24 op_sel_hi:[1,0,0]
    v_cvt_pk_bf16_f32 v232, v232, v236
    v_mfma_f32_16x16x32_bf16 a[56:59], v[112:115], a[196:199], a[56:59]
    ds_read_b128 a[172:175], v29 offset:26624
    v_fma_mix_f32 v233, v233, v21, v25 op_sel_hi:[1,0,0]
    v_mfma_f32_16x16x32_bf16 a[60:63], v[116:119], a[196:199], a[60:63]
    s_waitcnt lgkmcnt(4)
    v_fma_mix_f32 v237, v237, v21, v25 op_sel_hi:[1,0,0]
    v_mfma_f32_16x16x32_bf16 a[64:67], v[112:115], a[152:155], a[64:67]
    ds_read_b128 a[176:179], v30 offset:0
    v_cvt_pk_bf16_f32 v233, v233, v237
    v_fma_mix_f32 v234, v234, v22, v26 op_sel_hi:[1,0,0]
    v_mfma_f32_16x16x32_bf16 a[68:71], v[116:119], a[152:155], a[68:71]
    v_fma_mix_f32 v238, v238, v22, v26 op_sel_hi:[1,0,0]
    v_cvt_pk_bf16_f32 v234, v234, v238
    v_mfma_f32_16x16x32_bf16 a[72:75], v[112:115], a[156:159], a[72:75]
    ds_read_b128 a[180:183], v30 offset:8192
    buffer_load_dwordx4 v14, s[4:7], s40 offen offset:2048 lds
    v_mfma_f32_16x16x32_bf16 a[76:79], v[116:119], a[156:159], a[76:79]
    s_waitcnt lgkmcnt(4)
    v_fma_mix_f32 v235, v235, v23, v27 op_sel_hi:[1,0,0]
    buffer_load_dwordx4 v[168:171], v6, s[8:11], s55 offen
    v_mfma_f32_16x16x32_bf16 a[80:83], v[112:115], a[160:163], a[80:83]
    ds_read_b128 a[184:187], v30 offset:1024
    v_fma_mix_f32 v239, v239, v23, v27 op_sel_hi:[1,0,0]
    v_mfma_f32_16x16x32_bf16 a[84:87], v[116:119], a[160:163], a[84:87]
    v_cvt_pk_bf16_f32 v235, v235, v239
    s_waitcnt vmcnt(10)
    v_fma_mix_f32 v240, v240, v20, v24 op_sel_hi:[1,0,0]
    s_cbranch_execz L_ret
    v_mfma_f32_16x16x32_bf16 a[88:91], v[112:115], a[164:167], a[88:91]
    ds_read_b128 a[188:191], v30 offset:9216
    v_fma_mix_f32 v244, v244, v20, v24 op_sel_hi:[1,0,0]
    v_mfma_f32_16x16x32_bf16 a[92:95], v[116:119], a[164:167], a[92:95]
    s_waitcnt lgkmcnt(4)
    v_cvt_pk_bf16_f32 v240, v240, v244
    v_mfma_f32_16x16x32_bf16 a[96:99], v[112:115], a[168:171], a[96:99]
    ds_read_b128 a[192:195], v30 offset:2048
    v_fma_mix_f32 v241, v241, v21, v25 op_sel_hi:[1,0,0]
    v_fma_mix_f32 v245, v245, v21, v25 op_sel_hi:[1,0,0]
    v_mfma_f32_16x16x32_bf16 a[100:103], v[116:119], a[168:171], a[100:103]
    v_cvt_pk_bf16_f32 v241, v241, v245
    buffer_load_dwordx4 v[172:175], v7, s[8:11], s55 offen
    v_mfma_f32_16x16x32_bf16 a[104:107], v[112:115], a[172:175], a[104:107]
    ds_read_b128 a[196:199], v30 offset:10240
    v_fma_mix_f32 v242, v242, v22, v26 op_sel_hi:[1,0,0]
    v_mfma_f32_16x16x32_bf16 a[108:111], v[116:119], a[172:175], a[108:111]
    s_waitcnt lgkmcnt(4)
    buffer_load_dwordx4 v14, s[4:7], s41 offen offset:3072 lds
    v_mfma_f32_16x16x32_bf16 a[0:3], v[120:123], a[176:179], a[0:3]
    ds_read_b128 a[152:155], v30 offset:3072
    v_fma_mix_f32 v246, v246, v22, v26 op_sel_hi:[1,0,0]
    v_cvt_pk_bf16_f32 v242, v242, v246
    v_mfma_f32_16x16x32_bf16 a[4:7], v[124:127], a[176:179], a[4:7]
    v_fma_mix_f32 v243, v243, v23, v27 op_sel_hi:[1,0,0]
    v_fma_mix_f32 v247, v247, v23, v27 op_sel_hi:[1,0,0]
    v_mfma_f32_16x16x32_bf16 a[8:11], v[120:123], a[180:183], a[8:11]
    ds_read_b128 a[156:159], v30 offset:11264
    v_cvt_pk_bf16_f32 v243, v243, v247
    v_mfma_f32_16x16x32_bf16 a[12:15], v[124:127], a[180:183], a[12:15]
    s_waitcnt lgkmcnt(4)
    s_waitcnt vmcnt(8)
    v_fma_mix_f32 v248, v248, v20, v24 op_sel_hi:[1,0,0]
    s_nop 0
    s_cbranch_execz L_ret
    v_mfma_f32_16x16x32_bf16 a[16:19], v[120:123], a[184:187], a[16:19]
    ds_read_b128 a[160:163], v30 offset:16384
    v_fma_mix_f32 v252, v252, v20, v24 op_sel_hi:[1,0,0]
    v_cvt_pk_bf16_f32 v248, v248, v252
    v_mfma_f32_16x16x32_bf16 a[20:23], v[124:127], a[184:187], a[20:23]
    buffer_load_dwordx4 v[176:179], v8, s[8:11], s55 offen
    v_fma_mix_f32 v249, v249, v21, v25 op_sel_hi:[1,0,0]
    v_mfma_f32_16x16x32_bf16 a[24:27], v[120:123], a[188:191], a[24:27]
    ds_read_b128 a[164:167], v30 offset:24576
    s_add_u32 m0, s67, 81920
    s_nop 0
    buffer_load_dwordx4 v14, s[4:7], s42 offen offset:0 lds
    v_mfma_f32_16x16x32_bf16 a[28:31], v[124:127], a[188:191], a[28:31]
    s_waitcnt lgkmcnt(4)
    v_fma_mix_f32 v253, v253, v21, v25 op_sel_hi:[1,0,0]
    v_mfma_f32_16x16x32_bf16 a[32:35], v[120:123], a[192:195], a[32:35]
    ds_read_b128 a[168:171], v30 offset:17408
    v_cvt_pk_bf16_f32 v249, v249, v253
    v_mfma_f32_16x16x32_bf16 a[36:39], v[124:127], a[192:195], a[36:39]
    v_fma_mix_f32 v250, v250, v22, v26 op_sel_hi:[1,0,0]
    v_fma_mix_f32 v254, v254, v22, v26 op_sel_hi:[1,0,0]
    v_mfma_f32_16x16x32_bf16 a[40:43], v[120:123], a[196:199], a[40:43]
    ds_read_b128 a[172:175], v30 offset:25600
    v_cvt_pk_bf16_f32 v250, v250, v254
    v_fma_mix_f32 v251, v251, v23, v27 op_sel_hi:[1,0,0]
    v_mfma_f32_16x16x32_bf16 a[44:47], v[124:127], a[196:199], a[44:47]
    s_waitcnt lgkmcnt(4)
    v_fma_mix_f32 v255, v255, v23, v27 op_sel_hi:[1,0,0]
    v_mfma_f32_16x16x32_bf16 a[48:51], v[120:123], a[152:155], a[48:51]
    ds_read_b128 a[176:179], v30 offset:18432
    buffer_load_dwordx4 v[180:183], v9, s[8:11], s55 offen
    v_cvt_pk_bf16_f32 v251, v251, v255
    v_mfma_f32_16x16x32_bf16 a[52:55], v[124:127], a[152:155], a[52:55]
    s_cbranch_execz L_ret
    s_not_b64 vcc, vcc
    v_cndmask_b32_dpp v128, v226, v224, vcc row_ror:8 row_mask:0xf bank_mask:0xf
    v_mfma_f32_16x16x32_bf16 a[56:59], v[120:123], a[156:159], a[56:59]
    ds_read_b128 a[180:183], v30 offset:26624
    v_cndmask_b32_dpp v129, v234, v232, vcc row_ror:8 row_mask:0xf bank_mask:0xf
    v_mfma_f32_16x16x32_bf16 a[60:63], v[124:127], a[156:159], a[60:63]
    s_waitcnt lgkmcnt(4)
    buffer_load_dwordx4 v14, s[4:7], s43 offen offset:1024 lds
    v_cndmask_b32_dpp v130, v242, v240, vcc row_ror:8 row_mask:0xf bank_mask:0xf
    v_mfma_f32_16x16x32_bf16 a[64:67], v[120:123], a[160:163], a[64:67]
    s_barrier
    ds_read_b128 a[184:187], v29 offset:32768
    v_mfma_f32_16x16x32_bf16 a[68:71], v[124:127], a[160:163], a[68:71]
    v_cndmask_b32_dpp v131, v250, v248, vcc row_ror:8 row_mask:0xf bank_mask:0xf
    v_cndmask_b32_dpp v132, v227, v225, vcc row_ror:8 row_mask:0xf bank_mask:0xf
    v_cndmask_b32_dpp v133, v235, v233, vcc row_ror:8 row_mask:0xf bank_mask:0xf
    v_mfma_f32_16x16x32_bf16 a[72:75], v[120:123], a[164:167], a[72:75]
    ds_read_b128 a[188:191], v29 offset:40960
    v_cndmask_b32_dpp v134, v243, v241, vcc row_ror:8 row_mask:0xf bank_mask:0xf
    v_mfma_f32_16x16x32_bf16 a[76:79], v[124:127], a[164:167], a[76:79]
    s_waitcnt lgkmcnt(4)
    buffer_load_dwordx4 v[184:187], v10, s[8:11], s55 offen
    v_mfma_f32_16x16x32_bf16 a[80:83], v[120:123], a[168:171], a[80:83]
    ds_read_b128 a[192:195], v29 offset:33792
    v_cndmask_b32_dpp v135, v251, v249, vcc row_ror:8 row_mask:0xf bank_mask:0xf
    s_not_b64 vcc, vcc
    v_cndmask_b32_dpp v136, v224, v226, vcc row_ror:8 row_mask:0xf bank_mask:0xf
    v_mfma_f32_16x16x32_bf16 a[84:87], v[124:127], a[168:171], a[84:87]
    v_cndmask_b32_dpp v137, v232, v234, vcc row_ror:8 row_mask:0xf bank_mask:0xf
    v_cndmask_b32_dpp v138, v240, v242, vcc row_ror:8 row_mask:0xf bank_mask:0xf
    v_mfma_f32_16x16x32_bf16 a[88:91], v[120:123], a[172:175], a[88:91]
    ds_read_b128 a[196:199], v29 offset:41984
    v_cndmask_b32_dpp v139, v248, v250, vcc row_ror:8 row_mask:0xf bank_mask:0xf
    v_mfma_f32_16x16x32_bf16 a[92:95], v[124:127], a[172:175], a[92:95]
    s_cbranch_execz L_ret
    s_waitcnt lgkmcnt(4)
    buffer_load_dwordx4 v14, s[4:7], s44 offen offset:2048 lds
    v_mfma_f32_16x16x32_bf16 a[96:99], v[120:123], a[176:179], a[96:99]
    ds_read_b128 a[152:155], v29 offset:34816
    v_cndmask_b32_dpp v140, v225, v227, vcc row_ror:8 row_mask:0xf bank_mask:0xf
    v_cndmask_b32_dpp v141, v233, v235, vcc row_ror:8 row_mask:0xf bank_mask:0xf
    v_mfma_f32_16x16x32_bf16 a[100:103], v[124:127], a[176:179], a[100:103]
    v_cndmask_b32_dpp v142, v241, v243, vcc row_ror:8 row_mask:0xf bank_mask:0xf
    v_cndmask_b32_dpp v143, v249, v251, vcc row_ror:8 row_mask:0xf bank_mask:0xf
    v_mfma_f32_16x16x32_bf16 a[104:107], v[120:123], a[180:183], a[104:107]
    ds_read_b128 a[156:159], v29 offset:43008
    buffer_load_dwordx4 v[188:191], v11, s[8:11], s55 offen
    v_mfma_f32_16x16x32_bf16 a[108:111], v[124:127], a[180:183], a[108:111]
    s_waitcnt lgkmcnt(4)
    s_waitcnt vmcnt(11)
    v_fma_mix_f32 v160, v160, v20, v24 op_sel_hi:[1,0,0]
    v_mfma_f32_16x16x32_bf16 a[0:3], v[128:131], a[184:187], a[0:3]
    ds_read_b128 a[160:163], v29 offset:35840
    v_fma_mix_f32 v164, v164, v20, v24 op_sel_hi:[1,0,0]
    v_mfma_f32_16x16x32_bf16 a[4:7], v[132:135], a[184:187], a[4:7]
    s_add_u32 m0, s67, 98304
    v_add_u32 v14, s65, v12
    buffer_load_dwordx4 v14, s[4:7], s38 offen offset:0 lds
    v_mfma_f32_16x16x32_bf16 a[8:11], v[128:131], a[188:191], a[8:11]
    ds_read_b128 a[164:167], v29 offset:44032
    v_cvt_pk_bf16_f32 v160, v160, v164
    v_mfma_f32_16x16x32_bf16 a[12:15], v[132:135], a[188:191], a[12:15]
    s_waitcnt lgkmcnt(4)
    v_fma_mix_f32 v161, v161, v21, v25 op_sel_hi:[1,0,0]
    v_mfma_f32_16x16x32_bf16 a[16:19], v[128:131], a[192:195], a[16:19]
    ds_read_b128 a[168:171], v29 offset:49152
    v_fma_mix_f32 v165, v165, v21, v25 op_sel_hi:[1,0,0]
    v_mfma_f32_16x16x32_bf16 a[20:23], v[132:135], a[192:195], a[20:23]
    buffer_load_dwordx4 v[192:195], v4, s[8:11], s56 offen
    s_cbranch_execz L_ret
    v_cvt_pk_bf16_f32 v161, v161, v165
    v_mfma_f32_16x16x32_bf16 a[24:27], v[128:131], a[196:199], a[24:27]
    ds_read_b128 a[172:175], v29 offset:57344
    v_fma_mix_f32 v162, v162, v22, v26 op_sel_hi:[1,0,0]
    v_mfma_f32_16x16x32_bf16 a[28:31], v[132:135], a[196:199], a[28:31]
    s_waitcnt lgkmcnt(4)
    v_fma_mix_f32 v166, v166, v22, v26 op_sel_hi:[1,0,0]
    v_mfma_f32_16x16x32_bf16 a[32:35], v[128:131], a[152:155], a[32:35]
    ds_read_b128 a[176:179], v29 offset:50176
    v_cvt_pk_bf16_f32 v162, v162, v166
    v_mfma_f32_16x16x32_bf16 a[36:39], v[132:135], a[152:155], a[36:39]
    v_fma_mix_f32 v163, v163, v23, v27 op_sel_hi:[1,0,0]
    v_fma_mix_f32 v167, v167, v23, v27 op_sel_hi:[1,0,0]
    v_mfma_f32_16x16x32_bf16 a[40:43], v[128:131], a[156:159], a[40:43]
    ds_read_b128 a[180:183], v29 offset:58368
    buffer_load_dwordx4 v14, s[4:7], s39 offen offset:1024 lds
    v_cvt_pk_bf16_f32 v163, v163, v167
    v_mfma_f32_16x16x32_bf16 a[44:47], v[132:135], a[156:159], a[44:47]
    s_waitcnt lgkmcnt(4)
    s_waitcnt vmcnt(11)
    v_fma_mix_f32 v168, v168, v20, v24 op_sel_hi:[1,0,0]
    v_mfma_f32_16x16x32_bf16 a[48:51], v[128:131], a[160:163], a[48:51]
    ds_read_b128 a[184:187], v29 offset:51200
    buffer_load_dwordx4 v[196:199], v5, s[8:11], s56 offen
    v_mfma_f32_16x16x32_bf16 a[52:55], v[132:135], a[160:163], a[52:55]
    v_fma_mix_f32 v172, v172, v20, v24 op_sel_hi:[1,0,0]
    v_cvt_pk_bf16_f32 v168, v168, v172
    v_mfma_f32_16x16x32_bf16 a[56:59], v[128:131], a[164:167], a[56:59]
    ds_read_b128 a[188:191], v29 offset:59392
    v_fma_mix_f32 v169, v169, v21, v25 op_sel_hi:[1,0,0]
    v_mfma_f32_16x16x32_bf16 a[60:63], v[132:135], a[164:167], a[60:63]
    s_waitcnt lgkmcnt(4)
    v_fma_mix_f32 v173, v173, v21, v25 op_sel_hi:[1,0,0]
    s_nop 0
    s_cbranch_execz L_ret
    v_mfma_f32_16x16x32_bf16 a[64:67], v[128:131], a[168:171], a[64:67]
    ds_read_b128 a[192:195], v30 offset:32768
    v_cvt_pk_bf16_f32 v169, v169, v173
    v_fma_mix_f32 v170, v170, v22, v26 op_sel_hi:[1,0,0]
    v_mfma_f32_16x16x32_bf16 a[68:71], v[132:135], a[168:171], a[68:71]
    v_fma_mix_f32 v174, v174, v22, v26 op_sel_hi:[1,0,0]
    v_cvt_pk_bf16_f32 v170, v170, v174
    v_mfma_f32_16x16x32_bf16 a[72:75], v[128:131], a[172:175], a[72:75]
    ds_read_b128 a[196:199], v30 offset:40960
    buffer_load_dwordx4 v14, s[4:7], s40 offen offset:2048 lds
    v_mfma_f32_16x16x32_bf16 a[76:79], v[132:135], a[172:175], a[76:79]
    s_waitcnt lgkmcnt(4)
    v_fma_mix_f32 v171, v171, v23, v27 op_sel_hi:[1,0,0]
    buffer_load_dwordx4 v[200:203], v6, s[8:11], s56 offen
    v_mfma_f32_16x16x32_bf16 a[80:83], v[128:131], a[176:179], a[80:83]
    ds_read_b128 a[152:155], v30 offset:33792
    v_fma_mix_f32 v175, v175, v23, v27 op_sel_hi:[1,0,0]
    v_mfma_f32_16x16x32_bf16 a[84:87], v[132:135], a[176:179], a[84:87]
    v_cvt_pk_bf16_f32 v171, v171, v175
    s_waitcnt vmcnt(10)
    v_fma_mix_f32 v176, v176, v20, v24 op_sel_hi:[1,0,0]
    v_mfma_f32_16x16x32_bf16 a[88:91], v[128:131], a[180:183], a[88:91]
    ds_read_b128 a[156:159], v30 offset:41984
    v_fma_mix_f32 v180, v180, v20, v24 op_sel_hi:[1,0,0]
    v_mfma_f32_16x16x32_bf16 a[92:95], v[132:135], a[180:183], a[92:95]
    s_waitcnt lgkmcnt(4)
    v_cvt_pk_bf16_f32 v176, v176, v180
    v_mfma_f32_16x16x32_bf16 a[96:99], v[128:131], a[184:187], a[96:99]
    ds_read_b128 a[160:163], v30 offset:34816
    v_fma_mix_f32 v177, v177, v21, v25 op_sel_hi:[1,0,0]
    v_fma_mix_f32 v181, v181, v21, v25 op_sel_hi:[1,0,0]
    v_mfma_f32_16x16x32_bf16 a[100:103], v[132:135], a[184:187], a[100:103]
    v_cvt_pk_bf16_f32 v177, v177, v181
    s_cbranch_execz L_ret
    buffer_load_dwordx4 v[204:207], v7, s[8:11], s56 offen
    v_mfma_f32_16x16x32_bf16 a[104:107], v[128:131], a[188:191], a[104:107]
    ds_read_b128 a[164:167], v30 offset:43008
    v_fma_mix_f32 v178, v178, v22, v26 op_sel_hi:[1,0,0]
    v_mfma_f32_16x16x32_bf16 a[108:111], v[132:135], a[188:191], a[108:111]
    s_waitcnt lgkmcnt(4)
    buffer_load_dwordx4 v14, s[4:7], s41 offen offset:3072 lds
    v_mfma_f32_16x16x32_bf16 a[0:3], v[136:139], a[192:195], a[0:3]
    ds_read_b128 a[168:171], v30 offset:35840
    v_fma_mix_f32 v182, v182, v22, v26 op_sel_hi:[1,0,0]
    v_cvt_pk_bf16_f32 v178, v178, v182
    v_mfma_f32_16x16x32_bf16 a[4:7], v[140:143], a[192:195], a[4:7]
    v_fma_mix_f32 v179, v179, v23, v27 op_sel_hi:[1,0,0]
    v_fma_mix_f32 v183, v183, v23, v27 op_sel_hi:[1,0,0]
    v_mfma_f32_16x16x32_bf16 a[8:11], v[136:139], a[196:199], a[8:11]
    ds_read_b128 a[172:175], v30 offset:44032
    v_cvt_pk_bf16_f32 v179, v179, v183
    v_mfma_f32_16x16x32_bf16 a[12:15], v[140:143], a[196:199], a[12:15]
    s_waitcnt lgkmcnt(4)
    s_waitcnt vmcnt(8)
    v_fma_mix_f32 v184, v184, v20, v24 op_sel_hi:[1,0,0]
    v_mfma_f32_16x16x32_bf16 a[16:19], v[136:139], a[152:155], a[16:19]
    ds_read_b128 a[176:179], v30 offset:49152
    v_fma_mix_f32 v188, v188, v20, v24 op_sel_hi:[1,0,0]
    v_cvt_pk_bf16_f32 v184, v184, v188
    v_mfma_f32_16x16x32_bf16 a[20:23], v[140:143], a[152:155], a[20:23]
    buffer_load_dwordx4 v[208:211], v8, s[8:11], s56 offen
    v_fma_mix_f32 v185, v185, v21, v25 op_sel_hi:[1,0,0]
    v_mfma_f32_16x16x32_bf16 a[24:27], v[136:139], a[156:159], a[24:27]
    ds_read_b128 a[180:183], v30 offset:57344
    s_add_u32 m0, s67, 114688
    s_nop 0
    buffer_load_dwordx4 v14, s[4:7], s42 offen offset:0 lds
    s_nop 0
    s_cbranch_execz L_ret
    v_mfma_f32_16x16x32_bf16 a[28:31], v[140:143], a[156:159], a[28:31]
    s_waitcnt lgkmcnt(4)
    v_fma_mix_f32 v189, v189, v21, v25 op_sel_hi:[1,0,0]
    v_mfma_f32_16x16x32_bf16 a[32:35], v[136:139], a[160:163], a[32:35]
    ds_read_b128 a[184:187], v30 offset:50176
    v_cvt_pk_bf16_f32 v185, v185, v189
    v_mfma_f32_16x16x32_bf16 a[36:39], v[140:143], a[160:163], a[36:39]
    v_fma_mix_f32 v186, v186, v22, v26 op_sel_hi:[1,0,0]
    v_fma_mix_f32 v190, v190, v22, v26 op_sel_hi:[1,0,0]
    v_mfma_f32_16x16x32_bf16 a[40:43], v[136:139], a[164:167], a[40:43]
    ds_read_b128 a[188:191], v30 offset:58368
    v_cvt_pk_bf16_f32 v186, v186, v190
    v_fma_mix_f32 v187, v187, v23, v27 op_sel_hi:[1,0,0]
    v_mfma_f32_16x16x32_bf16 a[44:47], v[140:143], a[164:167], a[44:47]
    s_waitcnt lgkmcnt(4)
    v_fma_mix_f32 v191, v191, v23, v27 op_sel_hi:[1,0,0]
    v_mfma_f32_16x16x32_bf16 a[48:51], v[136:139], a[168:171], a[48:51]
    ds_read_b128 a[192:195], v30 offset:51200
    buffer_load_dwordx4 v[212:215], v9, s[8:11], s56 offen
    v_cvt_pk_bf16_f32 v187, v187, v191
    v_mfma_f32_16x16x32_bf16 a[52:55], v[140:143], a[168:171], a[52:55]
    s_not_b64 vcc, vcc
    v_cndmask_b32_dpp v144, v162, v160, vcc row_ror:8 row_mask:0xf bank_mask:0xf
    v_mfma_f32_16x16x32_bf16 a[56:59], v[136:139], a[172:175], a[56:59]
    ds_read_b128 a[196:199], v30 offset:59392
    v_cndmask_b32_dpp v145, v170, v168, vcc row_ror:8 row_mask:0xf bank_mask:0xf
    v_mfma_f32_16x16x32_bf16 a[60:63], v[140:143], a[172:175], a[60:63]
    s_waitcnt lgkmcnt(4)
    buffer_load_dwordx4 v14, s[4:7], s43 offen offset:1024 lds
    v_cndmask_b32_dpp v146, v178, v176, vcc row_ror:8 row_mask:0xf bank_mask:0xf
    v_mfma_f32_16x16x32_bf16 a[64:67], v[136:139], a[176:179], a[64:67]
    s_barrier
    ds_read_b128 a[152:155], v31 offset:0
    v_mfma_f32_16x16x32_bf16 a[68:71], v[140:143], a[176:179], a[68:71]
    s_cbranch_execz L_ret
    v_cndmask_b32_dpp v147, v186, v184, vcc row_ror:8 row_mask:0xf bank_mask:0xf
    v_cndmask_b32_dpp v148, v163, v161, vcc row_ror:8 row_mask:0xf bank_mask:0xf
    v_cndmask_b32_dpp v149, v171, v169, vcc row_ror:8 row_mask:0xf bank_mask:0xf
    v_mfma_f32_16x16x32_bf16 a[72:75], v[136:139], a[180:183], a[72:75]
    ds_read_b128 a[156:159], v31 offset:8192
    v_cndmask_b32_dpp v150, v179, v177, vcc row_ror:8 row_mask:0xf bank_mask:0xf
    v_mfma_f32_16x16x32_bf16 a[76:79], v[140:143], a[180:183], a[76:79]
    s_waitcnt lgkmcnt(4)
    buffer_load_dwordx4 v[216:219], v10, s[8:11], s56 offen
    v_mfma_f32_16x16x32_bf16 a[80:83], v[136:139], a[184:187], a[80:83]
    ds_read_b128 a[160:163], v31 offset:1024
    v_cndmask_b32_dpp v151, v187, v185, vcc row_ror:8 row_mask:0xf bank_mask:0xf
    s_not_b64 vcc, vcc
    v_cndmask_b32_dpp v152, v160, v162, vcc row_ror:8 row_mask:0xf bank_mask:0xf
    v_mfma_f32_16x16x32_bf16 a[84:87], v[140:143], a[184:187], a[84:87]
    v_cndmask_b32_dpp v153, v168, v170, vcc row_ror:8 row_mask:0xf bank_mask:0xf
    v_cndmask_b32_dpp v154, v176, v178, vcc row_ror:8 row_mask:0xf bank_mask:0xf
    v_mfma_f32_16x16x32_bf16 a[88:91], v[136:139], a[188:191], a[88:91]
    ds_read_b128 a[164:167], v31 offset:9216
    v_cndmask_b32_dpp v155, v184, v186, vcc row_ror:8 row_mask:0xf bank_mask:0xf
    v_mfma_f32_16x16x32_bf16 a[92:95], v[140:143], a[188:191], a[92:95]
    s_waitcnt lgkmcnt(4)
    buffer_load_dwordx4 v14, s[4:7], s44 offen offset:2048 lds
    v_mfma_f32_16x16x32_bf16 a[96:99], v[136:139], a[192:195], a[96:99]
    ds_read_b128 a[168:171], v31 offset:2048
    v_cndmask_b32_dpp v156, v161, v163, vcc row_ror:8 row_mask:0xf bank_mask:0xf
    v_cndmask_b32_dpp v157, v169, v171, vcc row_ror:8 row_mask:0xf bank_mask:0xf
    v_mfma_f32_16x16x32_bf16 a[100:103], v[140:143], a[192:195], a[100:103]
    v_cndmask_b32_dpp v158, v177, v179, vcc row_ror:8 row_mask:0xf bank_mask:0xf
    v_cndmask_b32_dpp v159, v185, v187, vcc row_ror:8 row_mask:0xf bank_mask:0xf
    v_mfma_f32_16x16x32_bf16 a[104:107], v[136:139], a[196:199], a[104:107]
    ds_read_b128 a[172:175], v31 offset:10240
    buffer_load_dwordx4 v[220:223], v11, s[8:11], s56 offen
    s_cbranch_execz L_ret
    v_mfma_f32_16x16x32_bf16 a[108:111], v[140:143], a[196:199], a[108:111]
    s_waitcnt lgkmcnt(4)
    s_waitcnt vmcnt(11)
    v_fma_mix_f32 v192, v192, v20, v24 op_sel_hi:[1,0,0]
    v_mfma_f32_16x16x32_bf16 a[0:3], v[144:147], a[152:155], a[0:3]
    ds_read_b128 a[176:179], v31 offset:3072
    v_fma_mix_f32 v196, v196, v20, v24 op_sel_hi:[1,0,0]
    v_mfma_f32_16x16x32_bf16 a[4:7], v[148:151], a[152:155], a[4:7]
    s_add_u32 m0, s67, 0
    v_add_u32 v14, s66, v12
    buffer_load_dwordx4 v14, s[4:7], s38 offen offset:0 lds
    v_mfma_f32_16x16x32_bf16 a[8:11], v[144:147], a[156:159], a[8:11]
    ds_read_b128 a[180:183], v31 offset:11264
    v_cvt_pk_bf16_f32 v192, v192, v196
    v_mfma_f32_16x16x32_bf16 a[12:15], v[148:151], a[156:159], a[12:15]
    s_waitcnt lgkmcnt(4)
    v_fma_mix_f32 v193, v193, v21, v25 op_sel_hi:[1,0,0]
    v_mfma_f32_16x16x32_bf16 a[16:19], v[144:147], a[160:163], a[16:19]
    ds_read_b128 a[184:187], v31 offset:16384
    v_fma_mix_f32 v197, v197, v21, v25 op_sel_hi:[1,0,0]
    v_mfma_f32_16x16x32_bf16 a[20:23], v[148:151], a[160:163], a[20:23]
    buffer_load_dwordx4 v[224:227], v4, s[8:11], s57 offen
    v_cvt_pk_bf16_f32 v193, v193, v197
    v_mfma_f32_16x16x32_bf16 a[24:27], v[144:147], a[164:167], a[24:27]
    ds_read_b128 a[188:191], v31 offset:24576
    v_fma_mix_f32 v194, v194, v22, v26 op_sel_hi:[1,0,0]
    v_mfma_f32_16x16x32_bf16 a[28:31], v[148:151], a[164:167], a[28:31]
    s_waitcnt lgkmcnt(4)
    v_fma_mix_f32 v198, v198, v22, v26 op_sel_hi:[1,0,0]
    v_mfma_f32_16x16x32_bf16 a[32:35], v[144:147], a[168:171], a[32:35]
    ds_read_b128 a[192:195], v31 offset:17408
    v_cvt_pk_bf16_f32 v194, v194, v198
    v_mfma_f32_16x16x32_bf16 a[36:39], v[148:151], a[168:171], a[36:39]
    v_fma_mix_f32 v195, v195, v23, v27 op_sel_hi:[1,0,0]
    s_nop 0
    s_cbranch_execz L_ret
    v_fma_mix_f32 v199, v199, v23, v27 op_sel_hi:[1,0,0]
    v_mfma_f32_16x16x32_bf16 a[40:43], v[144:147], a[172:175], a[40:43]
    ds_read_b128 a[196:199], v31 offset:25600
    buffer_load_dwordx4 v14, s[4:7], s39 offen offset:1024 lds
    v_cvt_pk_bf16_f32 v195, v195, v199
    v_mfma_f32_16x16x32_bf16 a[44:47], v[148:151], a[172:175], a[44:47]
    s_waitcnt lgkmcnt(4)
    s_waitcnt vmcnt(11)
    v_fma_mix_f32 v200, v200, v20, v24 op_sel_hi:[1,0,0]
    v_mfma_f32_16x16x32_bf16 a[48:51], v[144:147], a[176:179], a[48:51]
    ds_read_b128 a[152:155], v31 offset:18432
    buffer_load_dwordx4 v[228:231], v5, s[8:11], s57 offen
    v_mfma_f32_16x16x32_bf16 a[52:55], v[148:151], a[176:179], a[52:55]
    v_fma_mix_f32 v204, v204, v20, v24 op_sel_hi:[1,0,0]
    v_cvt_pk_bf16_f32 v200, v200, v204
    v_mfma_f32_16x16x32_bf16 a[56:59], v[144:147], a[180:183], a[56:59]
    ds_read_b128 a[156:159], v31 offset:26624
    v_fma_mix_f32 v201, v201, v21, v25 op_sel_hi:[1,0,0]
    v_mfma_f32_16x16x32_bf16 a[60:63], v[148:151], a[180:183], a[60:63]
    s_waitcnt lgkmcnt(4)
    v_fma_mix_f32 v205, v205, v21, v25 op_sel_hi:[1,0,0]
    v_mfma_f32_16x16x32_bf16 a[64:67], v[144:147], a[184:187], a[64:67]
    ds_read_b128 a[160:163], v32 offset:0
    v_cvt_pk_bf16_f32 v201, v201, v205
    v_fma_mix_f32 v202, v202, v22, v26 op_sel_hi:[1,0,0]
    v_mfma_f32_16x16x32_bf16 a[68:71], v[148:151], a[184:187], a[68:71]
    v_fma_mix_f32 v206, v206, v22, v26 op_sel_hi:[1,0,0]
    v_cvt_pk_bf16_f32 v202, v202, v206
    v_mfma_f32_16x16x32_bf16 a[72:75], v[144:147], a[188:191], a[72:75]
    ds_read_b128 a[164:167], v32 offset:8192
    buffer_load_dwordx4 v14, s[4:7], s40 offen offset:2048 lds
    v_mfma_f32_16x16x32_bf16 a[76:79], v[148:151], a[188:191], a[76:79]
    s_waitcnt lgkmcnt(4)
    s_nop 0
    s_cbranch_execz L_ret
    v_fma_mix_f32 v203, v203, v23, v27 op_sel_hi:[1,0,0]
    buffer_load_dwordx4 v[232:235], v6, s[8:11], s57 offen
    v_mfma_f32_16x16x32_bf16 a[80:83], v[144:147], a[192:195], a[80:83]
    ds_read_b128 a[168:171], v32 offset:1024
    v_fma_mix_f32 v207, v207, v23, v27 op_sel_hi:[1,0,0]
    v_mfma_f32_16x16x32_bf16 a[84:87], v[148:151], a[192:195], a[84:87]
    v_cvt_pk_bf16_f32 v203, v203, v207
    s_waitcnt vmcnt(10)
    v_fma_mix_f32 v208, v208, v20, v24 op_sel_hi:[1,0,0]
    v_mfma_f32_16x16x32_bf16 a[88:91], v[144:147], a[196:199], a[88:91]
    ds_read_b128 a[172:175], v32 offset:9216
    v_fma_mix_f32 v212, v212, v20, v24 op_sel_hi:[1,0,0]
    v_mfma_f32_16x16x32_bf16 a[92:95], v[148:151], a[196:199], a[92:95]
    s_waitcnt lgkmcnt(4)
    v_cvt_pk_bf16_f32 v208, v208, v212
    v_mfma_f32_16x16x32_bf16 a[96:99], v[144:147], a[152:155], a[96:99]
    ds_read_b128 a[176:179], v32 offset:2048
    v_fma_mix_f32 v209, v209, v21, v25 op_sel_hi:[1,0,0]
    v_fma_mix_f32 v213, v213, v21, v25 op_sel_hi:[1,0,0]
    v_mfma_f32_16x16x32_bf16 a[100:103], v[148:151], a[152:155], a[100:103]
    v_cvt_pk_bf16_f32 v209, v209, v213
    buffer_load_dwordx4 v[236:239], v7, s[8:11], s57 offen
    v_mfma_f32_16x16x32_bf16 a[104:107], v[144:147], a[156:159], a[104:107]
    ds_read_b128 a[180:183], v32 offset:10240
    v_fma_mix_f32 v210, v210, v22, v26 op_sel_hi:[1,0,0]
    v_mfma_f32_16x16x32_bf16 a[108:111], v[148:151], a[156:159], a[108:111]
    s_waitcnt lgkmcnt(4)
    buffer_load_dwordx4 v14, s[4:7], s41 offen offset:3072 lds
    v_mfma_f32_16x16x32_bf16 a[0:3], v[152:155], a[160:163], a[0:3]
    ds_read_b128 a[184:187], v32 offset:3072
    v_fma_mix_f32 v214, v214, v22, v26 op_sel_hi:[1,0,0]
    v_cvt_pk_bf16_f32 v210, v210, v214
    v_mfma_f32_16x16x32_bf16 a[4:7], v[156:159], a[160:163], a[4:7]
    s_cbranch_execz L_ret
    v_fma_mix_f32 v211, v211, v23, v27 op_sel_hi:[1,0,0]
    v_fma_mix_f32 v215, v215, v23, v27 op_sel_hi:[1,0,0]
    v_mfma_f32_16x16x32_bf16 a[8:11], v[152:155], a[164:167], a[8:11]
    ds_read_b128 a[188:191], v32 offset:11264
    v_cvt_pk_bf16_f32 v211, v211, v215
    v_mfma_f32_16x16x32_bf16 a[12:15], v[156:159], a[164:167], a[12:15]
    s_waitcnt lgkmcnt(4)
    s_waitcnt vmcnt(8)
    v_fma_mix_f32 v216, v216, v20, v24 op_sel_hi:[1,0,0]
    v_mfma_f32_16x16x32_bf16 a[16:19], v[152:155], a[168:171], a[16:19]
    ds_read_b128 a[192:195], v32 offset:16384
    v_fma_mix_f32 v220, v220, v20, v24 op_sel_hi:[1,0,0]
    v_cvt_pk_bf16_f32 v216, v216, v220
    v_mfma_f32_16x16x32_bf16 a[20:23], v[156:159], a[168:171], a[20:23]
    buffer_load_dwordx4 v[240:243], v8, s[8:11], s57 offen
    v_fma_mix_f32 v217, v217, v21, v25 op_sel_hi:[1,0,0]
    v_mfma_f32_16x16x32_bf16 a[24:27], v[152:155], a[172:175], a[24:27]
    ds_read_b128 a[196:199], v32 offset:24576
    s_add_u32 m0, s67, 16384
    s_nop 0
    buffer_load_dwordx4 v14, s[4:7], s42 offen offset:0 lds
    v_mfma_f32_16x16x32_bf16 a[28:31], v[156:159], a[172:175], a[28:31]
    s_waitcnt lgkmcnt(4)
    v_fma_mix_f32 v221, v221, v21, v25 op_sel_hi:[1,0,0]
    v_mfma_f32_16x16x32_bf16 a[32:35], v[152:155], a[176:179], a[32:35]
    ds_read_b128 a[152:155], v32 offset:17408
    v_cvt_pk_bf16_f32 v217, v217, v221
    v_mfma_f32_16x16x32_bf16 a[36:39], v[156:159], a[176:179], a[36:39]
    v_fma_mix_f32 v218, v218, v22, v26 op_sel_hi:[1,0,0]
    v_fma_mix_f32 v222, v222, v22, v26 op_sel_hi:[1,0,0]
    v_mfma_f32_16x16x32_bf16 a[40:43], v[152:155], a[180:183], a[40:43]
    ds_read_b128 a[156:159], v32 offset:25600
    v_cvt_pk_bf16_f32 v218, v218, v222
    s_nop 0
    s_cbranch_execz L_ret
    v_fma_mix_f32 v219, v219, v23, v27 op_sel_hi:[1,0,0]
    v_mfma_f32_16x16x32_bf16 a[44:47], v[156:159], a[180:183], a[44:47]
    s_waitcnt lgkmcnt(4)
    v_fma_mix_f32 v223, v223, v23, v27 op_sel_hi:[1,0,0]
    v_mfma_f32_16x16x32_bf16 a[48:51], v[152:155], a[184:187], a[48:51]
    ds_read_b128 a[160:163], v32 offset:18432
    buffer_load_dwordx4 v[244:247], v9, s[8:11], s57 offen
    v_cvt_pk_bf16_f32 v219, v219, v223
    v_mfma_f32_16x16x32_bf16 a[52:55], v[156:159], a[184:187], a[52:55]
    s_not_b64 vcc, vcc
    v_cndmask_b32_dpp v160, v194, v192, vcc row_ror:8 row_mask:0xf bank_mask:0xf
    v_mfma_f32_16x16x32_bf16 a[56:59], v[152:155], a[188:191], a[56:59]
    ds_read_b128 a[164:167], v32 offset:26624
    v_cndmask_b32_dpp v161, v202, v200, vcc row_ror:8 row_mask:0xf bank_mask:0xf
    v_mfma_f32_16x16x32_bf16 a[60:63], v[156:159], a[188:191], a[60:63]
    s_waitcnt lgkmcnt(4)
    buffer_load_dwordx4 v14, s[4:7], s43 offen offset:1024 lds
    v_cndmask_b32_dpp v162, v210, v208, vcc row_ror:8 row_mask:0xf bank_mask:0xf
    v_mfma_f32_16x16x32_bf16 a[64:67], v[152:155], a[192:195], a[64:67]
    s_barrier
    ds_read_b128 a[168:171], v31 offset:32768
    v_mfma_f32_16x16x32_bf16 a[68:71], v[156:159], a[192:195], a[68:71]
    v_cndmask_b32_dpp v163, v218, v216, vcc row_ror:8 row_mask:0xf bank_mask:0xf
    v_cndmask_b32_dpp v164, v195, v193, vcc row_ror:8 row_mask:0xf bank_mask:0xf
    v_cndmask_b32_dpp v165, v203, v201, vcc row_ror:8 row_mask:0xf bank_mask:0xf
    v_mfma_f32_16x16x32_bf16 a[72:75], v[152:155], a[196:199], a[72:75]
    ds_read_b128 a[172:175], v31 offset:40960
    v_cndmask_b32_dpp v166, v211, v209, vcc row_ror:8 row_mask:0xf bank_mask:0xf
    v_mfma_f32_16x16x32_bf16 a[76:79], v[156:159], a[196:199], a[76:79]
    s_waitcnt lgkmcnt(4)
    buffer_load_dwordx4 v[248:251], v10, s[8:11], s57 offen
    v_mfma_f32_16x16x32_bf16 a[80:83], v[152:155], a[152:155], a[80:83]
    ds_read_b128 a[176:179], v31 offset:33792
    v_cndmask_b32_dpp v167, v219, v217, vcc row_ror:8 row_mask:0xf bank_mask:0xf
    s_cbranch_execz L_ret
    s_not_b64 vcc, vcc
    v_cndmask_b32_dpp v168, v192, v194, vcc row_ror:8 row_mask:0xf bank_mask:0xf
    v_mfma_f32_16x16x32_bf16 a[84:87], v[156:159], a[152:155], a[84:87]
    v_cndmask_b32_dpp v169, v200, v202, vcc row_ror:8 row_mask:0xf bank_mask:0xf
    v_cndmask_b32_dpp v170, v208, v210, vcc row_ror:8 row_mask:0xf bank_mask:0xf
    v_mfma_f32_16x16x32_bf16 a[88:91], v[152:155], a[156:159], a[88:91]
    ds_read_b128 a[180:183], v31 offset:41984
    v_cndmask_b32_dpp v171, v216, v218, vcc row_ror:8 row_mask:0xf bank_mask:0xf
    v_mfma_f32_16x16x32_bf16 a[92:95], v[156:159], a[156:159], a[92:95]
    s_waitcnt lgkmcnt(4)
    buffer_load_dwordx4 v14, s[4:7], s44 offen offset:2048 lds
    v_mfma_f32_16x16x32_bf16 a[96:99], v[152:155], a[160:163], a[96:99]
    ds_read_b128 a[184:187], v31 offset:34816
    v_cndmask_b32_dpp v172, v193, v195, vcc row_ror:8 row_mask:0xf bank_mask:0xf
    v_cndmask_b32_dpp v173, v201, v203, vcc row_ror:8 row_mask:0xf bank_mask:0xf
    v_mfma_f32_16x16x32_bf16 a[100:103], v[156:159], a[160:163], a[100:103]
    v_cndmask_b32_dpp v174, v209, v211, vcc row_ror:8 row_mask:0xf bank_mask:0xf
    v_cndmask_b32_dpp v175, v217, v219, vcc row_ror:8 row_mask:0xf bank_mask:0xf
    v_mfma_f32_16x16x32_bf16 a[104:107], v[152:155], a[164:167], a[104:107]
    ds_read_b128 a[188:191], v31 offset:43008
    buffer_load_dwordx4 v[252:255], v11, s[8:11], s57 offen
    v_mfma_f32_16x16x32_bf16 a[108:111], v[156:159], a[164:167], a[108:111]
    s_waitcnt lgkmcnt(4)
    s_waitcnt vmcnt(11)
    v_fma_mix_f32 v224, v224, v20, v24 op_sel_hi:[1,0,0]
    v_mfma_f32_16x16x32_bf16 a[0:3], v[160:163], a[168:171], a[0:3]
    ds_read_b128 a[192:195], v31 offset:35840
    v_fma_mix_f32 v228, v228, v20, v24 op_sel_hi:[1,0,0]
    v_mfma_f32_16x16x32_bf16 a[4:7], v[164:167], a[168:171], a[4:7]
    v_cvt_pk_bf16_f32 v224, v224, v228
    v_fma_mix_f32 v225, v225, v21, v25 op_sel_hi:[1,0,0]
    v_mfma_f32_16x16x32_bf16 a[8:11], v[160:163], a[172:175], a[8:11]
    ds_read_b128 a[196:199], v31 offset:44032
    s_nop 0
    s_cbranch_execz L_ret
    v_add_u32 v16, 258048, v12
    v_add_u32 v17, 257024, v12
    v_add_u32 v18, 256000, v12
    v_add_u32 v19, 254976, v12
    buffer_load_dwordx4 v19, s[4:7], s58 offen offset:3072 lds
    v_mfma_f32_16x16x32_bf16 a[12:15], v[164:167], a[172:175], a[12:15]
    s_waitcnt lgkmcnt(4)
    v_fma_mix_f32 v229, v229, v21, v25 op_sel_hi:[1,0,0]
    v_mfma_f32_16x16x32_bf16 a[16:19], v[160:163], a[176:179], a[16:19]
    ds_read_b128 a[152:155], v31 offset:49152
    v_cvt_pk_bf16_f32 v225, v225, v229
    v_mfma_f32_16x16x32_bf16 a[20:23], v[164:167], a[176:179], a[20:23]
    v_fma_mix_f32 v226, v226, v22, v26 op_sel_hi:[1,0,0]
    v_fma_mix_f32 v230, v230, v22, v26 op_sel_hi:[1,0,0]
    v_mfma_f32_16x16x32_bf16 a[24:27], v[160:163], a[180:183], a[24:27]
    ds_read_b128 a[156:159], v31 offset:57344
    v_cvt_pk_bf16_f32 v226, v226, v230
    v_mfma_f32_16x16x32_bf16 a[28:31], v[164:167], a[180:183], a[28:31]
    s_waitcnt lgkmcnt(4)
    v_fma_mix_f32 v227, v227, v23, v27 op_sel_hi:[1,0,0]
    v_mfma_f32_16x16x32_bf16 a[32:35], v[160:163], a[184:187], a[32:35]
    ds_read_b128 a[160:163], v31 offset:50176
    v_fma_mix_f32 v231, v231, v23, v27 op_sel_hi:[1,0,0]
    v_mfma_f32_16x16x32_bf16 a[36:39], v[164:167], a[184:187], a[36:39]
    v_cvt_pk_bf16_f32 v227, v227, v231
    s_waitcnt vmcnt(9)
    v_fma_mix_f32 v232, v232, v20, v24 op_sel_hi:[1,0,0]
    v_mfma_f32_16x16x32_bf16 a[40:43], v[160:163], a[188:191], a[40:43]
    ds_read_b128 a[164:167], v31 offset:58368
    v_fma_mix_f32 v236, v236, v20, v24 op_sel_hi:[1,0,0]
    v_mfma_f32_16x16x32_bf16 a[44:47], v[164:167], a[188:191], a[44:47]
    s_waitcnt lgkmcnt(4)
    v_cvt_pk_bf16_f32 v232, v232, v236
    s_nop 0
    s_cbranch_execz L_ret
    v_mfma_f32_16x16x32_bf16 a[48:51], v[160:163], a[192:195], a[48:51]
    ds_read_b128 a[168:171], v31 offset:51200
    v_fma_mix_f32 v233, v233, v21, v25 op_sel_hi:[1,0,0]
    v_mfma_f32_16x16x32_bf16 a[52:55], v[164:167], a[192:195], a[52:55]
    v_fma_mix_f32 v237, v237, v21, v25 op_sel_hi:[1,0,0]
    s_add_u32 m0, s67, 49152
    s_nop 0
    buffer_load_dwordx4 v19, s[4:7], s59 offen offset:3072 lds
    v_mfma_f32_16x16x32_bf16 a[56:59], v[160:163], a[196:199], a[56:59]
    ds_read_b128 a[172:175], v31 offset:59392
    v_cvt_pk_bf16_f32 v233, v233, v237
    v_mfma_f32_16x16x32_bf16 a[60:63], v[164:167], a[196:199], a[60:63]
    s_waitcnt lgkmcnt(4)
    v_fma_mix_f32 v234, v234, v22, v26 op_sel_hi:[1,0,0]
    v_mfma_f32_16x16x32_bf16 a[64:67], v[160:163], a[152:155], a[64:67]
    ds_read_b128 a[176:179], v32 offset:32768
    v_fma_mix_f32 v238, v238, v22, v26 op_sel_hi:[1,0,0]
    v_mfma_f32_16x16x32_bf16 a[68:71], v[164:167], a[152:155], a[68:71]
    v_cvt_pk_bf16_f32 v234, v234, v238
    v_fma_mix_f32 v235, v235, v23, v27 op_sel_hi:[1,0,0]
    v_mfma_f32_16x16x32_bf16 a[72:75], v[160:163], a[156:159], a[72:75]
    ds_read_b128 a[180:183], v32 offset:40960
    v_fma_mix_f32 v239, v239, v23, v27 op_sel_hi:[1,0,0]
    v_mfma_f32_16x16x32_bf16 a[76:79], v[164:167], a[156:159], a[76:79]
    s_waitcnt lgkmcnt(4)
    v_cvt_pk_bf16_f32 v235, v235, v239
    v_mfma_f32_16x16x32_bf16 a[80:83], v[160:163], a[160:163], a[80:83]
    ds_read_b128 a[184:187], v32 offset:33792
    s_waitcnt vmcnt(6)
    v_fma_mix_f32 v240, v240, v20, v24 op_sel_hi:[1,0,0]
    v_mfma_f32_16x16x32_bf16 a[84:87], v[164:167], a[160:163], a[84:87]
    v_fma_mix_f32 v244, v244, v20, v24 op_sel_hi:[1,0,0]
    s_add_u32 m0, s67, 81920
    s_nop 0
    s_cbranch_execz L_ret
    buffer_load_dwordx4 v19, s[4:7], s60 offen offset:3072 lds
    v_mfma_f32_16x16x32_bf16 a[88:91], v[160:163], a[164:167], a[88:91]
    ds_read_b128 a[188:191], v32 offset:41984
    v_cvt_pk_bf16_f32 v240, v240, v244
    v_mfma_f32_16x16x32_bf16 a[92:95], v[164:167], a[164:167], a[92:95]
    s_waitcnt lgkmcnt(4)
    v_fma_mix_f32 v241, v241, v21, v25 op_sel_hi:[1,0,0]
    v_mfma_f32_16x16x32_bf16 a[96:99], v[160:163], a[168:171], a[96:99]
    ds_read_b128 a[192:195], v32 offset:34816
    v_fma_mix_f32 v245, v245, v21, v25 op_sel_hi:[1,0,0]
    v_mfma_f32_16x16x32_bf16 a[100:103], v[164:167], a[168:171], a[100:103]
    v_cvt_pk_bf16_f32 v241, v241, v245
    v_fma_mix_f32 v242, v242, v22, v26 op_sel_hi:[1,0,0]
    v_mfma_f32_16x16x32_bf16 a[104:107], v[160:163], a[172:175], a[104:107]
    ds_read_b128 a[196:199], v32 offset:43008
    v_fma_mix_f32 v246, v246, v22, v26 op_sel_hi:[1,0,0]
    v_mfma_f32_16x16x32_bf16 a[108:111], v[164:167], a[172:175], a[108:111]
    s_waitcnt lgkmcnt(4)
    s_add_u32 m0, s67, 114688
    s_nop 0
    buffer_load_dwordx4 v19, s[4:7], s61 offen offset:3072 lds
    v_mfma_f32_16x16x32_bf16 a[0:3], v[168:171], a[176:179], a[0:3]
    ds_read_b128 a[152:155], v32 offset:35840
    v_cvt_pk_bf16_f32 v242, v242, v246
    v_mfma_f32_16x16x32_bf16 a[4:7], v[172:175], a[176:179], a[4:7]
    v_fma_mix_f32 v243, v243, v23, v27 op_sel_hi:[1,0,0]
    v_fma_mix_f32 v247, v247, v23, v27 op_sel_hi:[1,0,0]
    v_mfma_f32_16x16x32_bf16 a[8:11], v[168:171], a[180:183], a[8:11]
    ds_read_b128 a[156:159], v32 offset:44032
    v_cvt_pk_bf16_f32 v243, v243, v247
    v_mfma_f32_16x16x32_bf16 a[12:15], v[172:175], a[180:183], a[12:15]
    s_waitcnt lgkmcnt(4)
    s_waitcnt vmcnt(4)
    v_fma_mix_f32 v248, v248, v20, v24 op_sel_hi:[1,0,0]
    s_cbranch_execz L_ret
    v_mfma_f32_16x16x32_bf16 a[16:19], v[168:171], a[184:187], a[16:19]
    ds_read_b128 a[160:163], v32 offset:49152
    v_fma_mix_f32 v252, v252, v20, v24 op_sel_hi:[1,0,0]
    v_mfma_f32_16x16x32_bf16 a[20:23], v[172:175], a[184:187], a[20:23]
    s_add_u32 m0, s67, 32768
    s_nop 0
    buffer_load_dwordx4 v16, s[4:7], s62 offen offset:0 lds
    v_cvt_pk_bf16_f32 v248, v248, v252
    v_mfma_f32_16x16x32_bf16 a[24:27], v[168:171], a[188:191], a[24:27]
    ds_read_b128 a[164:167], v32 offset:57344
    v_fma_mix_f32 v249, v249, v21, v25 op_sel_hi:[1,0,0]
    v_mfma_f32_16x16x32_bf16 a[28:31], v[172:175], a[188:191], a[28:31]
    s_waitcnt lgkmcnt(4)
    v_fma_mix_f32 v253, v253, v21, v25 op_sel_hi:[1,0,0]
    v_mfma_f32_16x16x32_bf16 a[32:35], v[168:171], a[192:195], a[32:35]
    ds_read_b128 a[168:171], v32 offset:50176
    v_cvt_pk_bf16_f32 v249, v249, v253
    v_fma_mix_f32 v250, v250, v22, v26 op_sel_hi:[1,0,0]
    v_mfma_f32_16x16x32_bf16 a[36:39], v[172:175], a[192:195], a[36:39]
    v_fma_mix_f32 v254, v254, v22, v26 op_sel_hi:[1,0,0]
    v_cvt_pk_bf16_f32 v250, v250, v254
    v_mfma_f32_16x16x32_bf16 a[40:43], v[168:171], a[196:199], a[40:43]
    ds_read_b128 a[172:175], v32 offset:58368
    buffer_load_dwordx4 v17, s[4:7], s63 offen offset:1024 lds
    v_mfma_f32_16x16x32_bf16 a[44:47], v[172:175], a[196:199], a[44:47]
    s_waitcnt lgkmcnt(4)
    v_fma_mix_f32 v251, v251, v23, v27 op_sel_hi:[1,0,0]
    v_mfma_f32_16x16x32_bf16 a[48:51], v[168:171], a[152:155], a[48:51]
    ds_read_b128 a[176:179], v32 offset:51200
    v_fma_mix_f32 v255, v255, v23, v27 op_sel_hi:[1,0,0]
    v_mfma_f32_16x16x32_bf16 a[52:55], v[172:175], a[152:155], a[52:55]
    v_cvt_pk_bf16_f32 v251, v251, v255
    s_not_b64 vcc, vcc
    s_nop 0
    s_cbranch_execz L_ret
    v_cndmask_b32_dpp v176, v226, v224, vcc row_ror:8 row_mask:0xf bank_mask:0xf
    v_mfma_f32_16x16x32_bf16 a[56:59], v[168:171], a[156:159], a[56:59]
    ds_read_b128 a[180:183], v32 offset:59392
    v_cndmask_b32_dpp v177, v234, v232, vcc row_ror:8 row_mask:0xf bank_mask:0xf
    v_mfma_f32_16x16x32_bf16 a[60:63], v[172:175], a[156:159], a[60:63]
    s_waitcnt lgkmcnt(4)
    v_cndmask_b32_dpp v178, v242, v240, vcc row_ror:8 row_mask:0xf bank_mask:0xf
    buffer_load_dwordx4 v18, s[4:7], s64 offen offset:2048 lds
    v_mfma_f32_16x16x32_bf16 a[64:67], v[168:171], a[160:163], a[64:67]
    s_barrier
    ds_read_b128 a[184:187], v29 offset:0
    v_mfma_f32_16x16x32_bf16 a[68:71], v[172:175], a[160:163], a[68:71]
    v_cndmask_b32_dpp v179, v250, v248, vcc row_ror:8 row_mask:0xf bank_mask:0xf
    v_cndmask_b32_dpp v180, v227, v225, vcc row_ror:8 row_mask:0xf bank_mask:0xf
    v_mfma_f32_16x16x32_bf16 a[72:75], v[168:171], a[164:167], a[72:75]
    ds_read_b128 a[188:191], v29 offset:8192
    v_cndmask_b32_dpp v181, v235, v233, vcc row_ror:8 row_mask:0xf bank_mask:0xf
    v_cndmask_b32_dpp v182, v243, v241, vcc row_ror:8 row_mask:0xf bank_mask:0xf
    v_mfma_f32_16x16x32_bf16 a[76:79], v[172:175], a[164:167], a[76:79]
    s_waitcnt lgkmcnt(4)
    v_cndmask_b32_dpp v183, v251, v249, vcc row_ror:8 row_mask:0xf bank_mask:0xf
    v_mfma_f32_16x16x32_bf16 a[80:83], v[168:171], a[168:171], a[80:83]
    ds_read_b128 a[192:195], v30 offset:0
    s_not_b64 vcc, vcc
    v_cndmask_b32_dpp v184, v224, v226, vcc row_ror:8 row_mask:0xf bank_mask:0xf
    v_mfma_f32_16x16x32_bf16 a[84:87], v[172:175], a[168:171], a[84:87]
    buffer_load_dwordx4 v19, s[4:7], s65 offen offset:3072 lds
    v_cndmask_b32_dpp v185, v232, v234, vcc row_ror:8 row_mask:0xf bank_mask:0xf
    v_mfma_f32_16x16x32_bf16 a[88:91], v[168:171], a[172:175], a[88:91]
    ds_read_b128 a[196:199], v29 offset:1024
    v_cndmask_b32_dpp v186, v240, v242, vcc row_ror:8 row_mask:0xf bank_mask:0xf
    v_mfma_f32_16x16x32_bf16 a[92:95], v[172:175], a[172:175], a[92:95]
    s_waitcnt lgkmcnt(4)
    v_cndmask_b32_dpp v187, v248, v250, vcc row_ror:8 row_mask:0xf bank_mask:0xf
    s_cbranch_execz L_ret
    v_mfma_f32_16x16x32_bf16 a[96:99], v[168:171], a[176:179], a[96:99]
    ds_read_b128 a[152:155], v30 offset:8192
    v_cndmask_b32_dpp v188, v225, v227, vcc row_ror:8 row_mask:0xf bank_mask:0xf
    v_cndmask_b32_dpp v189, v233, v235, vcc row_ror:8 row_mask:0xf bank_mask:0xf
    v_mfma_f32_16x16x32_bf16 a[100:103], v[172:175], a[176:179], a[100:103]
    v_cndmask_b32_dpp v190, v241, v243, vcc row_ror:8 row_mask:0xf bank_mask:0xf
    s_add_u32 m0, s67, 49152
    s_nop 0
    buffer_load_dwordx4 v16, s[4:7], s66 offen offset:0 lds
    v_mfma_f32_16x16x32_bf16 a[104:107], v[168:171], a[180:183], a[104:107]
    ds_read_b128 a[156:159], v29 offset:9216
    v_cndmask_b32_dpp v191, v249, v251, vcc row_ror:8 row_mask:0xf bank_mask:0xf
    v_mfma_f32_16x16x32_bf16 a[108:111], v[172:175], a[180:183], a[108:111]
    s_waitcnt lgkmcnt(4)
    v_add_u32 v16, 294912, v12
    v_add_u32 v17, 293888, v12
    v_add_u32 v18, 292864, v12
    v_add_u32 v19, 291840, v12
    buffer_load_dwordx4 v17, s[4:7], s58 offen offset:1024 lds
    v_mfma_f32_16x16x32_bf16 a[0:3], v[176:179], a[184:187], a[0:3]
    ds_read_b128 a[160:163], v30 offset:1024
    v_mfma_f32_16x16x32_bf16 a[4:7], v[180:183], a[184:187], a[4:7]
    v_mfma_f32_16x16x32_bf16 a[8:11], v[176:179], a[188:191], a[8:11]
    ds_read_b128 a[164:167], v29 offset:2048
    v_mfma_f32_16x16x32_bf16 a[12:15], v[180:183], a[188:191], a[12:15]
    s_waitcnt lgkmcnt(4)
    v_mfma_f32_16x16x32_bf16 a[0:3], v[184:187], a[192:195], a[0:3]
    ds_read_b128 a[168:171], v30 offset:9216
    buffer_load_dwordx4 v18, s[4:7], s59 offen offset:2048 lds
    v_mfma_f32_16x16x32_bf16 a[4:7], v[188:191], a[192:195], a[4:7]
    v_mfma_f32_16x16x32_bf16 a[16:19], v[176:179], a[196:199], a[16:19]
    ds_read_b128 a[172:175], v29 offset:10240
    v_mfma_f32_16x16x32_bf16 a[20:23], v[180:183], a[196:199], a[20:23]
    s_cbranch_execz L_ret
    s_waitcnt lgkmcnt(4)
    v_mfma_f32_16x16x32_bf16 a[8:11], v[184:187], a[152:155], a[8:11]
    ds_read_b128 a[176:179], v30 offset:2048
    v_accvgpr_read_b32 v192, a0
    v_mfma_f32_16x16x32_bf16 a[12:15], v[188:191], a[152:155], a[12:15]
    v_accvgpr_read_b32 v196, a4
    v_accvgpr_read_b32 v194, a1
    v_mfma_f32_16x16x32_bf16 a[24:27], v[176:179], a[156:159], a[24:27]
    ds_read_b128 a[180:183], v29 offset:3072
    v_accvgpr_read_b32 v197, a5
    v_mfma_f32_16x16x32_bf16 a[28:31], v[180:183], a[156:159], a[28:31]
    s_waitcnt lgkmcnt(4)
    v_accvgpr_read_b32 v193, a2
    v_mfma_f32_16x16x32_bf16 a[16:19], v[184:187], a[160:163], a[16:19]
    ds_read_b128 a[184:187], v30 offset:10240
    s_add_u32 m0, s67, 65536
    s_nop 0
    buffer_load_dwordx4 v16, s[4:7], s60 offen offset:0 lds
    v_mfma_f32_16x16x32_bf16 a[20:23], v[188:191], a[160:163], a[20:23]
    v_accvgpr_read_b32 v198, a6
    v_accvgpr_read_b32 v195, a3
    v_mfma_f32_16x16x32_bf16 a[32:35], v[176:179], a[164:167], a[32:35]
    ds_read_b128 a[188:191], v29 offset:11264
    v_accvgpr_read_b32 v199, a7
    v_cvt_pk_bf16_f32 v192, v192, v196
    v_mfma_f32_16x16x32_bf16 a[36:39], v[180:183], a[164:167], a[36:39]
    s_waitcnt lgkmcnt(4)
    v_cvt_pk_bf16_f32 v194, v194, v197
    v_cvt_pk_bf16_f32 v193, v193, v198
    v_mfma_f32_16x16x32_bf16 a[24:27], v[184:187], a[168:171], a[24:27]
    ds_read_b128 a[192:195], v30 offset:3072
    v_cvt_pk_bf16_f32 v195, v195, v199
    v_permlane32_swap_b32 v192, v193
    v_mfma_f32_16x16x32_bf16 a[28:31], v[188:191], a[168:171], a[28:31]
    s_cbranch_execz L_ret
    v_permlane32_swap_b32 v194, v195
    ds_write_b128 v37, v[192:195] offset:0
    v_mfma_f32_16x16x32_bf16 a[40:43], v[176:179], a[172:175], a[40:43]
    ds_read_b128 a[196:199], v29 offset:16384
    buffer_load_dwordx4 v17, s[4:7], s61 offen offset:1024 lds
    v_mfma_f32_16x16x32_bf16 a[44:47], v[180:183], a[172:175], a[44:47]
    s_waitcnt lgkmcnt(5)
    v_accvgpr_read_b32 v200, a8
    v_mfma_f32_16x16x32_bf16 a[32:35], v[184:187], a[176:179], a[32:35]
    ds_read_b128 a[152:155], v30 offset:11264
    v_accvgpr_read_b32 v204, a12
    v_accvgpr_read_b32 v202, a9
    v_mfma_f32_16x16x32_bf16 a[36:39], v[188:191], a[176:179], a[36:39]
    v_accvgpr_read_b32 v205, a13
    v_accvgpr_read_b32 v201, a10
    v_accvgpr_read_b32 v206, a14
    v_mfma_f32_16x16x32_bf16 a[48:51], v[176:179], a[180:183], a[48:51]
    ds_read_b128 a[156:159], v29 offset:24576
    v_accvgpr_read_b32 v203, a11
    v_accvgpr_read_b32 v207, a15
    v_mfma_f32_16x16x32_bf16 a[52:55], v[180:183], a[180:183], a[52:55]
    s_waitcnt lgkmcnt(5)
    buffer_load_dwordx4 v18, s[4:7], s62 offen offset:2048 lds
    v_cvt_pk_bf16_f32 v200, v200, v204
    v_mfma_f32_16x16x32_bf16 a[40:43], v[184:187], a[184:187], a[40:43]
    ds_read_b128 a[160:163], v30 offset:16384
    v_cvt_pk_bf16_f32 v202, v202, v205
    v_cvt_pk_bf16_f32 v201, v201, v206
    v_mfma_f32_16x16x32_bf16 a[44:47], v[188:191], a[184:187], a[44:47]
    v_cvt_pk_bf16_f32 v203, v203, v207
    v_permlane32_swap_b32 v200, v201
    v_mfma_f32_16x16x32_bf16 a[56:59], v[176:179], a[188:191], a[56:59]
    ds_read_b128 a[164:167], v29 offset:17408
    v_permlane32_swap_b32 v202, v203
    s_cbranch_execz L_ret
    v_mfma_f32_16x16x32_bf16 a[60:63], v[180:183], a[188:191], a[60:63]
    s_waitcnt lgkmcnt(4)
    ds_write_b128 v37, v[200:203] offset:1024
    v_mfma_f32_16x16x32_bf16 a[48:51], v[184:187], a[192:195], a[48:51]
    ds_read_b128 a[168:171], v30 offset:24576
    buffer_load_dwordx4 v19, s[4:7], s63 offen offset:3072 lds
    v_mfma_f32_16x16x32_bf16 a[52:55], v[188:191], a[192:195], a[52:55]
    v_accvgpr_read_b32 v192, a16
    v_accvgpr_read_b32 v196, a20
    v_mfma_f32_16x16x32_bf16 a[64:67], v[176:179], a[196:199], a[64:67]
    ds_read_b128 a[172:175], v29 offset:25600
    v_accvgpr_read_b32 v194, a17
    v_mfma_f32_16x16x32_bf16 a[68:71], v[180:183], a[196:199], a[68:71]
    s_waitcnt lgkmcnt(5)
    v_accvgpr_read_b32 v197, a21
    v_accvgpr_read_b32 v193, a18
    v_mfma_f32_16x16x32_bf16 a[56:59], v[184:187], a[152:155], a[56:59]
    ds_read_b128 a[176:179], v30 offset:17408
    v_accvgpr_read_b32 v198, a22
    v_accvgpr_read_b32 v195, a19
    v_mfma_f32_16x16x32_bf16 a[60:63], v[188:191], a[152:155], a[60:63]
    v_accvgpr_read_b32 v199, a23
    v_cvt_pk_bf16_f32 v192, v192, v196
    s_add_u32 m0, s67, 81920
    s_nop 0
    buffer_load_dwordx4 v16, s[4:7], s64 offen offset:0 lds
    v_mfma_f32_16x16x32_bf16 a[72:75], v[176:179], a[156:159], a[72:75]
    ds_read_b128 a[180:183], v29 offset:18432
    v_cvt_pk_bf16_f32 v194, v194, v197
    v_cvt_pk_bf16_f32 v193, v193, v198
    v_mfma_f32_16x16x32_bf16 a[76:79], v[180:183], a[156:159], a[76:79]
    s_waitcnt lgkmcnt(5)
    v_cvt_pk_bf16_f32 v195, v195, v199
    s_nop 0
    s_cbranch_execz L_ret
    v_mfma_f32_16x16x32_bf16 a[64:67], v[184:187], a[160:163], a[64:67]
    ds_read_b128 a[184:187], v30 offset:25600
    v_permlane32_swap_b32 v192, v193
    v_mfma_f32_16x16x32_bf16 a[68:71], v[188:191], a[160:163], a[68:71]
    v_permlane32_swap_b32 v194, v195
    ds_write_b128 v37, v[192:195] offset:2048
    v_mfma_f32_16x16x32_bf16 a[80:83], v[176:179], a[164:167], a[80:83]
    ds_read_b128 a[188:191], v29 offset:26624
    buffer_load_dwordx4 v17, s[4:7], s65 offen offset:1024 lds
    v_mfma_f32_16x16x32_bf16 a[84:87], v[180:183], a[164:167], a[84:87]
    s_waitcnt lgkmcnt(5)
    v_accvgpr_read_b32 v200, a24
    v_mfma_f32_16x16x32_bf16 a[72:75], v[184:187], a[168:171], a[72:75]
    ds_read_b128 a[192:195], v30 offset:18432
    v_accvgpr_read_b32 v204, a28
    v_accvgpr_read_b32 v202, a25
    v_mfma_f32_16x16x32_bf16 a[76:79], v[188:191], a[168:171], a[76:79]
    v_accvgpr_read_b32 v205, a29
    v_accvgpr_read_b32 v201, a26
    v_mfma_f32_16x16x32_bf16 a[88:91], v[176:179], a[172:175], a[88:91]
    ds_read_b128 a[196:199], v30 offset:26624
    v_accvgpr_read_b32 v206, a30
    v_accvgpr_read_b32 v203, a27
    v_mfma_f32_16x16x32_bf16 a[92:95], v[180:183], a[172:175], a[92:95]
    s_waitcnt lgkmcnt(5)
    v_accvgpr_read_b32 v207, a31
    v_cvt_pk_bf16_f32 v200, v200, v204
    v_mfma_f32_16x16x32_bf16 a[80:83], v[184:187], a[176:179], a[80:83]
    s_waitcnt vmcnt(12)
    s_waitcnt lgkmcnt(3)
    s_barrier
    ds_read_b128 a[152:155], v29 offset:19456
    v_mfma_f32_16x16x32_bf16 a[84:87], v[188:191], a[176:179], a[84:87]
    buffer_load_dwordx4 v18, s[4:7], s66 offen offset:2048 lds
    v_cvt_pk_bf16_f32 v202, v202, v205
    s_cbranch_execz L_ret
    v_cvt_pk_bf16_f32 v201, v201, v206
    v_mfma_f32_16x16x32_bf16 a[96:99], v[176:179], a[180:183], a[96:99]
    ds_read_b128 a[156:159], v29 offset:27648
    v_cvt_pk_bf16_f32 v203, v203, v207
    v_permlane32_swap_b32 v200, v201
    v_mfma_f32_16x16x32_bf16 a[100:103], v[180:183], a[180:183], a[100:103]
    s_waitcnt lgkmcnt(4)
    v_permlane32_swap_b32 v202, v203
    v_mfma_f32_16x16x32_bf16 a[88:91], v[184:187], a[184:187], a[88:91]
    ds_read_b128 a[160:163], v30 offset:19456
    ds_read_b128 v[208:211], v38 offset:0
    v_mfma_f32_16x16x32_bf16 a[92:95], v[188:191], a[184:187], a[92:95]
    ds_write_b128 v37, v[200:203] offset:3072
    s_add_u32 m0, s67, 98304
    v_add_u32 v16, 331776, v13
    v_add_u32 v17, 330752, v13
    v_add_u32 v18, 329728, v13
    v_add_u32 v19, 328704, v13
    s_mov_b32 exec_hi, 0
    buffer_load_dwordx4 v16, s[4:7], s58 offen offset:0 lds
    s_mov_b32 exec_hi, -1
    v_mfma_f32_16x16x32_bf16 a[104:107], v[176:179], a[188:191], a[104:107]
    ds_read_b128 a[164:167], v30 offset:27648
    ds_read_b128 v[212:215], v38 offset:1024
    v_mfma_f32_16x16x32_bf16 a[108:111], v[180:183], a[188:191], a[108:111]
    s_waitcnt lgkmcnt(7)
    v_accvgpr_read_b32 v192, a32
    v_accvgpr_read_b32 v196, a36
    v_mfma_f32_16x16x32_bf16 a[96:99], v[184:187], a[192:195], a[96:99]
    ds_read_b128 a[168:171], v29 offset:52224
    s_waitcnt lgkmcnt(4)
    buffer_store_dwordx4 v[208:211], v28, s[12:15], s68 offen sc1
    v_accvgpr_read_b32 v194, a33
    v_mfma_f32_16x16x32_bf16 a[100:103], v[188:191], a[192:195], a[100:103]
    v_accvgpr_read_b32 v197, a37
    s_cbranch_execz L_ret
    v_accvgpr_read_b32 v193, a34
    v_accvgpr_read_b32 v198, a38
    v_mfma_f32_16x16x32_bf16 a[104:107], v[184:187], a[196:199], a[104:107]
    ds_read_b128 a[172:175], v29 offset:60416
    ds_read_b128 v[216:219], v38 offset:2048
    s_mov_b32 exec_hi, 0
    buffer_load_dwordx4 v17, s[4:7], s59 offen offset:1024 lds
    s_mov_b32 exec_hi, -1
    v_mfma_f32_16x16x32_bf16 a[108:111], v[188:191], a[196:199], a[108:111]
    v_accvgpr_read_b32 v195, a35
    v_accvgpr_read_b32 v199, a39
    v_mfma_f32_16x16x32_bf16 a[112:115], v[48:51], a[152:155], 0
    ds_read_b128 a[176:179], v30 offset:52224
    v_cvt_pk_bf16_f32 v192, v192, v196
    v_cvt_pk_bf16_f32 v194, v194, v197
    v_mfma_f32_16x16x32_bf16 a[116:119], v[52:55], a[152:155], 0
    s_waitcnt lgkmcnt(4)
    buffer_store_dwordx4 v[212:215], v28, s[12:15], s69 offen sc1
    v_cvt_pk_bf16_f32 v193, v193, v198
    v_cvt_pk_bf16_f32 v195, v195, v199
    v_mfma_f32_16x16x32_bf16 v[224:227], v[48:51], a[156:159], 0
    ds_read_b128 a[180:183], v30 offset:60416
    v_permlane32_swap_b32 v192, v193
    v_permlane32_swap_b32 v194, v195
    v_mfma_f32_16x16x32_bf16 v[228:231], v[52:55], a[156:159], 0
    ds_write_b128 v37, v[192:195] offset:16384
    v_mfma_f32_16x16x32_bf16 a[112:115], v[56:59], a[160:163], a[112:115]
    ds_read_b128 a[184:187], v31 offset:19456
    s_mov_b32 exec_hi, 0
    buffer_load_dwordx4 v18, s[4:7], s60 offen offset:2048 lds
    s_mov_b32 exec_hi, -1
    v_mfma_f32_16x16x32_bf16 a[116:119], v[60:63], a[160:163], a[116:119]
    s_waitcnt lgkmcnt(4)
    buffer_store_dwordx4 v[216:219], v28, s[12:15], s70 offen sc1
    v_accvgpr_read_b32 v200, a40
    s_nop 0
    s_cbranch_execz L_ret
    v_mfma_f32_16x16x32_bf16 v[224:227], v[56:59], a[164:167], v[224:227]
    ds_read_b128 a[188:191], v31 offset:27648
    v_accvgpr_read_b32 v204, a44
    v_accvgpr_read_b32 v202, a41
    v_mfma_f32_16x16x32_bf16 v[228:231], v[60:63], a[164:167], v[228:231]
    v_accvgpr_read_b32 v205, a45
    v_accvgpr_read_b32 v201, a42
    v_mfma_f32_16x16x32_bf16 a[112:115], v[64:67], a[168:171], a[112:115]
    ds_read_b128 a[192:195], v32 offset:19456
    v_accvgpr_read_b32 v206, a46
    v_accvgpr_read_b32 v203, a43
    v_mfma_f32_16x16x32_bf16 a[116:119], v[68:71], a[168:171], a[116:119]
    s_mov_b32 exec_hi, 0
    buffer_load_dwordx4 v19, s[4:7], s61 offen offset:3072 lds
    s_mov_b32 exec_hi, -1
    v_mfma_f32_16x16x32_bf16 v[224:227], v[64:67], a[172:175], v[224:227]
    ds_read_b128 a[196:199], v32 offset:27648
    v_accvgpr_read_b32 v207, a47
    v_cvt_pk_bf16_f32 v200, v200, v204
    v_mfma_f32_16x16x32_bf16 v[228:231], v[68:71], a[172:175], v[228:231]
    s_waitcnt lgkmcnt(5)
    v_cvt_pk_bf16_f32 v202, v202, v205
    v_cvt_pk_bf16_f32 v201, v201, v206
    v_mfma_f32_16x16x32_bf16 a[112:115], v[72:75], a[176:179], a[112:115]
    ds_read_b128 a[152:155], v31 offset:52224
    v_cvt_pk_bf16_f32 v203, v203, v207
    v_permlane32_swap_b32 v200, v201
    v_mfma_f32_16x16x32_bf16 a[116:119], v[76:79], a[176:179], a[116:119]
    v_permlane32_swap_b32 v202, v203
    ds_write_b128 v37, v[200:203] offset:17408
    v_mfma_f32_16x16x32_bf16 v[224:227], v[72:75], a[180:183], v[224:227]
    ds_read_b128 a[156:159], v31 offset:60416
    s_add_u32 m0, s67, 0
    s_mov_b32 exec_hi, 0
    buffer_load_dwordx4 v16, s[4:7], s62 offen offset:0 lds
    s_cbranch_execz L_ret
    s_mov_b32 exec_hi, -1
    v_mfma_f32_16x16x32_bf16 v[228:231], v[76:79], a[180:183], v[228:231]
    s_waitcnt lgkmcnt(5)
    v_accvgpr_read_b32 v192, a48
    v_mfma_f32_16x16x32_bf16 a[112:115], v[80:83], a[184:187], a[112:115]
    ds_read_b128 a[160:163], v32 offset:52224
    v_accvgpr_read_b32 v196, a52
    v_mfma_f32_16x16x32_bf16 a[116:119], v[84:87], a[184:187], a[116:119]
    v_accvgpr_read_b32 v194, a49
    v_accvgpr_read_b32 v197, a53
    v_accvgpr_read_b32 v193, a50
    v_mfma_f32_16x16x32_bf16 v[224:227], v[80:83], a[188:191], v[224:227]
    ds_read_b128 a[164:167], v32 offset:60416
    v_accvgpr_read_b32 v198, a54
    v_mfma_f32_16x16x32_bf16 v[228:231], v[84:87], a[188:191], v[228:231]
    s_waitcnt lgkmcnt(5)
    s_mov_b32 exec_hi, 0
    buffer_load_dwordx4 v17, s[4:7], s63 offen offset:1024 lds
    s_mov_b32 exec_hi, -1
    v_mfma_f32_16x16x32_bf16 a[112:115], v[88:91], a[192:195], a[112:115]
    ds_read_b128 a[168:171], v29 offset:32768
    v_accvgpr_read_b32 v195, a51
    v_accvgpr_read_b32 v199, a55
    v_mfma_f32_16x16x32_bf16 a[116:119], v[92:95], a[192:195], a[116:119]
    v_cvt_pk_bf16_f32 v192, v192, v196
    v_cvt_pk_bf16_f32 v194, v194, v197
    v_mfma_f32_16x16x32_bf16 v[224:227], v[88:91], a[196:199], v[224:227]
    ds_read_b128 a[172:175], v29 offset:40960
    v_cvt_pk_bf16_f32 v193, v193, v198
    v_mfma_f32_16x16x32_bf16 v[228:231], v[92:95], a[196:199], v[228:231]
    s_waitcnt lgkmcnt(4)
    v_cvt_pk_bf16_f32 v195, v195, v199
    v_permlane32_swap_b32 v192, v193
    v_mfma_f32_16x16x32_bf16 a[112:115], v[96:99], a[152:155], a[112:115]
    ds_read_b128 a[176:179], v30 offset:32768
    s_cbranch_execz L_ret
    v_permlane32_swap_b32 v194, v195
    v_mfma_f32_16x16x32_bf16 a[116:119], v[100:103], a[152:155], a[116:119]
    s_mov_b32 exec_hi, 0
    buffer_load_dwordx4 v18, s[4:7], s64 offen offset:2048 lds
    s_mov_b32 exec_hi, -1
    v_mfma_f32_16x16x32_bf16 v[224:227], v[96:99], a[156:159], v[224:227]
    ds_read_b128 a[180:183], v30 offset:40960
    ds_write_b128 v37, v[192:195] offset:18432
    v_mfma_f32_16x16x32_bf16 v[228:231], v[100:103], a[156:159], v[228:231]
    s_waitcnt lgkmcnt(5)
    v_accvgpr_read_b32 v200, a56
    v_mfma_f32_16x16x32_bf16 a[112:115], v[104:107], a[160:163], a[112:115]
    s_waitcnt vmcnt(19)
    s_waitcnt lgkmcnt(0)
    s_barrier
    ds_read_b128 a[184:187], v29 offset:33792
    v_mfma_f32_16x16x32_bf16 a[116:119], v[108:111], a[160:163], a[116:119]
    v_accvgpr_read_b32 v204, a60
    s_mov_b32 exec_hi, 0
    buffer_load_dwordx4 v19, s[4:7], s65 offen offset:3072 lds
    s_mov_b32 exec_hi, -1
    v_mfma_f32_16x16x32_bf16 v[224:227], v[104:107], a[164:167], v[224:227]
    ds_read_b128 a[188:191], v29 offset:41984
    v_accvgpr_read_b32 v202, a57
    v_accvgpr_read_b32 v205, a61
    v_mfma_f32_16x16x32_bf16 v[228:231], v[108:111], a[164:167], v[228:231]
    ds_read_b128 v[220:223], v38 offset:3072
    v_accvgpr_read_b32 v201, a58
    v_mfma_f32_16x16x32_bf16 a[112:115], v[112:115], a[168:171], a[112:115]
    ds_read_b128 a[192:195], v30 offset:33792
    v_accvgpr_read_b32 v206, a62
    v_accvgpr_read_b32 v203, a59
    v_mfma_f32_16x16x32_bf16 a[116:119], v[116:119], a[168:171], a[116:119]
    v_accvgpr_read_b32 v207, a63
    v_cvt_pk_bf16_f32 v200, v200, v204
    v_cvt_pk_bf16_f32 v202, v202, v205
    s_cbranch_execz L_ret
    v_mfma_f32_16x16x32_bf16 v[224:227], v[112:115], a[172:175], v[224:227]
    ds_read_b128 a[196:199], v30 offset:41984
    ds_read_b128 v[208:211], v38 offset:16384
    s_add_u32 m0, s67, 16384
    s_mov_b32 exec_hi, 0
    buffer_load_dwordx4 v16, s[4:7], s66 offen offset:0 lds
    s_mov_b32 exec_hi, -1
    v_mfma_f32_16x16x32_bf16 v[228:231], v[116:119], a[172:175], v[228:231]
    v_cvt_pk_bf16_f32 v201, v201, v206
    v_cvt_pk_bf16_f32 v203, v203, v207
    v_mfma_f32_16x16x32_bf16 a[112:115], v[120:123], a[176:179], a[112:115]
    ds_read_b128 a[152:155], v29 offset:34816
    v_permlane32_swap_b32 v200, v201
    s_waitcnt lgkmcnt(4)
    buffer_store_dwordx4 v[220:223], v28, s[12:15], s71 offen sc1
    v_mfma_f32_16x16x32_bf16 a[116:119], v[124:127], a[176:179], a[116:119]
    v_permlane32_swap_b32 v202, v203
    ds_write_b128 v37, v[200:203] offset:19456
    v_mfma_f32_16x16x32_bf16 v[224:227], v[120:123], a[180:183], v[224:227]
    ds_read_b128 a[156:159], v29 offset:43008
    ds_read_b128 v[212:215], v38 offset:17408
    v_mfma_f32_16x16x32_bf16 v[228:231], v[124:127], a[180:183], v[228:231]
    v_accvgpr_read_b32 v192, a64
    v_accvgpr_read_b32 v196, a68
    v_mfma_f32_16x16x32_bf16 a[112:115], v[128:131], a[184:187], a[112:115]
    ds_read_b128 a[160:163], v30 offset:34816
    s_waitcnt lgkmcnt(5)
    buffer_store_dwordx4 v[208:211], v28, s[12:15], s72 offen sc1
    v_accvgpr_read_b32 v194, a65
    v_mfma_f32_16x16x32_bf16 a[116:119], v[132:135], a[184:187], a[116:119]
    v_accvgpr_read_b32 v197, a69
    v_accvgpr_read_b32 v193, a66
    v_mfma_f32_16x16x32_bf16 v[224:227], v[128:131], a[188:191], v[224:227]
    ds_read_b128 a[164:167], v30 offset:43008
    s_nop 0
    s_cbranch_execz L_ret
    ds_read_b128 v[216:219], v38 offset:18432
    v_accvgpr_read_b32 v198, a70
    v_mfma_f32_16x16x32_bf16 v[228:231], v[132:135], a[188:191], v[228:231]
    v_accvgpr_read_b32 v195, a67
    v_accvgpr_read_b32 v199, a71
    v_mfma_f32_16x16x32_bf16 a[112:115], v[136:139], a[192:195], a[112:115]
    ds_read_b128 a[168:171], v29 offset:35840
    s_waitcnt lgkmcnt(4)
    buffer_store_dwordx4 v[212:215], v28, s[12:15], s73 offen sc1
    v_mfma_f32_16x16x32_bf16 a[116:119], v[140:143], a[192:195], a[116:119]
    v_cvt_pk_bf16_f32 v192, v192, v196
    v_cvt_pk_bf16_f32 v194, v194, v197
    v_mfma_f32_16x16x32_bf16 v[224:227], v[136:139], a[196:199], v[224:227]
    ds_read_b128 a[172:175], v29 offset:44032
    v_cvt_pk_bf16_f32 v193, v193, v198
    v_cvt_pk_bf16_f32 v195, v195, v199
    v_mfma_f32_16x16x32_bf16 v[228:231], v[140:143], a[196:199], v[228:231]
    v_permlane32_swap_b32 v192, v193
    v_mfma_f32_16x16x32_bf16 a[112:115], v[144:147], a[152:155], a[112:115]
    ds_read_b128 a[176:179], v30 offset:35840
    v_permlane32_swap_b32 v194, v195
    v_mfma_f32_16x16x32_bf16 a[116:119], v[148:151], a[152:155], a[116:119]
    s_waitcnt lgkmcnt(3)
    buffer_store_dwordx4 v[216:219], v28, s[12:15], s74 offen sc1
    ds_write_b128 v37, v[192:195] offset:0
    v_mfma_f32_16x16x32_bf16 v[224:227], v[144:147], a[156:159], v[224:227]
    ds_read_b128 a[180:183], v30 offset:44032
    v_accvgpr_read_b32 v200, a72
    v_mfma_f32_16x16x32_bf16 v[228:231], v[148:151], a[156:159], v[228:231]
    v_accvgpr_read_b32 v204, a76
    v_mfma_f32_16x16x32_bf16 a[112:115], v[152:155], a[160:163], a[112:115]
    ds_read_b128 a[184:187], v29 offset:49152
    v_accvgpr_read_b32 v202, a73
    s_nop 0
    s_cbranch_execz L_ret
    v_mfma_f32_16x16x32_bf16 a[116:119], v[156:159], a[160:163], a[116:119]
    v_accvgpr_read_b32 v205, a77
    v_accvgpr_read_b32 v201, a74
    v_mfma_f32_16x16x32_bf16 v[224:227], v[152:155], a[164:167], v[224:227]
    ds_read_b128 a[188:191], v29 offset:57344
    v_accvgpr_read_b32 v206, a78
    v_mfma_f32_16x16x32_bf16 v[228:231], v[156:159], a[164:167], v[228:231]
    s_waitcnt lgkmcnt(5)
    v_accvgpr_read_b32 v203, a75
    v_mfma_f32_16x16x32_bf16 a[112:115], v[160:163], a[168:171], a[112:115]
    ds_read_b128 a[192:195], v30 offset:49152
    v_accvgpr_read_b32 v207, a79
    v_mfma_f32_16x16x32_bf16 a[116:119], v[164:167], a[168:171], a[116:119]
    v_cvt_pk_bf16_f32 v200, v200, v204
    v_cvt_pk_bf16_f32 v202, v202, v205
    v_mfma_f32_16x16x32_bf16 v[224:227], v[160:163], a[172:175], v[224:227]
    ds_read_b128 a[196:199], v30 offset:57344
    v_cvt_pk_bf16_f32 v201, v201, v206
    v_mfma_f32_16x16x32_bf16 v[228:231], v[164:167], a[172:175], v[228:231]
    s_waitcnt lgkmcnt(4)
    v_cvt_pk_bf16_f32 v203, v203, v207
    v_mfma_f32_16x16x32_bf16 a[112:115], v[168:171], a[176:179], a[112:115]
    s_waitcnt vmcnt(20)
    s_barrier
    ds_read_b128 a[152:155], v29 offset:50176
    v_mfma_f32_16x16x32_bf16 a[116:119], v[172:175], a[176:179], a[116:119]
    v_permlane32_swap_b32 v200, v201
    v_permlane32_swap_b32 v202, v203
    v_mfma_f32_16x16x32_bf16 v[224:227], v[168:171], a[180:183], v[224:227]
    ds_read_b128 a[156:159], v29 offset:58368
    ds_write_b128 v37, v[200:203] offset:1024
    v_mfma_f32_16x16x32_bf16 v[228:231], v[172:175], a[180:183], v[228:231]
    s_waitcnt lgkmcnt(5)
    ds_read_b128 v[220:223], v38 offset:19456
    v_mfma_f32_16x16x32_bf16 a[112:115], v[176:179], a[184:187], a[112:115]
    s_cbranch_execz L_ret
    ds_read_b128 a[160:163], v30 offset:50176
    v_accvgpr_read_b32 v192, a80
    v_accvgpr_read_b32 v196, a84
    v_mfma_f32_16x16x32_bf16 a[116:119], v[180:183], a[184:187], a[116:119]
    v_accvgpr_read_b32 v194, a81
    v_accvgpr_read_b32 v197, a85
    v_mfma_f32_16x16x32_bf16 v[224:227], v[176:179], a[188:191], v[224:227]
    ds_read_b128 a[164:167], v30 offset:58368
    ds_read_b128 v[208:211], v38 offset:0
    v_accvgpr_read_b32 v193, a82
    v_mfma_f32_16x16x32_bf16 v[228:231], v[180:183], a[188:191], v[228:231]
    s_waitcnt lgkmcnt(7)
    v_accvgpr_read_b32 v198, a86
    v_mfma_f32_16x16x32_bf16 a[112:115], v[184:187], a[192:195], a[112:115]
    ds_read_b128 a[168:171], v29 offset:51200
    v_accvgpr_read_b32 v195, a83
    s_waitcnt lgkmcnt(4)
    buffer_store_dwordx4 v[220:223], v28, s[12:15], s75 offen sc1
    v_mfma_f32_16x16x32_bf16 a[116:119], v[188:191], a[192:195], a[116:119]
    v_accvgpr_read_b32 v199, a87
    v_cvt_pk_bf16_f32 v192, v192, v196
    v_mfma_f32_16x16x32_bf16 v[224:227], v[184:187], a[196:199], v[224:227]
    ds_read_b128 a[172:175], v29 offset:59392
    v_cvt_pk_bf16_f32 v194, v194, v197
    v_cvt_pk_bf16_f32 v193, v193, v198
    v_mfma_f32_16x16x32_bf16 v[228:231], v[188:191], a[196:199], v[228:231]
    v_cvt_pk_bf16_f32 v195, v195, v199
    v_mfma_f32_16x16x32_bf16 v[232:235], v[48:51], a[152:155], 0
    ds_read_b128 a[176:179], v30 offset:51200
    v_permlane32_swap_b32 v192, v193
    v_mfma_f32_16x16x32_bf16 v[236:239], v[52:55], a[152:155], 0
    s_waitcnt lgkmcnt(3)
    buffer_store_dwordx4 v[208:211], v28, s[12:15], s76 offen sc1
    v_permlane32_swap_b32 v194, v195
    s_cbranch_execz L_ret
    v_mfma_f32_16x16x32_bf16 v[240:243], v[48:51], a[156:159], 0
    ds_read_b128 a[180:183], v30 offset:59392
    ds_write_b128 v37, v[192:195] offset:2048
    v_mfma_f32_16x16x32_bf16 v[244:247], v[52:55], a[156:159], 0
    v_accvgpr_read_b32 v200, a88
    v_mfma_f32_16x16x32_bf16 v[232:235], v[56:59], a[160:163], v[232:235]
    ds_read_b128 a[184:187], v31 offset:0
    v_accvgpr_read_b32 v204, a92
    v_mfma_f32_16x16x32_bf16 v[236:239], v[60:63], a[160:163], v[236:239]
    v_accvgpr_read_b32 v202, a89
    v_accvgpr_read_b32 v205, a93
    v_mfma_f32_16x16x32_bf16 v[240:243], v[56:59], a[164:167], v[240:243]
    ds_read_b128 a[188:191], v31 offset:8192
    v_accvgpr_read_b32 v201, a90
    v_mfma_f32_16x16x32_bf16 v[244:247], v[60:63], a[164:167], v[244:247]
    s_waitcnt lgkmcnt(5)
    v_accvgpr_read_b32 v206, a94
    v_mfma_f32_16x16x32_bf16 v[232:235], v[64:67], a[168:171], v[232:235]
    ds_read_b128 a[192:195], v32 offset:0
    v_accvgpr_read_b32 v203, a91
    v_mfma_f32_16x16x32_bf16 v[236:239], v[68:71], a[168:171], v[236:239]
    v_accvgpr_read_b32 v207, a95
    v_cvt_pk_bf16_f32 v200, v200, v204
    v_mfma_f32_16x16x32_bf16 v[240:243], v[64:67], a[172:175], v[240:243]
    ds_read_b128 a[196:199], v32 offset:8192
    v_cvt_pk_bf16_f32 v202, v202, v205
    v_mfma_f32_16x16x32_bf16 v[244:247], v[68:71], a[172:175], v[244:247]
    s_waitcnt lgkmcnt(5)
    v_cvt_pk_bf16_f32 v201, v201, v206
    v_mfma_f32_16x16x32_bf16 v[232:235], v[72:75], a[176:179], v[232:235]
    ds_read_b128 a[152:155], v31 offset:1024
    v_cvt_pk_bf16_f32 v203, v203, v207
    s_nop 0
    s_cbranch_execz L_ret
    v_mfma_f32_16x16x32_bf16 v[236:239], v[76:79], a[176:179], v[236:239]
    v_permlane32_swap_b32 v200, v201
    v_permlane32_swap_b32 v202, v203
    v_mfma_f32_16x16x32_bf16 v[240:243], v[72:75], a[180:183], v[240:243]
    ds_read_b128 a[156:159], v31 offset:9216
    ds_write_b128 v37, v[200:203] offset:3072
    v_mfma_f32_16x16x32_bf16 v[244:247], v[76:79], a[180:183], v[244:247]
    s_waitcnt lgkmcnt(5)
    v_accvgpr_read_b32 v192, a96
    v_mfma_f32_16x16x32_bf16 v[232:235], v[80:83], a[184:187], v[232:235]
    ds_read_b128 a[160:163], v32 offset:1024
    v_accvgpr_read_b32 v196, a100
    v_mfma_f32_16x16x32_bf16 v[236:239], v[84:87], a[184:187], v[236:239]
    v_accvgpr_read_b32 v194, a97
    v_accvgpr_read_b32 v197, a101
    v_mfma_f32_16x16x32_bf16 v[240:243], v[80:83], a[188:191], v[240:243]
    ds_read_b128 a[164:167], v32 offset:9216
    v_accvgpr_read_b32 v193, a98
    v_mfma_f32_16x16x32_bf16 v[244:247], v[84:87], a[188:191], v[244:247]
    s_waitcnt lgkmcnt(5)
    v_accvgpr_read_b32 v198, a102
    v_mfma_f32_16x16x32_bf16 v[232:235], v[88:91], a[192:195], v[232:235]
    ds_read_b128 a[168:171], v31 offset:2048
    v_accvgpr_read_b32 v195, a99
    v_mfma_f32_16x16x32_bf16 v[236:239], v[92:95], a[192:195], v[236:239]
    v_accvgpr_read_b32 v199, a103
    v_cvt_pk_bf16_f32 v192, v192, v196
    v_mfma_f32_16x16x32_bf16 v[240:243], v[88:91], a[196:199], v[240:243]
    ds_read_b128 a[172:175], v31 offset:10240
    v_cvt_pk_bf16_f32 v194, v194, v197
    v_mfma_f32_16x16x32_bf16 v[244:247], v[92:95], a[196:199], v[244:247]
    s_waitcnt lgkmcnt(5)
    v_cvt_pk_bf16_f32 v193, v193, v198
    v_mfma_f32_16x16x32_bf16 v[232:235], v[96:99], a[152:155], v[232:235]
    s_cbranch_execz L_ret
    ds_read_b128 a[176:179], v32 offset:2048
    v_cvt_pk_bf16_f32 v195, v195, v199
    v_mfma_f32_16x16x32_bf16 v[236:239], v[100:103], a[152:155], v[236:239]
    v_permlane32_swap_b32 v192, v193
    v_permlane32_swap_b32 v194, v195
    v_mfma_f32_16x16x32_bf16 v[240:243], v[96:99], a[156:159], v[240:243]
    ds_read_b128 a[180:183], v32 offset:10240
    ds_write_b128 v37, v[192:195] offset:16384
    v_mfma_f32_16x16x32_bf16 v[244:247], v[100:103], a[156:159], v[244:247]
    s_waitcnt lgkmcnt(5)
    v_accvgpr_read_b32 v200, a104
    v_mfma_f32_16x16x32_bf16 v[232:235], v[104:107], a[160:163], v[232:235]
    s_waitcnt vmcnt(18)
    s_waitcnt lgkmcnt(0)
    s_barrier
    ds_read_b128 a[184:187], v31 offset:3072
    v_mfma_f32_16x16x32_bf16 v[236:239], v[108:111], a[160:163], v[236:239]
    v_accvgpr_read_b32 v204, a108
    v_accvgpr_read_b32 v202, a105
    v_mfma_f32_16x16x32_bf16 v[240:243], v[104:107], a[164:167], v[240:243]
    ds_read_b128 a[188:191], v31 offset:11264
    v_accvgpr_read_b32 v205, a109
    ds_read_b128 v[212:215], v38 offset:1024
    v_mfma_f32_16x16x32_bf16 v[244:247], v[108:111], a[164:167], v[244:247]
    v_accvgpr_read_b32 v201, a106
    v_mfma_f32_16x16x32_bf16 v[232:235], v[112:115], a[168:171], v[232:235]
    ds_read_b128 a[192:195], v32 offset:3072
    v_accvgpr_read_b32 v206, a110
    v_accvgpr_read_b32 v203, a107
    v_mfma_f32_16x16x32_bf16 v[236:239], v[116:119], a[168:171], v[236:239]
    v_accvgpr_read_b32 v207, a111
    v_cvt_pk_bf16_f32 v200, v200, v204
    v_mfma_f32_16x16x32_bf16 v[240:243], v[112:115], a[172:175], v[240:243]
    ds_read_b128 a[196:199], v32 offset:11264
    s_nop 0
    s_cbranch_execz L_ret
    v_cvt_pk_bf16_f32 v202, v202, v205
    ds_read_b128 v[216:219], v38 offset:2048
    v_mfma_f32_16x16x32_bf16 v[244:247], v[116:119], a[172:175], v[244:247]
    v_cvt_pk_bf16_f32 v201, v201, v206
    v_cvt_pk_bf16_f32 v203, v203, v207
    v_mfma_f32_16x16x32_bf16 v[232:235], v[120:123], a[176:179], v[232:235]
    ds_read_b128 a[152:155], v31 offset:16384
    v_permlane32_swap_b32 v200, v201
    s_waitcnt lgkmcnt(4)
    buffer_store_dwordx4 v[212:215], v28, s[12:15], s77 offen sc1
    v_mfma_f32_16x16x32_bf16 v[236:239], v[124:127], a[176:179], v[236:239]
    v_permlane32_swap_b32 v202, v203
    ds_write_b128 v37, v[200:203] offset:17408
    v_mfma_f32_16x16x32_bf16 v[240:243], v[120:123], a[180:183], v[240:243]
    ds_read_b128 a[156:159], v31 offset:24576
    ds_read_b128 v[220:223], v38 offset:3072
    v_mfma_f32_16x16x32_bf16 v[244:247], v[124:127], a[180:183], v[244:247]
    v_accvgpr_read_b32 v192, a112
    v_accvgpr_read_b32 v196, a116
    v_mfma_f32_16x16x32_bf16 v[232:235], v[128:131], a[184:187], v[232:235]
    ds_read_b128 a[160:163], v32 offset:16384
    s_waitcnt lgkmcnt(5)
    buffer_store_dwordx4 v[216:219], v28, s[12:15], s78 offen sc1
    v_accvgpr_read_b32 v194, a113
    v_mfma_f32_16x16x32_bf16 v[236:239], v[132:135], a[184:187], v[236:239]
    v_accvgpr_read_b32 v197, a117
    v_accvgpr_read_b32 v193, a114
    v_mfma_f32_16x16x32_bf16 v[240:243], v[128:131], a[188:191], v[240:243]
    ds_read_b128 a[164:167], v32 offset:24576
    ds_read_b128 v[208:211], v38 offset:16384
    v_accvgpr_read_b32 v198, a118
    v_mfma_f32_16x16x32_bf16 v[244:247], v[132:135], a[188:191], v[244:247]
    v_accvgpr_read_b32 v195, a115
    s_nop 0
    s_cbranch_execz L_ret
    v_accvgpr_read_b32 v199, a119
    v_mfma_f32_16x16x32_bf16 v[232:235], v[136:139], a[192:195], v[232:235]
    ds_read_b128 a[168:171], v31 offset:17408
    s_waitcnt lgkmcnt(4)
    buffer_store_dwordx4 v[220:223], v28, s[12:15], s79 offen sc1
    v_mfma_f32_16x16x32_bf16 v[236:239], v[140:143], a[192:195], v[236:239]
    v_cvt_pk_bf16_f32 v192, v192, v196
    v_cvt_pk_bf16_f32 v194, v194, v197
    v_mfma_f32_16x16x32_bf16 v[240:243], v[136:139], a[196:199], v[240:243]
    ds_read_b128 a[172:175], v31 offset:25600
    v_cvt_pk_bf16_f32 v193, v193, v198
    v_cvt_pk_bf16_f32 v195, v195, v199
    v_mfma_f32_16x16x32_bf16 v[244:247], v[140:143], a[196:199], v[244:247]
    v_permlane32_swap_b32 v192, v193
    v_mfma_f32_16x16x32_bf16 v[232:235], v[144:147], a[152:155], v[232:235]
    ds_read_b128 a[176:179], v32 offset:17408
    v_permlane32_swap_b32 v194, v195
    v_mfma_f32_16x16x32_bf16 v[236:239], v[148:151], a[152:155], v[236:239]
    s_waitcnt lgkmcnt(3)
    buffer_store_dwordx4 v[208:211], v28, s[12:15], s80 offen sc1
    ds_write_b128 v37, v[192:195] offset:18432
    v_mfma_f32_16x16x32_bf16 v[240:243], v[144:147], a[156:159], v[240:243]
    ds_read_b128 a[180:183], v32 offset:25600
    v_cvt_pk_bf16_f32 v200, v224, v228
    v_mfma_f32_16x16x32_bf16 v[244:247], v[148:151], a[156:159], v[244:247]
    v_cvt_pk_bf16_f32 v202, v225, v229
    v_mfma_f32_16x16x32_bf16 v[232:235], v[152:155], a[160:163], v[232:235]
    ds_read_b128 a[184:187], v31 offset:18432
    v_cvt_pk_bf16_f32 v201, v226, v230
    v_mfma_f32_16x16x32_bf16 v[236:239], v[156:159], a[160:163], v[236:239]
    v_cvt_pk_bf16_f32 v203, v227, v231
    v_permlane32_swap_b32 v200, v201
    v_mfma_f32_16x16x32_bf16 v[240:243], v[152:155], a[164:167], v[240:243]
    ds_read_b128 a[188:191], v31 offset:26624
    s_cbranch_execz L_ret
    v_permlane32_swap_b32 v202, v203
    v_mfma_f32_16x16x32_bf16 v[244:247], v[156:159], a[164:167], v[244:247]
    s_waitcnt lgkmcnt(5)
    ds_write_b128 v37, v[200:203] offset:0
    v_mfma_f32_16x16x32_bf16 v[232:235], v[160:163], a[168:171], v[232:235]
    ds_read_b128 a[192:195], v32 offset:18432
    v_mfma_f32_16x16x32_bf16 v[236:239], v[164:167], a[168:171], v[236:239]
    v_mfma_f32_16x16x32_bf16 v[240:243], v[160:163], a[172:175], v[240:243]
    ds_read_b128 a[196:199], v32 offset:26624
    v_mfma_f32_16x16x32_bf16 v[244:247], v[164:167], a[172:175], v[244:247]
    s_waitcnt lgkmcnt(5)
    v_mfma_f32_16x16x32_bf16 v[232:235], v[168:171], a[176:179], v[232:235]
    s_waitcnt vmcnt(12)
    s_waitcnt lgkmcnt(2)
    s_barrier
    ds_read_b128 a[152:155], v33 offset:32768
    v_mfma_f32_16x16x32_bf16 v[236:239], v[172:175], a[176:179], v[236:239]
    ds_read_b128 v[212:215], v38 offset:17408
    v_mfma_f32_16x16x32_bf16 v[240:243], v[168:171], a[180:183], v[240:243]
    ds_read_b128 a[156:159], v34 offset:32768
    ds_read_b128 v[216:219], v38 offset:18432
    v_mfma_f32_16x16x32_bf16 v[244:247], v[172:175], a[180:183], v[244:247]
    v_mfma_f32_16x16x32_bf16 v[232:235], v[176:179], a[184:187], v[232:235]
    ds_read_b128 a[160:163], v33 offset:33792
    s_waitcnt lgkmcnt(3)
    buffer_store_dwordx4 v[212:215], v28, s[12:15], s81 offen sc1
    v_mfma_f32_16x16x32_bf16 v[236:239], v[180:183], a[184:187], v[236:239]
    v_mfma_f32_16x16x32_bf16 v[240:243], v[176:179], a[188:191], v[240:243]
    ds_read_b128 a[164:167], v34 offset:33792
    ds_read_b128 v[220:223], v38 offset:0
    v_mfma_f32_16x16x32_bf16 v[244:247], v[180:183], a[188:191], v[244:247]
    v_mfma_f32_16x16x32_bf16 v[232:235], v[184:187], a[192:195], v[232:235]
    ds_read_b128 a[168:171], v33 offset:34816
    s_waitcnt lgkmcnt(4)
    buffer_store_dwordx4 v[216:219], v28, s[12:15], s82 offen sc1
    s_nop 0
    s_cbranch_execz L_ret
    v_mfma_f32_16x16x32_bf16 v[236:239], v[188:191], a[192:195], v[236:239]
    v_mfma_f32_16x16x32_bf16 v[240:243], v[184:187], a[196:199], v[240:243]
    ds_read_b128 a[172:175], v34 offset:34816
    v_mfma_f32_16x16x32_bf16 v[244:247], v[188:191], a[196:199], v[244:247]
    v_mfma_f32_16x16x32_bf16 v[248:251], v[48:51], a[152:155], 0
    ds_read_b128 a[176:179], v33 offset:35840
    s_nop 2
    v_cvt_pk_bf16_f32 v192, v232, v236
    v_mfma_f32_16x16x32_bf16 v[252:255], v[52:55], a[152:155], 0
    v_cvt_pk_bf16_f32 v194, v233, v237
    v_cvt_pk_bf16_f32 v193, v234, v238
    v_mfma_f32_16x16x32_bf16 v[248:251], v[56:59], a[156:159], v[248:251]
    ds_read_b128 a[180:183], v34 offset:35840
    v_cvt_pk_bf16_f32 v195, v235, v239
    v_mfma_f32_16x16x32_bf16 v[252:255], v[60:63], a[156:159], v[252:255]
    s_waitcnt lgkmcnt(5)
    s_waitcnt lgkmcnt(4)
    buffer_store_dwordx4 v[220:223], v28, s[12:15], s83 offen sc1
    v_mfma_f32_16x16x32_bf16 v[248:251], v[64:67], a[160:163], v[248:251]
    ds_read_b128 a[184:187], v35 offset:0
    v_permlane32_swap_b32 v192, v193
    v_mfma_f32_16x16x32_bf16 v[252:255], v[68:71], a[160:163], v[252:255]
    v_permlane32_swap_b32 v194, v195
    ds_write_b128 v37, v[192:195] offset:19456
    v_mfma_f32_16x16x32_bf16 v[248:251], v[72:75], a[164:167], v[248:251]
    ds_read_b128 a[188:191], v36 offset:0
    v_mfma_f32_16x16x32_bf16 v[252:255], v[76:79], a[164:167], v[252:255]
    s_waitcnt lgkmcnt(5)
    v_mfma_f32_16x16x32_bf16 v[248:251], v[80:83], a[168:171], v[248:251]
    ds_read_b128 a[192:195], v35 offset:1024
    v_cvt_pk_bf16_f32 v200, v240, v244
    v_mfma_f32_16x16x32_bf16 v[252:255], v[84:87], a[168:171], v[252:255]
    v_cvt_pk_bf16_f32 v202, v241, v245
    v_mfma_f32_16x16x32_bf16 v[248:251], v[88:91], a[172:175], v[248:251]
    s_nop 0
    s_cbranch_execz L_ret
    ds_read_b128 a[196:199], v36 offset:1024
    v_cvt_pk_bf16_f32 v201, v242, v246
    v_mfma_f32_16x16x32_bf16 v[252:255], v[92:95], a[172:175], v[252:255]
    s_waitcnt lgkmcnt(5)
    v_cvt_pk_bf16_f32 v203, v243, v247
    v_mfma_f32_16x16x32_bf16 v[248:251], v[96:99], a[176:179], v[248:251]
    ds_read_b128 a[152:155], v35 offset:2048
    v_permlane32_swap_b32 v200, v201
    v_mfma_f32_16x16x32_bf16 v[252:255], v[100:103], a[176:179], v[252:255]
    v_permlane32_swap_b32 v202, v203
    ds_write_b128 v37, v[200:203] offset:1024
    v_mfma_f32_16x16x32_bf16 v[248:251], v[104:107], a[180:183], v[248:251]
    ds_read_b128 a[156:159], v36 offset:2048
    v_mfma_f32_16x16x32_bf16 v[252:255], v[108:111], a[180:183], v[252:255]
    s_waitcnt lgkmcnt(5)
    v_mfma_f32_16x16x32_bf16 v[248:251], v[112:115], a[184:187], v[248:251]
    s_waitcnt vmcnt(13)
    s_waitcnt lgkmcnt(1)
    s_barrier
    ds_read_b128 a[160:163], v35 offset:3072
    v_mfma_f32_16x16x32_bf16 v[252:255], v[116:119], a[184:187], v[252:255]
    ds_read_b128 v[208:211], v38 offset:19456
    v_mfma_f32_16x16x32_bf16 v[248:251], v[120:123], a[188:191], v[248:251]
    ds_read_b128 a[164:167], v36 offset:3072
    ds_read_b128 v[212:215], v38 offset:1024
    v_mfma_f32_16x16x32_bf16 v[252:255], v[124:127], a[188:191], v[252:255]
    v_mfma_f32_16x16x32_bf16 v[248:251], v[128:131], a[192:195], v[248:251]
    ds_read_b128 a[168:171], v35 offset:16384
    s_waitcnt lgkmcnt(3)
    buffer_store_dwordx4 v[208:211], v28, s[12:15], s84 offen sc1
    v_mfma_f32_16x16x32_bf16 v[252:255], v[132:135], a[192:195], v[252:255]
    v_mfma_f32_16x16x32_bf16 v[248:251], v[136:139], a[196:199], v[248:251]
    ds_read_b128 a[172:175], v36 offset:16384
    v_mfma_f32_16x16x32_bf16 v[252:255], v[140:143], a[196:199], v[252:255]
    v_mfma_f32_16x16x32_bf16 v[248:251], v[144:147], a[152:155], v[248:251]
    s_waitcnt lgkmcnt(2)
    s_cbranch_execz L_ret
    buffer_store_dwordx4 v[212:215], v28, s[12:15], s85 offen sc1
    v_mfma_f32_16x16x32_bf16 v[252:255], v[148:151], a[152:155], v[252:255]
    v_mfma_f32_16x16x32_bf16 v[248:251], v[152:155], a[156:159], v[248:251]
    v_mfma_f32_16x16x32_bf16 v[252:255], v[156:159], a[156:159], v[252:255]
    v_mfma_f32_16x16x32_bf16 v[248:251], v[160:163], a[160:163], v[248:251]
    v_mfma_f32_16x16x32_bf16 v[252:255], v[164:167], a[160:163], v[252:255]
    v_mfma_f32_16x16x32_bf16 v[248:251], v[168:171], a[164:167], v[248:251]
    v_mfma_f32_16x16x32_bf16 v[252:255], v[172:175], a[164:167], v[252:255]
    s_waitcnt lgkmcnt(0)
    v_mfma_f32_16x16x32_bf16 v[248:251], v[176:179], a[168:171], v[248:251]
    v_mfma_f32_16x16x32_bf16 v[252:255], v[180:183], a[168:171], v[252:255]
    v_mfma_f32_16x16x32_bf16 v[248:251], v[184:187], a[172:175], v[248:251]
    v_mfma_f32_16x16x32_bf16 v[252:255], v[188:191], a[172:175], v[252:255]
    s_nop 7
    v_cvt_pk_bf16_f32 v192, v248, v252
    v_cvt_pk_bf16_f32 v194, v249, v253
    v_cvt_pk_bf16_f32 v193, v250, v254
    v_cvt_pk_bf16_f32 v195, v251, v255
    s_nop 0
    v_permlane32_swap_b32 v192, v193
    v_permlane32_swap_b32 v194, v195
    ds_write_b128 v37, v[192:195] offset:2048
    s_waitcnt lgkmcnt(0)
    s_barrier
    ds_read_b128 v[216:219], v38 offset:2048
    s_waitcnt lgkmcnt(0)
    buffer_store_dwordx4 v[216:219], v28, s[12:15], s86 offen sc1
    s_endpgm
L_general:
    s_waitcnt vmcnt(13)
    v_cvt_f32_i32 v64, v64
    v_cvt_f32_i32 v68, v68
    v_add_f32 v64, v64, v24
    v_add_f32 v68, v68, v24
    v_cvt_pk_bf16_f32 v64, v64, v68
    v_and_b32 v68, 0xffff0000, v64
    v_lshlrev_b32 v64, 16, v64
    v_mul_f32 v64, v64, v20
    v_mul_f32 v68, v68, v20
    v_cvt_pk_bf16_f32 v64, v64, v68
    v_cvt_f32_i32 v65, v65
    buffer_load_dwordx4 v[96:99], v4, s[8:11], s50 offen
    v_cvt_f32_i32 v69, v69
    v_add_f32 v65, v65, v25
    v_add_f32 v69, v69, v25
    v_cvt_pk_bf16_f32 v65, v65, v69
    v_and_b32 v69, 0xffff0000, v65
    v_lshlrev_b32 v65, 16, v65
    v_mul_f32 v65, v65, v21
    v_mul_f32 v69, v69, v21
    v_cvt_pk_bf16_f32 v65, v65, v69
    v_cvt_f32_i32 v66, v66
    v_cvt_f32_i32 v70, v70
    v_add_f32 v66, v66, v26
    v_add_f32 v70, v70, v26
    v_cvt_pk_bf16_f32 v66, v66, v70
    v_and_b32 v70, 0xffff0000, v66
    v_lshlrev_b32 v66, 16, v66
    v_mul_f32 v66, v66, v22
    v_mul_f32 v70, v70, v22
    v_cvt_pk_bf16_f32 v66, v66, v70
    v_cvt_f32_i32 v67, v67
    v_cvt_f32_i32 v71, v71
    v_add_f32 v67, v67, v27
    buffer_load_dwordx4 v[100:103], v5, s[8:11], s50 offen
    v_add_f32 v71, v71, v27
    v_cvt_pk_bf16_f32 v67, v67, v71
    v_and_b32 v71, 0xffff0000, v67
    v_lshlrev_b32 v67, 16, v67
    v_mul_f32 v67, v67, v23
    v_mul_f32 v71, v71, v23
    v_cvt_pk_bf16_f32 v67, v67, v71
    s_waitcnt vmcnt(13)
    v_cvt_f32_i32 v72, v72
    v_cvt_f32_i32 v76, v76
    v_add_f32 v72, v72, v24
    v_add_f32 v76, v76, v24
    v_cvt_pk_bf16_f32 v72, v72, v76
    v_and_b32 v76, 0xffff0000, v72
    v_lshlrev_b32 v72, 16, v72
    v_mul_f32 v72, v72, v20
    v_mul_f32 v76, v76, v20
    v_cvt_pk_bf16_f32 v72, v72, v76
    v_cvt_f32_i32 v73, v73
    v_cvt_f32_i32 v77, v77
    v_add_f32 v73, v73, v25
    v_add_f32 v77, v77, v25
    v_cvt_pk_bf16_f32 v73, v73, v77
    buffer_load_dwordx4 v[104:107], v6, s[8:11], s50 offen
    v_and_b32 v77, 0xffff0000, v73
    v_lshlrev_b32 v73, 16, v73
    v_mul_f32 v73, v73, v21
    v_mul_f32 v77, v77, v21
    v_cvt_pk_bf16_f32 v73, v73, v77
    v_cvt_f32_i32 v74, v74
    v_cvt_f32_i32 v78, v78
    v_add_f32 v74, v74, v26
    v_add_f32 v78, v78, v26
    v_cvt_pk_bf16_f32 v74, v74, v78
    v_and_b32 v78, 0xffff0000, v74
    v_lshlrev_b32 v74, 16, v74
    v_mul_f32 v74, v74, v22
    v_mul_f32 v78, v78, v22
    v_cvt_pk_bf16_f32 v74, v74, v78
    v_cvt_f32_i32 v75, v75
    v_cvt_f32_i32 v79, v79
    v_add_f32 v75, v75, v27
    v_add_f32 v79, v79, v27
    v_cvt_pk_bf16_f32 v75, v75, v79
    v_and_b32 v79, 0xffff0000, v75
    v_lshlrev_b32 v75, 16, v75
    buffer_load_dwordx4 v[108:111], v7, s[8:11], s50 offen
    v_mul_f32 v75, v75, v23
    v_mul_f32 v79, v79, v23
    v_cvt_pk_bf16_f32 v75, v75, v79
    s_waitcnt vmcnt(13)
    v_cvt_f32_i32 v80, v80
    v_cvt_f32_i32 v84, v84
    v_add_f32 v80, v80, v24
    v_add_f32 v84, v84, v24
    v_cvt_pk_bf16_f32 v80, v80, v84
    v_and_b32 v84, 0xffff0000, v80
    v_lshlrev_b32 v80, 16, v80
    v_mul_f32 v80, v80, v20
    v_mul_f32 v84, v84, v20
    v_cvt_pk_bf16_f32 v80, v80, v84
    v_cvt_f32_i32 v81, v81
    v_cvt_f32_i32 v85, v85
    v_add_f32 v81, v81, v25
    v_add_f32 v85, v85, v25
    v_cvt_pk_bf16_f32 v81, v81, v85
    v_and_b32 v85, 0xffff0000, v81
    v_lshlrev_b32 v81, 16, v81
    v_mul_f32 v81, v81, v21
    v_mul_f32 v85, v85, v21
    buffer_load_dwordx4 v[112:115], v8, s[8:11], s50 offen
    v_cvt_pk_bf16_f32 v81, v81, v85
    v_cvt_f32_i32 v82, v82
    v_cvt_f32_i32 v86, v86
    v_add_f32 v82, v82, v26
    v_add_f32 v86, v86, v26
    v_cvt_pk_bf16_f32 v82, v82, v86
    v_and_b32 v86, 0xffff0000, v82
    v_lshlrev_b32 v82, 16, v82
    v_mul_f32 v82, v82, v22
    v_mul_f32 v86, v86, v22
    v_cvt_pk_bf16_f32 v82, v82, v86
    v_cvt_f32_i32 v83, v83
    v_cvt_f32_i32 v87, v87
    v_add_f32 v83, v83, v27
    v_add_f32 v87, v87, v27
    v_cvt_pk_bf16_f32 v83, v83, v87
    v_and_b32 v87, 0xffff0000, v83
    v_lshlrev_b32 v83, 16, v83
    v_mul_f32 v83, v83, v23
    v_mul_f32 v87, v87, v23
    v_cvt_pk_bf16_f32 v83, v83, v87
    s_waitcnt vmcnt(12)
    v_cvt_f32_i32 v88, v88
    buffer_load_dwordx4 v[116:119], v9, s[8:11], s50 offen
    v_cvt_f32_i32 v92, v92
    v_add_f32 v88, v88, v24
    v_add_f32 v92, v92, v24
    v_cvt_pk_bf16_f32 v88, v88, v92
    v_and_b32 v92, 0xffff0000, v88
    v_lshlrev_b32 v88, 16, v88
    v_mul_f32 v88, v88, v20
    v_mul_f32 v92, v92, v20
    v_cvt_pk_bf16_f32 v88, v88, v92
    v_cvt_f32_i32 v89, v89
    v_cvt_f32_i32 v93, v93
    v_add_f32 v89, v89, v25
    v_add_f32 v93, v93, v25
    v_cvt_pk_bf16_f32 v89, v89, v93
    v_and_b32 v93, 0xffff0000, v89
    v_lshlrev_b32 v89, 16, v89
    v_mul_f32 v89, v89, v21
    v_mul_f32 v93, v93, v21
    v_cvt_pk_bf16_f32 v89, v89, v93
    v_cvt_f32_i32 v90, v90
    v_cvt_f32_i32 v94, v94
    v_add_f32 v90, v90, v26
    buffer_load_dwordx4 v[120:123], v10, s[8:11], s50 offen
    v_add_f32 v94, v94, v26
    v_cvt_pk_bf16_f32 v90, v90, v94
    v_and_b32 v94, 0xffff0000, v90
    v_lshlrev_b32 v90, 16, v90
    v_mul_f32 v90, v90, v22
    v_mul_f32 v94, v94, v22
    v_cvt_pk_bf16_f32 v90, v90, v94
    v_cvt_f32_i32 v91, v91
    v_cvt_f32_i32 v95, v95
    v_add_f32 v91, v91, v27
    v_add_f32 v95, v95, v27
    v_cvt_pk_bf16_f32 v91, v91, v95
    v_and_b32 v95, 0xffff0000, v91
    v_lshlrev_b32 v91, 16, v91
    v_mul_f32 v91, v91, v23
    v_mul_f32 v95, v95, v23
    v_cvt_pk_bf16_f32 v91, v91, v95
    s_not_b64 vcc, vcc
    v_cndmask_b32_dpp v48, v66, v64, vcc row_ror:8 row_mask:0xf bank_mask:0xf
    v_cndmask_b32_dpp v49, v74, v72, vcc row_ror:8 row_mask:0xf bank_mask:0xf
    v_cndmask_b32_dpp v50, v82, v80, vcc row_ror:8 row_mask:0xf bank_mask:0xf
    v_cndmask_b32_dpp v51, v90, v88, vcc row_ror:8 row_mask:0xf bank_mask:0xf
    v_cndmask_b32_dpp v52, v67, v65, vcc row_ror:8 row_mask:0xf bank_mask:0xf
    buffer_load_dwordx4 v[124:127], v11, s[8:11], s50 offen
    v_cndmask_b32_dpp v53, v75, v73, vcc row_ror:8 row_mask:0xf bank_mask:0xf
    v_cndmask_b32_dpp v54, v83, v81, vcc row_ror:8 row_mask:0xf bank_mask:0xf
    v_cndmask_b32_dpp v55, v91, v89, vcc row_ror:8 row_mask:0xf bank_mask:0xf
    s_not_b64 vcc, vcc
    v_cndmask_b32_dpp v56, v64, v66, vcc row_ror:8 row_mask:0xf bank_mask:0xf
    v_cndmask_b32_dpp v57, v72, v74, vcc row_ror:8 row_mask:0xf bank_mask:0xf
    v_cndmask_b32_dpp v58, v80, v82, vcc row_ror:8 row_mask:0xf bank_mask:0xf
    v_cndmask_b32_dpp v59, v88, v90, vcc row_ror:8 row_mask:0xf bank_mask:0xf
    v_cndmask_b32_dpp v60, v65, v67, vcc row_ror:8 row_mask:0xf bank_mask:0xf
    v_cndmask_b32_dpp v61, v73, v75, vcc row_ror:8 row_mask:0xf bank_mask:0xf
    v_cndmask_b32_dpp v62, v81, v83, vcc row_ror:8 row_mask:0xf bank_mask:0xf
    v_cndmask_b32_dpp v63, v89, v91, vcc row_ror:8 row_mask:0xf bank_mask:0xf
    s_waitcnt vmcnt(8)
    s_barrier
    ds_read_b128 a[152:155], v29 offset:0
    ds_read_b128 a[156:159], v29 offset:8192
    ds_read_b128 a[160:163], v29 offset:1024
    ds_read_b128 a[164:167], v29 offset:9216
    ds_read_b128 a[168:171], v29 offset:2048
    ds_read_b128 a[172:175], v29 offset:10240
    s_waitcnt lgkmcnt(4)
    s_waitcnt vmcnt(6)
    v_cvt_f32_i32 v96, v96
    s_add_u32 m0, s67, 32768
    v_add_u32 v14, s59, v12
    buffer_load_dwordx4 v14, s[4:7], s38 offen offset:0 lds
    v_mfma_f32_16x16x32_bf16 a[0:3], v[48:51], a[152:155], 0
    ds_read_b128 a[176:179], v29 offset:3072
    buffer_load_dwordx4 v14, s[4:7], s39 offen offset:1024 lds
    buffer_load_dwordx4 v14, s[4:7], s40 offen offset:2048 lds
    v_mfma_f32_16x16x32_bf16 a[4:7], v[52:55], a[152:155], 0
    buffer_load_dwordx4 v14, s[4:7], s41 offen offset:3072 lds
    s_add_u32 m0, s67, 49152
    s_nop 0
    buffer_load_dwordx4 v14, s[4:7], s42 offen offset:0 lds
    buffer_load_dwordx4 v14, s[4:7], s43 offen offset:1024 lds
    v_mfma_f32_16x16x32_bf16 a[8:11], v[48:51], a[156:159], 0
    ds_read_b128 a[180:183], v29 offset:11264
    buffer_load_dwordx4 v14, s[4:7], s44 offen offset:2048 lds
    v_cvt_f32_i32 v100, v100
    v_add_f32 v96, v96, v24
    v_mfma_f32_16x16x32_bf16 a[12:15], v[52:55], a[156:159], 0
    s_waitcnt lgkmcnt(4)
    v_add_f32 v100, v100, v24
    s_add_u32 m0, s67, 65536
    v_add_u32 v14, s60, v12
    buffer_load_dwordx4 v14, s[4:7], s38 offen offset:0 lds
    v_mfma_f32_16x16x32_bf16 a[16:19], v[48:51], a[160:163], 0
    ds_read_b128 a[184:187], v29 offset:16384
    v_cvt_pk_bf16_f32 v96, v96, v100
    v_and_b32 v100, 0xffff0000, v96
    v_lshlrev_b32 v96, 16, v96
    v_mfma_f32_16x16x32_bf16 a[20:23], v[52:55], a[160:163], 0
    v_mul_f32 v96, v96, v20
    v_mul_f32 v100, v100, v20
    v_cvt_pk_bf16_f32 v96, v96, v100
    v_cvt_f32_i32 v97, v97
    v_mfma_f32_16x16x32_bf16 a[24:27], v[48:51], a[164:167], 0
    ds_read_b128 a[188:191], v29 offset:24576
    v_cvt_f32_i32 v101, v101
    buffer_load_dwordx4 v[128:131], v4, s[8:11], s51 offen
    v_add_f32 v97, v97, v25
    v_mfma_f32_16x16x32_bf16 a[28:31], v[52:55], a[164:167], 0
    s_waitcnt lgkmcnt(4)
    v_add_f32 v101, v101, v25
    v_cvt_pk_bf16_f32 v97, v97, v101
    v_and_b32 v101, 0xffff0000, v97
    v_mfma_f32_16x16x32_bf16 a[32:35], v[48:51], a[168:171], 0
    ds_read_b128 a[192:195], v29 offset:17408
    v_lshlrev_b32 v97, 16, v97
    v_mul_f32 v97, v97, v21
    v_mul_f32 v101, v101, v21
    v_mfma_f32_16x16x32_bf16 a[36:39], v[52:55], a[168:171], 0
    v_cvt_pk_bf16_f32 v97, v97, v101
    v_cvt_f32_i32 v98, v98
    v_cvt_f32_i32 v102, v102
    v_add_f32 v98, v98, v26
    v_mfma_f32_16x16x32_bf16 a[40:43], v[48:51], a[172:175], 0
    ds_read_b128 a[196:199], v29 offset:25600
    v_add_f32 v102, v102, v26
    v_cvt_pk_bf16_f32 v98, v98, v102
    v_and_b32 v102, 0xffff0000, v98
    v_mfma_f32_16x16x32_bf16 a[44:47], v[52:55], a[172:175], 0
    s_waitcnt lgkmcnt(4)
    v_lshlrev_b32 v98, 16, v98
    v_mul_f32 v98, v98, v22
    v_mul_f32 v102, v102, v22
    v_mfma_f32_16x16x32_bf16 a[48:51], v[48:51], a[176:179], 0
    ds_read_b128 a[152:155], v29 offset:18432
    v_cvt_pk_bf16_f32 v98, v98, v102
    buffer_load_dwordx4 v14, s[4:7], s39 offen offset:1024 lds
    v_cvt_f32_i32 v99, v99
    v_mfma_f32_16x16x32_bf16 a[52:55], v[52:55], a[176:179], 0
    v_cvt_f32_i32 v103, v103
    v_add_f32 v99, v99, v27
    v_add_f32 v103, v103, v27
    v_cvt_pk_bf16_f32 v99, v99, v103
    v_mfma_f32_16x16x32_bf16 a[56:59], v[48:51], a[180:183], 0
    ds_read_b128 a[156:159], v29 offset:26624
    buffer_load_dwordx4 v[132:135], v5, s[8:11], s51 offen
    v_and_b32 v103, 0xffff0000, v99
    v_lshlrev_b32 v99, 16, v99
    v_mfma_f32_16x16x32_bf16 a[60:63], v[52:55], a[180:183], 0
    s_waitcnt lgkmcnt(4)
    v_mul_f32 v99, v99, v23
    v_mul_f32 v103, v103, v23
    v_cvt_pk_bf16_f32 v99, v99, v103
    v_mfma_f32_16x16x32_bf16 a[64:67], v[48:51], a[184:187], 0
    ds_read_b128 a[160:163], v30 offset:0
    s_waitcnt vmcnt(15)
    v_cvt_f32_i32 v104, v104
    v_cvt_f32_i32 v108, v108
    v_add_f32 v104, v104, v24
    v_mfma_f32_16x16x32_bf16 a[68:71], v[52:55], a[184:187], 0
    v_add_f32 v108, v108, v24
    v_cvt_pk_bf16_f32 v104, v104, v108
    v_and_b32 v108, 0xffff0000, v104
    v_lshlrev_b32 v104, 16, v104
    v_mfma_f32_16x16x32_bf16 a[72:75], v[48:51], a[188:191], 0
    ds_read_b128 a[164:167], v30 offset:8192
    v_mul_f32 v104, v104, v20
    v_mul_f32 v108, v108, v20
    v_cvt_pk_bf16_f32 v104, v104, v108
    v_mfma_f32_16x16x32_bf16 a[76:79], v[52:55], a[188:191], 0
    s_waitcnt lgkmcnt(4)
    v_cvt_f32_i32 v105, v105
    v_cvt_f32_i32 v109, v109
    v_add_f32 v105, v105, v25
    v_mfma_f32_16x16x32_bf16 a[80:83], v[48:51], a[192:195], 0
    ds_read_b128 a[168:171], v30 offset:1024
    v_add_f32 v109, v109, v25
    v_cvt_pk_bf16_f32 v105, v105, v109
    v_and_b32 v109, 0xffff0000, v105
    v_mfma_f32_16x16x32_bf16 a[84:87], v[52:55], a[192:195], 0
    v_lshlrev_b32 v105, 16, v105
    buffer_load_dwordx4 v14, s[4:7], s40 offen offset:2048 lds
    v_mul_f32 v105, v105, v21
    v_mul_f32 v109, v109, v21
    v_mfma_f32_16x16x32_bf16 a[88:91], v[48:51], a[196:199], 0
    ds_read_b128 a[172:175], v30 offset:9216
    buffer_load_dwordx4 v[136:139], v6, s[8:11], s51 offen
    v_cvt_pk_bf16_f32 v105, v105, v109
    v_cvt_f32_i32 v106, v106
    v_mfma_f32_16x16x32_bf16 a[92:95], v[52:55], a[196:199], 0
    s_waitcnt lgkmcnt(4)
    v_cvt_f32_i32 v110, v110
    v_add_f32 v106, v106, v26
    v_add_f32 v110, v110, v26
    v_mfma_f32_16x16x32_bf16 a[96:99], v[48:51], a[152:155], 0
    ds_read_b128 a[176:179], v30 offset:2048
    v_cvt_pk_bf16_f32 v106, v106, v110
    v_and_b32 v110, 0xffff0000, v106
    v_lshlrev_b32 v106, 16, v106
    v_mfma_f32_16x16x32_bf16 a[100:103], v[52:55], a[152:155], 0
    v_mul_f32 v106, v106, v22
    v_mul_f32 v110, v110, v22
    v_cvt_pk_bf16_f32 v106, v106, v110
    v_cvt_f32_i32 v107, v107
    v_mfma_f32_16x16x32_bf16 a[104:107], v[48:51], a[156:159], 0
    ds_read_b128 a[180:183], v30 offset:10240
    v_cvt_f32_i32 v111, v111
    v_add_f32 v107, v107, v27
    v_add_f32 v111, v111, v27
    v_mfma_f32_16x16x32_bf16 a[108:111], v[52:55], a[156:159], 0
    s_waitcnt lgkmcnt(4)
    v_cvt_pk_bf16_f32 v107, v107, v111
    v_and_b32 v111, 0xffff0000, v107
    v_lshlrev_b32 v107, 16, v107
    v_mfma_f32_16x16x32_bf16 a[0:3], v[56:59], a[160:163], a[0:3]
    ds_read_b128 a[184:187], v30 offset:3072
    v_mul_f32 v107, v107, v23
    v_mul_f32 v111, v111, v23
    v_cvt_pk_bf16_f32 v107, v107, v111
    v_mfma_f32_16x16x32_bf16 a[4:7], v[60:63], a[160:163], a[4:7]
    s_waitcnt vmcnt(15)
    v_cvt_f32_i32 v112, v112
    v_cvt_f32_i32 v116, v116
    buffer_load_dwordx4 v[140:143], v7, s[8:11], s51 offen
    v_add_f32 v112, v112, v24
    v_mfma_f32_16x16x32_bf16 a[8:11], v[56:59], a[164:167], a[8:11]
    ds_read_b128 a[188:191], v30 offset:11264
    v_add_f32 v116, v116, v24
    buffer_load_dwordx4 v14, s[4:7], s41 offen offset:3072 lds
    v_cvt_pk_bf16_f32 v112, v112, v116
    v_mfma_f32_16x16x32_bf16 a[12:15], v[60:63], a[164:167], a[12:15]
    s_waitcnt lgkmcnt(4)
    v_and_b32 v116, 0xffff0000, v112
    v_lshlrev_b32 v112, 16, v112
    v_mul_f32 v112, v112, v20
    v_mfma_f32_16x16x32_bf16 a[16:19], v[56:59], a[168:171], a[16:19]
    ds_read_b128 a[192:195], v30 offset:16384
    v_mul_f32 v116, v116, v20
    v_cvt_pk_bf16_f32 v112, v112, v116
    v_cvt_f32_i32 v113, v113
    v_mfma_f32_16x16x32_bf16 a[20:23], v[60:63], a[168:171], a[20:23]
    v_cvt_f32_i32 v117, v117
    v_add_f32 v113, v113, v25
    v_add_f32 v117, v117, v25
    v_cvt_pk_bf16_f32 v113, v113, v117
    v_mfma_f32_16x16x32_bf16 a[24:27], v[56:59], a[172:175], a[24:27]
    ds_read_b128 a[196:199], v30 offset:24576
    v_and_b32 v117, 0xffff0000, v113
    v_lshlrev_b32 v113, 16, v113
    v_mul_f32 v113, v113, v21
    v_mfma_f32_16x16x32_bf16 a[28:31], v[60:63], a[172:175], a[28:31]
    s_waitcnt lgkmcnt(4)
    v_mul_f32 v117, v117, v21
    v_cvt_pk_bf16_f32 v113, v113, v117
    v_cvt_f32_i32 v114, v114
    v_mfma_f32_16x16x32_bf16 a[32:35], v[56:59], a[176:179], a[32:35]
    ds_read_b128 a[152:155], v30 offset:17408
    v_cvt_f32_i32 v118, v118
    v_add_f32 v114, v114, v26
    v_add_f32 v118, v118, v26
    v_mfma_f32_16x16x32_bf16 a[36:39], v[60:63], a[176:179], a[36:39]
    v_cvt_pk_bf16_f32 v114, v114, v118
    buffer_load_dwordx4 v[144:147], v8, s[8:11], s51 offen
    v_and_b32 v118, 0xffff0000, v114
    v_lshlrev_b32 v114, 16, v114
    v_mfma_f32_16x16x32_bf16 a[40:43], v[56:59], a[180:183], a[40:43]
    ds_read_b128 a[156:159], v30 offset:25600
    v_mul_f32 v114, v114, v22
    v_mul_f32 v118, v118, v22
    v_cvt_pk_bf16_f32 v114, v114, v118
    v_mfma_f32_16x16x32_bf16 a[44:47], v[60:63], a[180:183], a[44:47]
    s_waitcnt lgkmcnt(4)
    s_add_u32 m0, s67, 81920
    s_nop 0
    buffer_load_dwordx4 v14, s[4:7], s42 offen offset:0 lds
    v_cvt_f32_i32 v115, v115
    v_mfma_f32_16x16x32_bf16 a[48:51], v[56:59], a[184:187], a[48:51]
    ds_read_b128 a[160:163], v30 offset:18432
    v_cvt_f32_i32 v119, v119
    v_add_f32 v115, v115, v27
    v_add_f32 v119, v119, v27
    v_mfma_f32_16x16x32_bf16 a[52:55], v[60:63], a[184:187], a[52:55]
    v_cvt_pk_bf16_f32 v115, v115, v119
    v_and_b32 v119, 0xffff0000, v115
    v_lshlrev_b32 v115, 16, v115
    v_mul_f32 v115, v115, v23
    v_mfma_f32_16x16x32_bf16 a[56:59], v[56:59], a[188:191], a[56:59]
    ds_read_b128 a[164:167], v30 offset:26624
    v_mul_f32 v119, v119, v23
    v_cvt_pk_bf16_f32 v115, v115, v119
    s_waitcnt vmcnt(17)
    v_cvt_f32_i32 v120, v120
    v_mfma_f32_16x16x32_bf16 a[60:63], v[60:63], a[188:191], a[60:63]
    s_waitcnt lgkmcnt(4)
    v_cvt_f32_i32 v124, v124
    v_add_f32 v120, v120, v24
    v_add_f32 v124, v124, v24
    v_mfma_f32_16x16x32_bf16 a[64:67], v[56:59], a[192:195], a[64:67]
    s_waitcnt vmcnt(10)
    s_barrier
    ds_read_b128 a[168:171], v29 offset:32768
    v_cvt_pk_bf16_f32 v120, v120, v124
    v_mfma_f32_16x16x32_bf16 a[68:71], v[60:63], a[192:195], a[68:71]
    v_and_b32 v124, 0xffff0000, v120
    v_lshlrev_b32 v120, 16, v120
    v_mul_f32 v120, v120, v20
    buffer_load_dwordx4 v[148:151], v9, s[8:11], s51 offen
    v_mfma_f32_16x16x32_bf16 a[72:75], v[56:59], a[196:199], a[72:75]
    ds_read_b128 a[172:175], v29 offset:40960
    v_mul_f32 v124, v124, v20
    v_cvt_pk_bf16_f32 v120, v120, v124
    v_cvt_f32_i32 v121, v121
    v_mfma_f32_16x16x32_bf16 a[76:79], v[60:63], a[196:199], a[76:79]
    s_waitcnt lgkmcnt(4)
    v_cvt_f32_i32 v125, v125
    v_add_f32 v121, v121, v25
    v_add_f32 v125, v125, v25
    v_mfma_f32_16x16x32_bf16 a[80:83], v[56:59], a[152:155], a[80:83]
    ds_read_b128 a[176:179], v29 offset:33792
    v_cvt_pk_bf16_f32 v121, v121, v125
    v_and_b32 v125, 0xffff0000, v121
    v_lshlrev_b32 v121, 16, v121
    v_mfma_f32_16x16x32_bf16 a[84:87], v[60:63], a[152:155], a[84:87]
    buffer_load_dwordx4 v14, s[4:7], s43 offen offset:1024 lds
    v_mul_f32 v121, v121, v21
    v_mul_f32 v125, v125, v21
    v_cvt_pk_bf16_f32 v121, v121, v125
    v_mfma_f32_16x16x32_bf16 a[88:91], v[56:59], a[156:159], a[88:91]
    ds_read_b128 a[180:183], v29 offset:41984
    v_cvt_f32_i32 v122, v122
    v_cvt_f32_i32 v126, v126
    v_add_f32 v122, v122, v26
    v_mfma_f32_16x16x32_bf16 a[92:95], v[60:63], a[156:159], a[92:95]
    s_waitcnt lgkmcnt(4)
    v_add_f32 v126, v126, v26
    v_cvt_pk_bf16_f32 v122, v122, v126
    v_and_b32 v126, 0xffff0000, v122
    v_mfma_f32_16x16x32_bf16 a[96:99], v[56:59], a[160:163], a[96:99]
    ds_read_b128 a[184:187], v29 offset:34816
    v_lshlrev_b32 v122, 16, v122
    v_mul_f32 v122, v122, v22
    v_mul_f32 v126, v126, v22
    v_mfma_f32_16x16x32_bf16 a[100:103], v[60:63], a[160:163], a[100:103]
    v_cvt_pk_bf16_f32 v122, v122, v126
    v_cvt_f32_i32 v123, v123
    v_cvt_f32_i32 v127, v127
    buffer_load_dwordx4 v[152:155], v10, s[8:11], s51 offen
    v_mfma_f32_16x16x32_bf16 a[104:107], v[56:59], a[164:167], a[104:107]
    ds_read_b128 a[188:191], v29 offset:43008
    v_add_f32 v123, v123, v27
    v_add_f32 v127, v127, v27
    v_cvt_pk_bf16_f32 v123, v123, v127
    v_and_b32 v127, 0xffff0000, v123
    v_lshlrev_b32 v123, 16, v123
    v_mul_f32 v123, v123, v23
    v_mul_f32 v127, v127, v23
    v_cvt_pk_bf16_f32 v123, v123, v127
    s_not_b64 vcc, vcc
    v_cndmask_b32_dpp v64, v98, v96, vcc row_ror:8 row_mask:0xf bank_mask:0xf
    v_cndmask_b32_dpp v65, v106, v104, vcc row_ror:8 row_mask:0xf bank_mask:0xf
    v_cndmask_b32_dpp v66, v114, v112, vcc row_ror:8 row_mask:0xf bank_mask:0xf
    v_cndmask_b32_dpp v67, v122, v120, vcc row_ror:8 row_mask:0xf bank_mask:0xf
    v_cndmask_b32_dpp v68, v99, v97, vcc row_ror:8 row_mask:0xf bank_mask:0xf
    v_cndmask_b32_dpp v69, v107, v105, vcc row_ror:8 row_mask:0xf bank_mask:0xf
    v_cndmask_b32_dpp v70, v115, v113, vcc row_ror:8 row_mask:0xf bank_mask:0xf
    v_cndmask_b32_dpp v71, v123, v121, vcc row_ror:8 row_mask:0xf bank_mask:0xf
    buffer_load_dwordx4 v[156:159], v11, s[8:11], s51 offen
    v_mfma_f32_16x16x32_bf16 a[108:111], v[60:63], a[164:167], a[108:111]
    s_waitcnt lgkmcnt(4)
    buffer_load_dwordx4 v14, s[4:7], s44 offen offset:2048 lds
    s_not_b64 vcc, vcc
    v_cndmask_b32_dpp v72, v96, v98, vcc row_ror:8 row_mask:0xf bank_mask:0xf
    v_mfma_f32_16x16x32_bf16 a[0:3], v[64:67], a[168:171], a[0:3]
    ds_read_b128 a[192:195], v29 offset:35840
    v_cndmask_b32_dpp v73, v104, v106, vcc row_ror:8 row_mask:0xf bank_mask:0xf
    v_cndmask_b32_dpp v74, v112, v114, vcc row_ror:8 row_mask:0xf bank_mask:0xf
    v_cndmask_b32_dpp v75, v120, v122, vcc row_ror:8 row_mask:0xf bank_mask:0xf
    v_mfma_f32_16x16x32_bf16 a[4:7], v[68:71], a[168:171], a[4:7]
    v_cndmask_b32_dpp v76, v97, v99, vcc row_ror:8 row_mask:0xf bank_mask:0xf
    v_cndmask_b32_dpp v77, v105, v107, vcc row_ror:8 row_mask:0xf bank_mask:0xf
    v_cndmask_b32_dpp v78, v113, v115, vcc row_ror:8 row_mask:0xf bank_mask:0xf
    v_cndmask_b32_dpp v79, v121, v123, vcc row_ror:8 row_mask:0xf bank_mask:0xf
    v_mfma_f32_16x16x32_bf16 a[8:11], v[64:67], a[172:175], a[8:11]
    ds_read_b128 a[196:199], v29 offset:44032
    s_waitcnt vmcnt(11)
    v_cvt_f32_i32 v128, v128
    v_cvt_f32_i32 v132, v132
    v_add_f32 v128, v128, v24
    v_mfma_f32_16x16x32_bf16 a[12:15], v[68:71], a[172:175], a[12:15]
    s_waitcnt lgkmcnt(4)
    v_add_f32 v132, v132, v24
    s_add_u32 m0, s67, 98304
    v_add_u32 v14, s61, v12
    buffer_load_dwordx4 v14, s[4:7], s38 offen offset:0 lds
    v_mfma_f32_16x16x32_bf16 a[16:19], v[64:67], a[176:179], a[16:19]
    ds_read_b128 a[152:155], v29 offset:49152
    v_cvt_pk_bf16_f32 v128, v128, v132
    v_and_b32 v132, 0xffff0000, v128
    v_lshlrev_b32 v128, 16, v128
    v_mfma_f32_16x16x32_bf16 a[20:23], v[68:71], a[176:179], a[20:23]
    v_mul_f32 v128, v128, v20
    v_mul_f32 v132, v132, v20
    v_cvt_pk_bf16_f32 v128, v128, v132
    v_cvt_f32_i32 v129, v129
    v_mfma_f32_16x16x32_bf16 a[24:27], v[64:67], a[180:183], a[24:27]
    ds_read_b128 a[156:159], v29 offset:57344
    v_cvt_f32_i32 v133, v133
    buffer_load_dwordx4 v[160:163], v4, s[8:11], s52 offen
    v_add_f32 v129, v129, v25
    v_mfma_f32_16x16x32_bf16 a[28:31], v[68:71], a[180:183], a[28:31]
    s_waitcnt lgkmcnt(4)
    v_add_f32 v133, v133, v25
    v_cvt_pk_bf16_f32 v129, v129, v133
    v_and_b32 v133, 0xffff0000, v129
    v_mfma_f32_16x16x32_bf16 a[32:35], v[64:67], a[184:187], a[32:35]
    ds_read_b128 a[160:163], v29 offset:50176
    v_lshlrev_b32 v129, 16, v129
    v_mul_f32 v129, v129, v21
    v_mul_f32 v133, v133, v21
    v_mfma_f32_16x16x32_bf16 a[36:39], v[68:71], a[184:187], a[36:39]
    v_cvt_pk_bf16_f32 v129, v129, v133
    v_cvt_f32_i32 v130, v130
    v_cvt_f32_i32 v134, v134
    v_add_f32 v130, v130, v26
    v_mfma_f32_16x16x32_bf16 a[40:43], v[64:67], a[188:191], a[40:43]
    ds_read_b128 a[164:167], v29 offset:58368
    v_add_f32 v134, v134, v26
    v_cvt_pk_bf16_f32 v130, v130, v134
    v_and_b32 v134, 0xffff0000, v130
    v_mfma_f32_16x16x32_bf16 a[44:47], v[68:71], a[188:191], a[44:47]
    s_waitcnt lgkmcnt(4)
    v_lshlrev_b32 v130, 16, v130
    v_mul_f32 v130, v130, v22
    v_mul_f32 v134, v134, v22
    v_mfma_f32_16x16x32_bf16 a[48:51], v[64:67], a[192:195], a[48:51]
    ds_read_b128 a[168:171], v29 offset:51200
    v_cvt_pk_bf16_f32 v130, v130, v134
    buffer_load_dwordx4 v14, s[4:7], s39 offen offset:1024 lds
    v_cvt_f32_i32 v131, v131
    v_mfma_f32_16x16x32_bf16 a[52:55], v[68:71], a[192:195], a[52:55]
    v_cvt_f32_i32 v135, v135
    v_add_f32 v131, v131, v27
    v_add_f32 v135, v135, v27
    v_cvt_pk_bf16_f32 v131, v131, v135
    v_mfma_f32_16x16x32_bf16 a[56:59], v[64:67], a[196:199], a[56:59]
    ds_read_b128 a[172:175], v29 offset:59392
    buffer_load_dwordx4 v[164:167], v5, s[8:11], s52 offen
    v_and_b32 v135, 0xffff0000, v131
    v_lshlrev_b32 v131, 16, v131
    v_mfma_f32_16x16x32_bf16 a[60:63], v[68:71], a[196:199], a[60:63]
    s_waitcnt lgkmcnt(4)
    v_mul_f32 v131, v131, v23
    v_mul_f32 v135, v135, v23
    v_cvt_pk_bf16_f32 v131, v131, v135
    v_mfma_f32_16x16x32_bf16 a[64:67], v[64:67], a[152:155], a[64:67]
    ds_read_b128 a[176:179], v30 offset:32768
    s_waitcnt vmcnt(12)
    v_cvt_f32_i32 v136, v136
    v_cvt_f32_i32 v140, v140
    v_add_f32 v136, v136, v24
    v_mfma_f32_16x16x32_bf16 a[68:71], v[68:71], a[152:155], a[68:71]
    v_add_f32 v140, v140, v24
    v_cvt_pk_bf16_f32 v136, v136, v140
    v_and_b32 v140, 0xffff0000, v136
    v_lshlrev_b32 v136, 16, v136
    v_mfma_f32_16x16x32_bf16 a[72:75], v[64:67], a[156:159], a[72:75]
    ds_read_b128 a[180:183], v30 offset:40960
    v_mul_f32 v136, v136, v20
    v_mul_f32 v140, v140, v20
    v_cvt_pk_bf16_f32 v136, v136, v140
    v_mfma_f32_16x16x32_bf16 a[76:79], v[68:71], a[156:159], a[76:79]
    s_waitcnt lgkmcnt(4)
    v_cvt_f32_i32 v137, v137
    v_cvt_f32_i32 v141, v141
    v_add_f32 v137, v137, v25
    v_mfma_f32_16x16x32_bf16 a[80:83], v[64:67], a[160:163], a[80:83]
    ds_read_b128 a[184:187], v30 offset:33792
    v_add_f32 v141, v141, v25
    v_cvt_pk_bf16_f32 v137, v137, v141
    v_and_b32 v141, 0xffff0000, v137
    v_mfma_f32_16x16x32_bf16 a[84:87], v[68:71], a[160:163], a[84:87]
    v_lshlrev_b32 v137, 16, v137
    buffer_load_dwordx4 v14, s[4:7], s40 offen offset:2048 lds
    v_mul_f32 v137, v137, v21
    v_mul_f32 v141, v141, v21
    v_mfma_f32_16x16x32_bf16 a[88:91], v[64:67], a[164:167], a[88:91]
    ds_read_b128 a[188:191], v30 offset:41984
    buffer_load_dwordx4 v[168:171], v6, s[8:11], s52 offen
    v_cvt_pk_bf16_f32 v137, v137, v141
    v_cvt_f32_i32 v138, v138
    v_mfma_f32_16x16x32_bf16 a[92:95], v[68:71], a[164:167], a[92:95]
    s_waitcnt lgkmcnt(4)
    v_cvt_f32_i32 v142, v142
    v_add_f32 v138, v138, v26
    v_add_f32 v142, v142, v26
    v_mfma_f32_16x16x32_bf16 a[96:99], v[64:67], a[168:171], a[96:99]
    ds_read_b128 a[192:195], v30 offset:34816
    v_cvt_pk_bf16_f32 v138, v138, v142
    v_and_b32 v142, 0xffff0000, v138
    v_lshlrev_b32 v138, 16, v138
    v_mfma_f32_16x16x32_bf16 a[100:103], v[68:71], a[168:171], a[100:103]
    v_mul_f32 v138, v138, v22
    v_mul_f32 v142, v142, v22
    v_cvt_pk_bf16_f32 v138, v138, v142
    v_cvt_f32_i32 v139, v139
    v_mfma_f32_16x16x32_bf16 a[104:107], v[64:67], a[172:175], a[104:107]
    ds_read_b128 a[196:199], v30 offset:43008
    v_cvt_f32_i32 v143, v143
    v_add_f32 v139, v139, v27
    v_add_f32 v143, v143, v27
    v_mfma_f32_16x16x32_bf16 a[108:111], v[68:71], a[172:175], a[108:111]
    s_waitcnt lgkmcnt(4)
    v_cvt_pk_bf16_f32 v139, v139, v143
    v_and_b32 v143, 0xffff0000, v139
    v_lshlrev_b32 v139, 16, v139
    v_mfma_f32_16x16x32_bf16 a[0:3], v[72:75], a[176:179], a[0:3]
    ds_read_b128 a[152:155], v30 offset:35840
    v_mul_f32 v139, v139, v23
    v_mul_f32 v143, v143, v23
    v_cvt_pk_bf16_f32 v139, v139, v143
    v_mfma_f32_16x16x32_bf16 a[4:7], v[76:79], a[176:179], a[4:7]
    s_waitcnt vmcnt(10)
    v_cvt_f32_i32 v144, v144
    v_cvt_f32_i32 v148, v148
    buffer_load_dwordx4 v[172:175], v7, s[8:11], s52 offen
    v_add_f32 v144, v144, v24
    v_mfma_f32_16x16x32_bf16 a[8:11], v[72:75], a[180:183], a[8:11]
    ds_read_b128 a[156:159], v30 offset:44032
    v_add_f32 v148, v148, v24
    buffer_load_dwordx4 v14, s[4:7], s41 offen offset:3072 lds
    v_cvt_pk_bf16_f32 v144, v144, v148
    v_mfma_f32_16x16x32_bf16 a[12:15], v[76:79], a[180:183], a[12:15]
    s_waitcnt lgkmcnt(4)
    v_and_b32 v148, 0xffff0000, v144
    v_lshlrev_b32 v144, 16, v144
    v_mul_f32 v144, v144, v20
    v_mfma_f32_16x16x32_bf16 a[16:19], v[72:75], a[184:187], a[16:19]
    ds_read_b128 a[160:163], v30 offset:49152
    v_mul_f32 v148, v148, v20
    v_cvt_pk_bf16_f32 v144, v144, v148
    v_cvt_f32_i32 v145, v145
    v_mfma_f32_16x16x32_bf16 a[20:23], v[76:79], a[184:187], a[20:23]
    v_cvt_f32_i32 v149, v149
    v_add_f32 v145, v145, v25
    v_add_f32 v149, v149, v25
    v_cvt_pk_bf16_f32 v145, v145, v149
    v_mfma_f32_16x16x32_bf16 a[24:27], v[72:75], a[188:191], a[24:27]
    ds_read_b128 a[164:167], v30 offset:57344
    v_and_b32 v149, 0xffff0000, v145
    v_lshlrev_b32 v145, 16, v145
    v_mul_f32 v145, v145, v21
    v_mfma_f32_16x16x32_bf16 a[28:31], v[76:79], a[188:191], a[28:31]
    s_waitcnt lgkmcnt(4)
    v_mul_f32 v149, v149, v21
    v_cvt_pk_bf16_f32 v145, v145, v149
    v_cvt_f32_i32 v146, v146
    v_mfma_f32_16x16x32_bf16 a[32:35], v[72:75], a[192:195], a[32:35]
    ds_read_b128 a[168:171], v30 offset:50176
    v_cvt_f32_i32 v150, v150
    v_add_f32 v146, v146, v26
    v_add_f32 v150, v150, v26
    v_mfma_f32_16x16x32_bf16 a[36:39], v[76:79], a[192:195], a[36:39]
    v_cvt_pk_bf16_f32 v146, v146, v150
    buffer_load_dwordx4 v[176:179], v8, s[8:11], s52 offen
    v_and_b32 v150, 0xffff0000, v146
    v_lshlrev_b32 v146, 16, v146
    v_mfma_f32_16x16x32_bf16 a[40:43], v[72:75], a[196:199], a[40:43]
    ds_read_b128 a[172:175], v30 offset:58368
    v_mul_f32 v146, v146, v22
    v_mul_f32 v150, v150, v22
    v_cvt_pk_bf16_f32 v146, v146, v150
    v_mfma_f32_16x16x32_bf16 a[44:47], v[76:79], a[196:199], a[44:47]
    s_waitcnt lgkmcnt(4)
    s_add_u32 m0, s67, 114688
    s_nop 0
    buffer_load_dwordx4 v14, s[4:7], s42 offen offset:0 lds
    v_cvt_f32_i32 v147, v147
    v_mfma_f32_16x16x32_bf16 a[48:51], v[72:75], a[152:155], a[48:51]
    ds_read_b128 a[176:179], v30 offset:51200
    v_cvt_f32_i32 v151, v151
    v_add_f32 v147, v147, v27
    v_add_f32 v151, v151, v27
    v_mfma_f32_16x16x32_bf16 a[52:55], v[76:79], a[152:155], a[52:55]
    v_cvt_pk_bf16_f32 v147, v147, v151
    v_and_b32 v151, 0xffff0000, v147
    v_lshlrev_b32 v147, 16, v147
    v_mul_f32 v147, v147, v23
    v_mfma_f32_16x16x32_bf16 a[56:59], v[72:75], a[156:159], a[56:59]
    ds_read_b128 a[180:183], v30 offset:59392
    v_mul_f32 v151, v151, v23
    v_cvt_pk_bf16_f32 v147, v147, v151
    s_waitcnt vmcnt(11)
    v_cvt_f32_i32 v152, v152
    v_mfma_f32_16x16x32_bf16 a[60:63], v[76:79], a[156:159], a[60:63]
    s_waitcnt lgkmcnt(4)
    v_cvt_f32_i32 v156, v156
    v_add_f32 v152, v152, v24
    v_add_f32 v156, v156, v24
    v_mfma_f32_16x16x32_bf16 a[64:67], v[72:75], a[160:163], a[64:67]
    s_waitcnt vmcnt(10)
    s_barrier
    ds_read_b128 a[184:187], v31 offset:0
    v_cvt_pk_bf16_f32 v152, v152, v156
    v_mfma_f32_16x16x32_bf16 a[68:71], v[76:79], a[160:163], a[68:71]
    v_and_b32 v156, 0xffff0000, v152
    v_lshlrev_b32 v152, 16, v152
    v_mul_f32 v152, v152, v20
    buffer_load_dwordx4 v[180:183], v9, s[8:11], s52 offen
    v_mfma_f32_16x16x32_bf16 a[72:75], v[72:75], a[164:167], a[72:75]
    ds_read_b128 a[188:191], v31 offset:8192
    v_mul_f32 v156, v156, v20
    v_cvt_pk_bf16_f32 v152, v152, v156
    v_cvt_f32_i32 v153, v153
    v_mfma_f32_16x16x32_bf16 a[76:79], v[76:79], a[164:167], a[76:79]
    s_waitcnt lgkmcnt(4)
    v_cvt_f32_i32 v157, v157
    v_add_f32 v153, v153, v25
    v_add_f32 v157, v157, v25
    v_mfma_f32_16x16x32_bf16 a[80:83], v[72:75], a[168:171], a[80:83]
    ds_read_b128 a[192:195], v31 offset:1024
    v_cvt_pk_bf16_f32 v153, v153, v157
    v_and_b32 v157, 0xffff0000, v153
    v_lshlrev_b32 v153, 16, v153
    v_mfma_f32_16x16x32_bf16 a[84:87], v[76:79], a[168:171], a[84:87]
    buffer_load_dwordx4 v14, s[4:7], s43 offen offset:1024 lds
    v_mul_f32 v153, v153, v21
    v_mul_f32 v157, v157, v21
    v_cvt_pk_bf16_f32 v153, v153, v157
    v_mfma_f32_16x16x32_bf16 a[88:91], v[72:75], a[172:175], a[88:91]
    ds_read_b128 a[196:199], v31 offset:9216
    v_cvt_f32_i32 v154, v154
    v_cvt_f32_i32 v158, v158
    v_add_f32 v154, v154, v26
    v_mfma_f32_16x16x32_bf16 a[92:95], v[76:79], a[172:175], a[92:95]
    s_waitcnt lgkmcnt(4)
    v_add_f32 v158, v158, v26
    v_cvt_pk_bf16_f32 v154, v154, v158
    v_and_b32 v158, 0xffff0000, v154
    v_mfma_f32_16x16x32_bf16 a[96:99], v[72:75], a[176:179], a[96:99]
    ds_read_b128 a[152:155], v31 offset:2048
    v_lshlrev_b32 v154, 16, v154
    v_mul_f32 v154, v154, v22
    v_mul_f32 v158, v158, v22
    v_mfma_f32_16x16x32_bf16 a[100:103], v[76:79], a[176:179], a[100:103]
    v_cvt_pk_bf16_f32 v154, v154, v158
    v_cvt_f32_i32 v155, v155
    v_cvt_f32_i32 v159, v159
    buffer_load_dwordx4 v[184:187], v10, s[8:11], s52 offen
    v_mfma_f32_16x16x32_bf16 a[104:107], v[72:75], a[180:183], a[104:107]
    ds_read_b128 a[156:159], v31 offset:10240
    v_add_f32 v155, v155, v27
    v_add_f32 v159, v159, v27
    v_cvt_pk_bf16_f32 v155, v155, v159
    v_and_b32 v159, 0xffff0000, v155
    v_lshlrev_b32 v155, 16, v155
    v_mul_f32 v155, v155, v23
    v_mul_f32 v159, v159, v23
    v_cvt_pk_bf16_f32 v155, v155, v159
    s_not_b64 vcc, vcc
    v_cndmask_b32_dpp v80, v130, v128, vcc row_ror:8 row_mask:0xf bank_mask:0xf
    v_cndmask_b32_dpp v81, v138, v136, vcc row_ror:8 row_mask:0xf bank_mask:0xf
    v_cndmask_b32_dpp v82, v146, v144, vcc row_ror:8 row_mask:0xf bank_mask:0xf
    v_cndmask_b32_dpp v83, v154, v152, vcc row_ror:8 row_mask:0xf bank_mask:0xf
    v_cndmask_b32_dpp v84, v131, v129, vcc row_ror:8 row_mask:0xf bank_mask:0xf
    v_cndmask_b32_dpp v85, v139, v137, vcc row_ror:8 row_mask:0xf bank_mask:0xf
    v_cndmask_b32_dpp v86, v147, v145, vcc row_ror:8 row_mask:0xf bank_mask:0xf
    v_cndmask_b32_dpp v87, v155, v153, vcc row_ror:8 row_mask:0xf bank_mask:0xf
    buffer_load_dwordx4 v[188:191], v11, s[8:11], s52 offen
    v_mfma_f32_16x16x32_bf16 a[108:111], v[76:79], a[180:183], a[108:111]
    s_waitcnt lgkmcnt(4)
    buffer_load_dwordx4 v14, s[4:7], s44 offen offset:2048 lds
    s_not_b64 vcc, vcc
    v_cndmask_b32_dpp v88, v128, v130, vcc row_ror:8 row_mask:0xf bank_mask:0xf
    v_mfma_f32_16x16x32_bf16 a[0:3], v[80:83], a[184:187], a[0:3]
    ds_read_b128 a[160:163], v31 offset:3072
    v_cndmask_b32_dpp v89, v136, v138, vcc row_ror:8 row_mask:0xf bank_mask:0xf
    v_cndmask_b32_dpp v90, v144, v146, vcc row_ror:8 row_mask:0xf bank_mask:0xf
    v_cndmask_b32_dpp v91, v152, v154, vcc row_ror:8 row_mask:0xf bank_mask:0xf
    v_mfma_f32_16x16x32_bf16 a[4:7], v[84:87], a[184:187], a[4:7]
    v_cndmask_b32_dpp v92, v129, v131, vcc row_ror:8 row_mask:0xf bank_mask:0xf
    v_cndmask_b32_dpp v93, v137, v139, vcc row_ror:8 row_mask:0xf bank_mask:0xf
    v_cndmask_b32_dpp v94, v145, v147, vcc row_ror:8 row_mask:0xf bank_mask:0xf
    v_cndmask_b32_dpp v95, v153, v155, vcc row_ror:8 row_mask:0xf bank_mask:0xf
    v_mfma_f32_16x16x32_bf16 a[8:11], v[80:83], a[188:191], a[8:11]
    ds_read_b128 a[164:167], v31 offset:11264
    s_waitcnt vmcnt(11)
    v_cvt_f32_i32 v160, v160
    v_cvt_f32_i32 v164, v164
    v_add_f32 v160, v160, v24
    v_mfma_f32_16x16x32_bf16 a[12:15], v[84:87], a[188:191], a[12:15]
    s_waitcnt lgkmcnt(4)
    v_add_f32 v164, v164, v24
    s_add_u32 m0, s67, 0
    v_add_u32 v14, s62, v12
    buffer_load_dwordx4 v14, s[4:7], s38 offen offset:0 lds
    v_mfma_f32_16x16x32_bf16 a[16:19], v[80:83], a[192:195], a[16:19]
    ds_read_b128 a[168:171], v31 offset:16384
    v_cvt_pk_bf16_f32 v160, v160, v164
    v_and_b32 v164, 0xffff0000, v160
    v_lshlrev_b32 v160, 16, v160
    v_mfma_f32_16x16x32_bf16 a[20:23], v[84:87], a[192:195], a[20:23]
    v_mul_f32 v160, v160, v20
    v_mul_f32 v164, v164, v20
    v_cvt_pk_bf16_f32 v160, v160, v164
    v_cvt_f32_i32 v161, v161
    v_mfma_f32_16x16x32_bf16 a[24:27], v[80:83], a[196:199], a[24:27]
    ds_read_b128 a[172:175], v31 offset:24576
    v_cvt_f32_i32 v165, v165
    buffer_load_dwordx4 v[192:195], v4, s[8:11], s53 offen
    v_add_f32 v161, v161, v25
    v_mfma_f32_16x16x32_bf16 a[28:31], v[84:87], a[196:199], a[28:31]
    s_waitcnt lgkmcnt(4)
    v_add_f32 v165, v165, v25
    v_cvt_pk_bf16_f32 v161, v161, v165
    v_and_b32 v165, 0xffff0000, v161
    v_mfma_f32_16x16x32_bf16 a[32:35], v[80:83], a[152:155], a[32:35]
    ds_read_b128 a[176:179], v31 offset:17408
    v_lshlrev_b32 v161, 16, v161
    v_mul_f32 v161, v161, v21
    v_mul_f32 v165, v165, v21
    v_mfma_f32_16x16x32_bf16 a[36:39], v[84:87], a[152:155], a[36:39]
    v_cvt_pk_bf16_f32 v161, v161, v165
    v_cvt_f32_i32 v162, v162
    v_cvt_f32_i32 v166, v166
    v_add_f32 v162, v162, v26
    v_mfma_f32_16x16x32_bf16 a[40:43], v[80:83], a[156:159], a[40:43]
    ds_read_b128 a[180:183], v31 offset:25600
    v_add_f32 v166, v166, v26
    v_cvt_pk_bf16_f32 v162, v162, v166
    v_and_b32 v166, 0xffff0000, v162
    v_mfma_f32_16x16x32_bf16 a[44:47], v[84:87], a[156:159], a[44:47]
    s_waitcnt lgkmcnt(4)
    v_lshlrev_b32 v162, 16, v162
    v_mul_f32 v162, v162, v22
    v_mul_f32 v166, v166, v22
    v_mfma_f32_16x16x32_bf16 a[48:51], v[80:83], a[160:163], a[48:51]
    ds_read_b128 a[184:187], v31 offset:18432
    v_cvt_pk_bf16_f32 v162, v162, v166
    buffer_load_dwordx4 v14, s[4:7], s39 offen offset:1024 lds
    v_cvt_f32_i32 v163, v163
    v_mfma_f32_16x16x32_bf16 a[52:55], v[84:87], a[160:163], a[52:55]
    v_cvt_f32_i32 v167, v167
    v_add_f32 v163, v163, v27
    v_add_f32 v167, v167, v27
    v_cvt_pk_bf16_f32 v163, v163, v167
    v_mfma_f32_16x16x32_bf16 a[56:59], v[80:83], a[164:167], a[56:59]
    ds_read_b128 a[188:191], v31 offset:26624
    buffer_load_dwordx4 v[196:199], v5, s[8:11], s53 offen
    v_and_b32 v167, 0xffff0000, v163
    v_lshlrev_b32 v163, 16, v163
    v_mfma_f32_16x16x32_bf16 a[60:63], v[84:87], a[164:167], a[60:63]
    s_waitcnt lgkmcnt(4)
    v_mul_f32 v163, v163, v23
    v_mul_f32 v167, v167, v23
    v_cvt_pk_bf16_f32 v163, v163, v167
    v_mfma_f32_16x16x32_bf16 a[64:67], v[80:83], a[168:171], a[64:67]
    ds_read_b128 a[192:195], v32 offset:0
    s_waitcnt vmcnt(12)
    v_cvt_f32_i32 v168, v168
    v_cvt_f32_i32 v172, v172
    v_add_f32 v168, v168, v24
    v_mfma_f32_16x16x32_bf16 a[68:71], v[84:87], a[168:171], a[68:71]
    v_add_f32 v172, v172, v24
    v_cvt_pk_bf16_f32 v168, v168, v172
    v_and_b32 v172, 0xffff0000, v168
    v_lshlrev_b32 v168, 16, v168
    v_mfma_f32_16x16x32_bf16 a[72:75], v[80:83], a[172:175], a[72:75]
    ds_read_b128 a[196:199], v32 offset:8192
    v_mul_f32 v168, v168, v20
    v_mul_f32 v172, v172, v20
    v_cvt_pk_bf16_f32 v168, v168, v172
    v_mfma_f32_16x16x32_bf16 a[76:79], v[84:87], a[172:175], a[76:79]
    s_waitcnt lgkmcnt(4)
    v_cvt_f32_i32 v169, v169
    v_cvt_f32_i32 v173, v173
    v_add_f32 v169, v169, v25
    v_mfma_f32_16x16x32_bf16 a[80:83], v[80:83], a[176:179], a[80:83]
    ds_read_b128 a[152:155], v32 offset:1024
    v_add_f32 v173, v173, v25
    v_cvt_pk_bf16_f32 v169, v169, v173
    v_and_b32 v173, 0xffff0000, v169
    v_mfma_f32_16x16x32_bf16 a[84:87], v[84:87], a[176:179], a[84:87]
    v_lshlrev_b32 v169, 16, v169
    buffer_load_dwordx4 v14, s[4:7], s40 offen offset:2048 lds
    v_mul_f32 v169, v169, v21
    v_mul_f32 v173, v173, v21
    v_mfma_f32_16x16x32_bf16 a[88:91], v[80:83], a[180:183], a[88:91]
    ds_read_b128 a[156:159], v32 offset:9216
    buffer_load_dwordx4 v[200:203], v6, s[8:11], s53 offen
    v_cvt_pk_bf16_f32 v169, v169, v173
    v_cvt_f32_i32 v170, v170
    v_mfma_f32_16x16x32_bf16 a[92:95], v[84:87], a[180:183], a[92:95]
    s_waitcnt lgkmcnt(4)
    v_cvt_f32_i32 v174, v174
    v_add_f32 v170, v170, v26
    v_add_f32 v174, v174, v26
    v_mfma_f32_16x16x32_bf16 a[96:99], v[80:83], a[184:187], a[96:99]
    ds_read_b128 a[160:163], v32 offset:2048
    v_cvt_pk_bf16_f32 v170, v170, v174
    v_and_b32 v174, 0xffff0000, v170
    v_lshlrev_b32 v170, 16, v170
    v_mfma_f32_16x16x32_bf16 a[100:103], v[84:87], a[184:187], a[100:103]
    v_mul_f32 v170, v170, v22
    v_mul_f32 v174, v174, v22
    v_cvt_pk_bf16_f32 v170, v170, v174
    v_cvt_f32_i32 v171, v171
    v_mfma_f32_16x16x32_bf16 a[104:107], v[80:83], a[188:191], a[104:107]
    ds_read_b128 a[164:167], v32 offset:10240
    v_cvt_f32_i32 v175, v175
    v_add_f32 v171, v171, v27
    v_add_f32 v175, v175, v27
    v_mfma_f32_16x16x32_bf16 a[108:111], v[84:87], a[188:191], a[108:111]
    s_waitcnt lgkmcnt(4)
    v_cvt_pk_bf16_f32 v171, v171, v175
    v_and_b32 v175, 0xffff0000, v171
    v_lshlrev_b32 v171, 16, v171
    v_mfma_f32_16x16x32_bf16 a[0:3], v[88:91], a[192:195], a[0:3]
    ds_read_b128 a[168:171], v32 offset:3072
    v_mul_f32 v171, v171, v23
    v_mul_f32 v175, v175, v23
    v_cvt_pk_bf16_f32 v171, v171, v175
    v_mfma_f32_16x16x32_bf16 a[4:7], v[92:95], a[192:195], a[4:7]
    s_waitcnt vmcnt(10)
    v_cvt_f32_i32 v176, v176
    v_cvt_f32_i32 v180, v180
    buffer_load_dwordx4 v[204:207], v7, s[8:11], s53 offen
    v_add_f32 v176, v176, v24
    v_mfma_f32_16x16x32_bf16 a[8:11], v[88:91], a[196:199], a[8:11]
    ds_read_b128 a[172:175], v32 offset:11264
    v_add_f32 v180, v180, v24
    buffer_load_dwordx4 v14, s[4:7], s41 offen offset:3072 lds
    v_cvt_pk_bf16_f32 v176, v176, v180
    v_mfma_f32_16x16x32_bf16 a[12:15], v[92:95], a[196:199], a[12:15]
    s_waitcnt lgkmcnt(4)
    v_and_b32 v180, 0xffff0000, v176
    v_lshlrev_b32 v176, 16, v176
    v_mul_f32 v176, v176, v20
    v_mfma_f32_16x16x32_bf16 a[16:19], v[88:91], a[152:155], a[16:19]
    ds_read_b128 a[176:179], v32 offset:16384
    v_mul_f32 v180, v180, v20
    v_cvt_pk_bf16_f32 v176, v176, v180
    v_cvt_f32_i32 v177, v177
    v_mfma_f32_16x16x32_bf16 a[20:23], v[92:95], a[152:155], a[20:23]
    v_cvt_f32_i32 v181, v181
    v_add_f32 v177, v177, v25
    v_add_f32 v181, v181, v25
    v_cvt_pk_bf16_f32 v177, v177, v181
    v_mfma_f32_16x16x32_bf16 a[24:27], v[88:91], a[156:159], a[24:27]
    ds_read_b128 a[180:183], v32 offset:24576
    v_and_b32 v181, 0xffff0000, v177
    v_lshlrev_b32 v177, 16, v177
    v_mul_f32 v177, v177, v21
    v_mfma_f32_16x16x32_bf16 a[28:31], v[92:95], a[156:159], a[28:31]
    s_waitcnt lgkmcnt(4)
    v_mul_f32 v181, v181, v21
    v_cvt_pk_bf16_f32 v177, v177, v181
    v_cvt_f32_i32 v178, v178
    v_mfma_f32_16x16x32_bf16 a[32:35], v[88:91], a[160:163], a[32:35]
    ds_read_b128 a[184:187], v32 offset:17408
    v_cvt_f32_i32 v182, v182
    v_add_f32 v178, v178, v26
    v_add_f32 v182, v182, v26
    v_mfma_f32_16x16x32_bf16 a[36:39], v[92:95], a[160:163], a[36:39]
    v_cvt_pk_bf16_f32 v178, v178, v182
    buffer_load_dwordx4 v[208:211], v8, s[8:11], s53 offen
    v_and_b32 v182, 0xffff0000, v178
    v_lshlrev_b32 v178, 16, v178
    v_mfma_f32_16x16x32_bf16 a[40:43], v[88:91], a[164:167], a[40:43]
    ds_read_b128 a[188:191], v32 offset:25600
    v_mul_f32 v178, v178, v22
    v_mul_f32 v182, v182, v22
    v_cvt_pk_bf16_f32 v178, v178, v182
    v_mfma_f32_16x16x32_bf16 a[44:47], v[92:95], a[164:167], a[44:47]
    s_waitcnt lgkmcnt(4)
    s_add_u32 m0, s67, 16384
    s_nop 0
    buffer_load_dwordx4 v14, s[4:7], s42 offen offset:0 lds
    v_cvt_f32_i32 v179, v179
    v_mfma_f32_16x16x32_bf16 a[48:51], v[88:91], a[168:171], a[48:51]
    ds_read_b128 a[192:195], v32 offset:18432
    v_cvt_f32_i32 v183, v183
    v_add_f32 v179, v179, v27
    v_add_f32 v183, v183, v27
    v_mfma_f32_16x16x32_bf16 a[52:55], v[92:95], a[168:171], a[52:55]
    v_cvt_pk_bf16_f32 v179, v179, v183
    v_and_b32 v183, 0xffff0000, v179
    v_lshlrev_b32 v179, 16, v179
    v_mul_f32 v179, v179, v23
    v_mfma_f32_16x16x32_bf16 a[56:59], v[88:91], a[172:175], a[56:59]
    ds_read_b128 a[196:199], v32 offset:26624
    v_mul_f32 v183, v183, v23
    v_cvt_pk_bf16_f32 v179, v179, v183
    s_waitcnt vmcnt(11)
    v_cvt_f32_i32 v184, v184
    v_mfma_f32_16x16x32_bf16 a[60:63], v[92:95], a[172:175], a[60:63]
    s_waitcnt lgkmcnt(4)
    v_cvt_f32_i32 v188, v188
    v_add_f32 v184, v184, v24
    v_add_f32 v188, v188, v24
    v_mfma_f32_16x16x32_bf16 a[64:67], v[88:91], a[176:179], a[64:67]
    s_waitcnt vmcnt(10)
    s_barrier
    ds_read_b128 a[152:155], v31 offset:32768
    v_cvt_pk_bf16_f32 v184, v184, v188
    v_mfma_f32_16x16x32_bf16 a[68:71], v[92:95], a[176:179], a[68:71]
    v_and_b32 v188, 0xffff0000, v184
    v_lshlrev_b32 v184, 16, v184
    v_mul_f32 v184, v184, v20
    buffer_load_dwordx4 v[212:215], v9, s[8:11], s53 offen
    v_mfma_f32_16x16x32_bf16 a[72:75], v[88:91], a[180:183], a[72:75]
    ds_read_b128 a[156:159], v31 offset:40960
    v_mul_f32 v188, v188, v20
    v_cvt_pk_bf16_f32 v184, v184, v188
    v_cvt_f32_i32 v185, v185
    v_mfma_f32_16x16x32_bf16 a[76:79], v[92:95], a[180:183], a[76:79]
    s_waitcnt lgkmcnt(4)
    v_cvt_f32_i32 v189, v189
    v_add_f32 v185, v185, v25
    v_add_f32 v189, v189, v25
    v_mfma_f32_16x16x32_bf16 a[80:83], v[88:91], a[184:187], a[80:83]
    ds_read_b128 a[160:163], v31 offset:33792
    v_cvt_pk_bf16_f32 v185, v185, v189
    v_and_b32 v189, 0xffff0000, v185
    v_lshlrev_b32 v185, 16, v185
    v_mfma_f32_16x16x32_bf16 a[84:87], v[92:95], a[184:187], a[84:87]
    buffer_load_dwordx4 v14, s[4:7], s43 offen offset:1024 lds
    v_mul_f32 v185, v185, v21
    v_mul_f32 v189, v189, v21
    v_cvt_pk_bf16_f32 v185, v185, v189
    v_mfma_f32_16x16x32_bf16 a[88:91], v[88:91], a[188:191], a[88:91]
    ds_read_b128 a[164:167], v31 offset:41984
    v_cvt_f32_i32 v186, v186
    v_cvt_f32_i32 v190, v190
    v_add_f32 v186, v186, v26
    v_mfma_f32_16x16x32_bf16 a[92:95], v[92:95], a[188:191], a[92:95]
    s_waitcnt lgkmcnt(4)
    v_add_f32 v190, v190, v26
    v_cvt_pk_bf16_f32 v186, v186, v190
    v_and_b32 v190, 0xffff0000, v186
    v_mfma_f32_16x16x32_bf16 a[96:99], v[88:91], a[192:195], a[96:99]
    ds_read_b128 a[168:171], v31 offset:34816
    v_lshlrev_b32 v186, 16, v186
    v_mul_f32 v186, v186, v22
    v_mul_f32 v190, v190, v22
    v_mfma_f32_16x16x32_bf16 a[100:103], v[92:95], a[192:195], a[100:103]
    v_cvt_pk_bf16_f32 v186, v186, v190
    v_cvt_f32_i32 v187, v187
    v_cvt_f32_i32 v191, v191
    buffer_load_dwordx4 v[216:219], v10, s[8:11], s53 offen
    v_mfma_f32_16x16x32_bf16 a[104:107], v[88:91], a[196:199], a[104:107]
    ds_read_b128 a[172:175], v31 offset:43008
    v_add_f32 v187, v187, v27
    v_add_f32 v191, v191, v27
    v_cvt_pk_bf16_f32 v187, v187, v191
    v_and_b32 v191, 0xffff0000, v187
    v_lshlrev_b32 v187, 16, v187
    v_mul_f32 v187, v187, v23
    v_mul_f32 v191, v191, v23
    v_cvt_pk_bf16_f32 v187, v187, v191
    s_not_b64 vcc, vcc
    v_cndmask_b32_dpp v96, v162, v160, vcc row_ror:8 row_mask:0xf bank_mask:0xf
    v_cndmask_b32_dpp v97, v170, v168, vcc row_ror:8 row_mask:0xf bank_mask:0xf
    v_cndmask_b32_dpp v98, v178, v176, vcc row_ror:8 row_mask:0xf bank_mask:0xf
    v_cndmask_b32_dpp v99, v186, v184, vcc row_ror:8 row_mask:0xf bank_mask:0xf
    v_cndmask_b32_dpp v100, v163, v161, vcc row_ror:8 row_mask:0xf bank_mask:0xf
    v_cndmask_b32_dpp v101, v171, v169, vcc row_ror:8 row_mask:0xf bank_mask:0xf
    v_cndmask_b32_dpp v102, v179, v177, vcc row_ror:8 row_mask:0xf bank_mask:0xf
    v_cndmask_b32_dpp v103, v187, v185, vcc row_ror:8 row_mask:0xf bank_mask:0xf
    buffer_load_dwordx4 v[220:223], v11, s[8:11], s53 offen
    v_mfma_f32_16x16x32_bf16 a[108:111], v[92:95], a[196:199], a[108:111]
    s_waitcnt lgkmcnt(4)
    buffer_load_dwordx4 v14, s[4:7], s44 offen offset:2048 lds
    s_not_b64 vcc, vcc
    v_cndmask_b32_dpp v104, v160, v162, vcc row_ror:8 row_mask:0xf bank_mask:0xf
    v_mfma_f32_16x16x32_bf16 a[0:3], v[96:99], a[152:155], a[0:3]
    ds_read_b128 a[176:179], v31 offset:35840
    v_cndmask_b32_dpp v105, v168, v170, vcc row_ror:8 row_mask:0xf bank_mask:0xf
    v_cndmask_b32_dpp v106, v176, v178, vcc row_ror:8 row_mask:0xf bank_mask:0xf
    v_cndmask_b32_dpp v107, v184, v186, vcc row_ror:8 row_mask:0xf bank_mask:0xf
    v_mfma_f32_16x16x32_bf16 a[4:7], v[100:103], a[152:155], a[4:7]
    v_cndmask_b32_dpp v108, v161, v163, vcc row_ror:8 row_mask:0xf bank_mask:0xf
    v_cndmask_b32_dpp v109, v169, v171, vcc row_ror:8 row_mask:0xf bank_mask:0xf
    v_cndmask_b32_dpp v110, v177, v179, vcc row_ror:8 row_mask:0xf bank_mask:0xf
    v_cndmask_b32_dpp v111, v185, v187, vcc row_ror:8 row_mask:0xf bank_mask:0xf
    v_mfma_f32_16x16x32_bf16 a[8:11], v[96:99], a[156:159], a[8:11]
    ds_read_b128 a[180:183], v31 offset:44032
    s_waitcnt vmcnt(11)
    v_cvt_f32_i32 v192, v192
    v_cvt_f32_i32 v196, v196
    v_add_f32 v192, v192, v24
    v_mfma_f32_16x16x32_bf16 a[12:15], v[100:103], a[156:159], a[12:15]
    s_waitcnt lgkmcnt(4)
    v_add_f32 v196, v196, v24
    s_add_u32 m0, s67, 32768
    v_add_u32 v14, s63, v12
    buffer_load_dwordx4 v14, s[4:7], s38 offen offset:0 lds
    v_mfma_f32_16x16x32_bf16 a[16:19], v[96:99], a[160:163], a[16:19]
    ds_read_b128 a[184:187], v31 offset:49152
    v_cvt_pk_bf16_f32 v192, v192, v196
    v_and_b32 v196, 0xffff0000, v192
    v_lshlrev_b32 v192, 16, v192
    v_mfma_f32_16x16x32_bf16 a[20:23], v[100:103], a[160:163], a[20:23]
    v_mul_f32 v192, v192, v20
    v_mul_f32 v196, v196, v20
    v_cvt_pk_bf16_f32 v192, v192, v196
    v_cvt_f32_i32 v193, v193
    v_mfma_f32_16x16x32_bf16 a[24:27], v[96:99], a[164:167], a[24:27]
    ds_read_b128 a[188:191], v31 offset:57344
    v_cvt_f32_i32 v197, v197
    buffer_load_dwordx4 v[224:227], v4, s[8:11], s54 offen
    v_add_f32 v193, v193, v25
    v_mfma_f32_16x16x32_bf16 a[28:31], v[100:103], a[164:167], a[28:31]
    s_waitcnt lgkmcnt(4)
    v_add_f32 v197, v197, v25
    v_cvt_pk_bf16_f32 v193, v193, v197
    v_and_b32 v197, 0xffff0000, v193
    v_mfma_f32_16x16x32_bf16 a[32:35], v[96:99], a[168:171], a[32:35]
    ds_read_b128 a[192:195], v31 offset:50176
    v_lshlrev_b32 v193, 16, v193
    v_mul_f32 v193, v193, v21
    v_mul_f32 v197, v197, v21
    v_mfma_f32_16x16x32_bf16 a[36:39], v[100:103], a[168:171], a[36:39]
    v_cvt_pk_bf16_f32 v193, v193, v197
    v_cvt_f32_i32 v194, v194
    v_cvt_f32_i32 v198, v198
    v_add_f32 v194, v194, v26
    v_mfma_f32_16x16x32_bf16 a[40:43], v[96:99], a[172:175], a[40:43]
    ds_read_b128 a[196:199], v31 offset:58368
    v_add_f32 v198, v198, v26
    v_cvt_pk_bf16_f32 v194, v194, v198
    v_and_b32 v198, 0xffff0000, v194
    v_mfma_f32_16x16x32_bf16 a[44:47], v[100:103], a[172:175], a[44:47]
    s_waitcnt lgkmcnt(4)
    v_lshlrev_b32 v194, 16, v194
    v_mul_f32 v194, v194, v22
    v_mul_f32 v198, v198, v22
    v_mfma_f32_16x16x32_bf16 a[48:51], v[96:99], a[176:179], a[48:51]
    ds_read_b128 a[152:155], v31 offset:51200
    v_cvt_pk_bf16_f32 v194, v194, v198
    buffer_load_dwordx4 v14, s[4:7], s39 offen offset:1024 lds
    v_cvt_f32_i32 v195, v195
    v_mfma_f32_16x16x32_bf16 a[52:55], v[100:103], a[176:179], a[52:55]
    v_cvt_f32_i32 v199, v199
    v_add_f32 v195, v195, v27
    v_add_f32 v199, v199, v27
    v_cvt_pk_bf16_f32 v195, v195, v199
    v_mfma_f32_16x16x32_bf16 a[56:59], v[96:99], a[180:183], a[56:59]
    ds_read_b128 a[156:159], v31 offset:59392
    buffer_load_dwordx4 v[228:231], v5, s[8:11], s54 offen
    v_and_b32 v199, 0xffff0000, v195
    v_lshlrev_b32 v195, 16, v195
    v_mfma_f32_16x16x32_bf16 a[60:63], v[100:103], a[180:183], a[60:63]
    s_waitcnt lgkmcnt(4)
    v_mul_f32 v195, v195, v23
    v_mul_f32 v199, v199, v23
    v_cvt_pk_bf16_f32 v195, v195, v199
    v_mfma_f32_16x16x32_bf16 a[64:67], v[96:99], a[184:187], a[64:67]
    ds_read_b128 a[160:163], v32 offset:32768
    s_waitcnt vmcnt(12)
    v_cvt_f32_i32 v200, v200
    v_cvt_f32_i32 v204, v204
    v_add_f32 v200, v200, v24
    v_mfma_f32_16x16x32_bf16 a[68:71], v[100:103], a[184:187], a[68:71]
    v_add_f32 v204, v204, v24
    v_cvt_pk_bf16_f32 v200, v200, v204
    v_and_b32 v204, 0xffff0000, v200
    v_lshlrev_b32 v200, 16, v200
    v_mfma_f32_16x16x32_bf16 a[72:75], v[96:99], a[188:191], a[72:75]
    ds_read_b128 a[164:167], v32 offset:40960
    v_mul_f32 v200, v200, v20
    v_mul_f32 v204, v204, v20
    v_cvt_pk_bf16_f32 v200, v200, v204
    v_mfma_f32_16x16x32_bf16 a[76:79], v[100:103], a[188:191], a[76:79]
    s_waitcnt lgkmcnt(4)
    v_cvt_f32_i32 v201, v201
    v_cvt_f32_i32 v205, v205
    v_add_f32 v201, v201, v25
    v_mfma_f32_16x16x32_bf16 a[80:83], v[96:99], a[192:195], a[80:83]
    ds_read_b128 a[168:171], v32 offset:33792
    v_add_f32 v205, v205, v25
    v_cvt_pk_bf16_f32 v201, v201, v205
    v_and_b32 v205, 0xffff0000, v201
    v_mfma_f32_16x16x32_bf16 a[84:87], v[100:103], a[192:195], a[84:87]
    v_lshlrev_b32 v201, 16, v201
    buffer_load_dwordx4 v14, s[4:7], s40 offen offset:2048 lds
    v_mul_f32 v201, v201, v21
    v_mul_f32 v205, v205, v21
    v_mfma_f32_16x16x32_bf16 a[88:91], v[96:99], a[196:199], a[88:91]
    ds_read_b128 a[172:175], v32 offset:41984
    buffer_load_dwordx4 v[232:235], v6, s[8:11], s54 offen
    v_cvt_pk_bf16_f32 v201, v201, v205
    v_cvt_f32_i32 v202, v202
    v_mfma_f32_16x16x32_bf16 a[92:95], v[100:103], a[196:199], a[92:95]
    s_waitcnt lgkmcnt(4)
    v_cvt_f32_i32 v206, v206
    v_add_f32 v202, v202, v26
    v_add_f32 v206, v206, v26
    v_mfma_f32_16x16x32_bf16 a[96:99], v[96:99], a[152:155], a[96:99]
    ds_read_b128 a[176:179], v32 offset:34816
    v_cvt_pk_bf16_f32 v202, v202, v206
    v_and_b32 v206, 0xffff0000, v202
    v_lshlrev_b32 v202, 16, v202
    v_mfma_f32_16x16x32_bf16 a[100:103], v[100:103], a[152:155], a[100:103]
    v_mul_f32 v202, v202, v22
    v_mul_f32 v206, v206, v22
    v_cvt_pk_bf16_f32 v202, v202, v206
    v_cvt_f32_i32 v203, v203
    v_mfma_f32_16x16x32_bf16 a[104:107], v[96:99], a[156:159], a[104:107]
    ds_read_b128 a[180:183], v32 offset:43008
    v_cvt_f32_i32 v207, v207
    v_add_f32 v203, v203, v27
    v_add_f32 v207, v207, v27
    v_mfma_f32_16x16x32_bf16 a[108:111], v[100:103], a[156:159], a[108:111]
    s_waitcnt lgkmcnt(4)
    v_cvt_pk_bf16_f32 v203, v203, v207
    v_and_b32 v207, 0xffff0000, v203
    v_lshlrev_b32 v203, 16, v203
    v_mfma_f32_16x16x32_bf16 a[0:3], v[104:107], a[160:163], a[0:3]
    ds_read_b128 a[184:187], v32 offset:35840
    v_mul_f32 v203, v203, v23
    v_mul_f32 v207, v207, v23
    v_cvt_pk_bf16_f32 v203, v203, v207
    v_mfma_f32_16x16x32_bf16 a[4:7], v[108:111], a[160:163], a[4:7]
    s_waitcnt vmcnt(10)
    v_cvt_f32_i32 v208, v208
    v_cvt_f32_i32 v212, v212
    buffer_load_dwordx4 v[236:239], v7, s[8:11], s54 offen
    v_add_f32 v208, v208, v24
    v_mfma_f32_16x16x32_bf16 a[8:11], v[104:107], a[164:167], a[8:11]
    ds_read_b128 a[188:191], v32 offset:44032
    v_add_f32 v212, v212, v24
    buffer_load_dwordx4 v14, s[4:7], s41 offen offset:3072 lds
    v_cvt_pk_bf16_f32 v208, v208, v212
    v_mfma_f32_16x16x32_bf16 a[12:15], v[108:111], a[164:167], a[12:15]
    s_waitcnt lgkmcnt(4)
    v_and_b32 v212, 0xffff0000, v208
    v_lshlrev_b32 v208, 16, v208
    v_mul_f32 v208, v208, v20
    v_mfma_f32_16x16x32_bf16 a[16:19], v[104:107], a[168:171], a[16:19]
    ds_read_b128 a[192:195], v32 offset:49152
    v_mul_f32 v212, v212, v20
    v_cvt_pk_bf16_f32 v208, v208, v212
    v_cvt_f32_i32 v209, v209
    v_mfma_f32_16x16x32_bf16 a[20:23], v[108:111], a[168:171], a[20:23]
    v_cvt_f32_i32 v213, v213
    v_add_f32 v209, v209, v25
    v_add_f32 v213, v213, v25
    v_cvt_pk_bf16_f32 v209, v209, v213
    v_mfma_f32_16x16x32_bf16 a[24:27], v[104:107], a[172:175], a[24:27]
    ds_read_b128 a[196:199], v32 offset:57344
    v_and_b32 v213, 0xffff0000, v209
    v_lshlrev_b32 v209, 16, v209
    v_mul_f32 v209, v209, v21
    v_mfma_f32_16x16x32_bf16 a[28:31], v[108:111], a[172:175], a[28:31]
    s_waitcnt lgkmcnt(4)
    v_mul_f32 v213, v213, v21
    v_cvt_pk_bf16_f32 v209, v209, v213
    v_cvt_f32_i32 v210, v210
    v_mfma_f32_16x16x32_bf16 a[32:35], v[104:107], a[176:179], a[32:35]
    ds_read_b128 a[152:155], v32 offset:50176
    v_cvt_f32_i32 v214, v214
    v_add_f32 v210, v210, v26
    v_add_f32 v214, v214, v26
    v_mfma_f32_16x16x32_bf16 a[36:39], v[108:111], a[176:179], a[36:39]
    v_cvt_pk_bf16_f32 v210, v210, v214
    buffer_load_dwordx4 v[240:243], v8, s[8:11], s54 offen
    v_and_b32 v214, 0xffff0000, v210
    v_lshlrev_b32 v210, 16, v210
    v_mfma_f32_16x16x32_bf16 a[40:43], v[104:107], a[180:183], a[40:43]
    ds_read_b128 a[156:159], v32 offset:58368
    v_mul_f32 v210, v210, v22
    v_mul_f32 v214, v214, v22
    v_cvt_pk_bf16_f32 v210, v210, v214
    v_mfma_f32_16x16x32_bf16 a[44:47], v[108:111], a[180:183], a[44:47]
    s_waitcnt lgkmcnt(4)
    s_add_u32 m0, s67, 49152
    s_nop 0
    buffer_load_dwordx4 v14, s[4:7], s42 offen offset:0 lds
    v_cvt_f32_i32 v211, v211
    v_mfma_f32_16x16x32_bf16 a[48:51], v[104:107], a[184:187], a[48:51]
    ds_read_b128 a[160:163], v32 offset:51200
    v_cvt_f32_i32 v215, v215
    v_add_f32 v211, v211, v27
    v_add_f32 v215, v215, v27
    v_mfma_f32_16x16x32_bf16 a[52:55], v[108:111], a[184:187], a[52:55]
    v_cvt_pk_bf16_f32 v211, v211, v215
    v_and_b32 v215, 0xffff0000, v211
    v_lshlrev_b32 v211, 16, v211
    v_mul_f32 v211, v211, v23
    v_mfma_f32_16x16x32_bf16 a[56:59], v[104:107], a[188:191], a[56:59]
    ds_read_b128 a[164:167], v32 offset:59392
    v_mul_f32 v215, v215, v23
    v_cvt_pk_bf16_f32 v211, v211, v215
    s_waitcnt vmcnt(11)
    v_cvt_f32_i32 v216, v216
    v_mfma_f32_16x16x32_bf16 a[60:63], v[108:111], a[188:191], a[60:63]
    s_waitcnt lgkmcnt(4)
    v_cvt_f32_i32 v220, v220
    v_add_f32 v216, v216, v24
    v_add_f32 v220, v220, v24
    v_mfma_f32_16x16x32_bf16 a[64:67], v[104:107], a[192:195], a[64:67]
    s_waitcnt vmcnt(10)
    s_barrier
    ds_read_b128 a[168:171], v29 offset:0
    v_cvt_pk_bf16_f32 v216, v216, v220
    v_mfma_f32_16x16x32_bf16 a[68:71], v[108:111], a[192:195], a[68:71]
    v_and_b32 v220, 0xffff0000, v216
    v_lshlrev_b32 v216, 16, v216
    v_mul_f32 v216, v216, v20
    buffer_load_dwordx4 v[244:247], v9, s[8:11], s54 offen
    v_mfma_f32_16x16x32_bf16 a[72:75], v[104:107], a[196:199], a[72:75]
    ds_read_b128 a[172:175], v29 offset:8192
    v_mul_f32 v220, v220, v20
    v_cvt_pk_bf16_f32 v216, v216, v220
    v_cvt_f32_i32 v217, v217
    v_mfma_f32_16x16x32_bf16 a[76:79], v[108:111], a[196:199], a[76:79]
    s_waitcnt lgkmcnt(4)
    v_cvt_f32_i32 v221, v221
    v_add_f32 v217, v217, v25
    v_add_f32 v221, v221, v25
    v_mfma_f32_16x16x32_bf16 a[80:83], v[104:107], a[152:155], a[80:83]
    ds_read_b128 a[176:179], v29 offset:1024
    v_cvt_pk_bf16_f32 v217, v217, v221
    v_and_b32 v221, 0xffff0000, v217
    v_lshlrev_b32 v217, 16, v217
    v_mfma_f32_16x16x32_bf16 a[84:87], v[108:111], a[152:155], a[84:87]
    buffer_load_dwordx4 v14, s[4:7], s43 offen offset:1024 lds
    v_mul_f32 v217, v217, v21
    v_mul_f32 v221, v221, v21
    v_cvt_pk_bf16_f32 v217, v217, v221
    v_mfma_f32_16x16x32_bf16 a[88:91], v[104:107], a[156:159], a[88:91]
    ds_read_b128 a[180:183], v29 offset:9216
    v_cvt_f32_i32 v218, v218
    v_cvt_f32_i32 v222, v222
    v_add_f32 v218, v218, v26
    v_mfma_f32_16x16x32_bf16 a[92:95], v[108:111], a[156:159], a[92:95]
    s_waitcnt lgkmcnt(4)
    v_add_f32 v222, v222, v26
    v_cvt_pk_bf16_f32 v218, v218, v222
    v_and_b32 v222, 0xffff0000, v218
    v_mfma_f32_16x16x32_bf16 a[96:99], v[104:107], a[160:163], a[96:99]
    ds_read_b128 a[184:187], v29 offset:2048
    v_lshlrev_b32 v218, 16, v218
    v_mul_f32 v218, v218, v22
    v_mul_f32 v222, v222, v22
    v_mfma_f32_16x16x32_bf16 a[100:103], v[108:111], a[160:163], a[100:103]
    v_cvt_pk_bf16_f32 v218, v218, v222
    v_cvt_f32_i32 v219, v219
    v_cvt_f32_i32 v223, v223
    buffer_load_dwordx4 v[248:251], v10, s[8:11], s54 offen
    v_mfma_f32_16x16x32_bf16 a[104:107], v[104:107], a[164:167], a[104:107]
    ds_read_b128 a[188:191], v29 offset:10240
    v_add_f32 v219, v219, v27
    v_add_f32 v223, v223, v27
    v_cvt_pk_bf16_f32 v219, v219, v223
    v_and_b32 v223, 0xffff0000, v219
    v_lshlrev_b32 v219, 16, v219
    v_mul_f32 v219, v219, v23
    v_mul_f32 v223, v223, v23
    v_cvt_pk_bf16_f32 v219, v219, v223
    s_not_b64 vcc, vcc
    v_cndmask_b32_dpp v112, v194, v192, vcc row_ror:8 row_mask:0xf bank_mask:0xf
    v_cndmask_b32_dpp v113, v202, v200, vcc row_ror:8 row_mask:0xf bank_mask:0xf
    v_cndmask_b32_dpp v114, v210, v208, vcc row_ror:8 row_mask:0xf bank_mask:0xf
    v_cndmask_b32_dpp v115, v218, v216, vcc row_ror:8 row_mask:0xf bank_mask:0xf
    v_cndmask_b32_dpp v116, v195, v193, vcc row_ror:8 row_mask:0xf bank_mask:0xf
    v_cndmask_b32_dpp v117, v203, v201, vcc row_ror:8 row_mask:0xf bank_mask:0xf
    v_cndmask_b32_dpp v118, v211, v209, vcc row_ror:8 row_mask:0xf bank_mask:0xf
    v_cndmask_b32_dpp v119, v219, v217, vcc row_ror:8 row_mask:0xf bank_mask:0xf
    buffer_load_dwordx4 v[252:255], v11, s[8:11], s54 offen
    v_mfma_f32_16x16x32_bf16 a[108:111], v[108:111], a[164:167], a[108:111]
    s_waitcnt lgkmcnt(4)
    buffer_load_dwordx4 v14, s[4:7], s44 offen offset:2048 lds
    s_not_b64 vcc, vcc
    v_cndmask_b32_dpp v120, v192, v194, vcc row_ror:8 row_mask:0xf bank_mask:0xf
    v_mfma_f32_16x16x32_bf16 a[0:3], v[112:115], a[168:171], a[0:3]
    ds_read_b128 a[192:195], v29 offset:3072
    v_cndmask_b32_dpp v121, v200, v202, vcc row_ror:8 row_mask:0xf bank_mask:0xf
    v_cndmask_b32_dpp v122, v208, v210, vcc row_ror:8 row_mask:0xf bank_mask:0xf
    v_cndmask_b32_dpp v123, v216, v218, vcc row_ror:8 row_mask:0xf bank_mask:0xf
    v_mfma_f32_16x16x32_bf16 a[4:7], v[116:119], a[168:171], a[4:7]
    v_cndmask_b32_dpp v124, v193, v195, vcc row_ror:8 row_mask:0xf bank_mask:0xf
    v_cndmask_b32_dpp v125, v201, v203, vcc row_ror:8 row_mask:0xf bank_mask:0xf
    v_cndmask_b32_dpp v126, v209, v211, vcc row_ror:8 row_mask:0xf bank_mask:0xf
    v_cndmask_b32_dpp v127, v217, v219, vcc row_ror:8 row_mask:0xf bank_mask:0xf
    v_mfma_f32_16x16x32_bf16 a[8:11], v[112:115], a[172:175], a[8:11]
    ds_read_b128 a[196:199], v29 offset:11264
    s_waitcnt vmcnt(11)
    v_cvt_f32_i32 v224, v224
    v_cvt_f32_i32 v228, v228
    v_add_f32 v224, v224, v24
    v_mfma_f32_16x16x32_bf16 a[12:15], v[116:119], a[172:175], a[12:15]
    s_waitcnt lgkmcnt(4)
    v_add_f32 v228, v228, v24
    s_add_u32 m0, s67, 65536
    v_add_u32 v14, s64, v12
    buffer_load_dwordx4 v14, s[4:7], s38 offen offset:0 lds
    v_mfma_f32_16x16x32_bf16 a[16:19], v[112:115], a[176:179], a[16:19]
    ds_read_b128 a[152:155], v29 offset:16384
    v_cvt_pk_bf16_f32 v224, v224, v228
    v_and_b32 v228, 0xffff0000, v224
    v_lshlrev_b32 v224, 16, v224
    v_mfma_f32_16x16x32_bf16 a[20:23], v[116:119], a[176:179], a[20:23]
    v_mul_f32 v224, v224, v20
    v_mul_f32 v228, v228, v20
    v_cvt_pk_bf16_f32 v224, v224, v228
    v_cvt_f32_i32 v225, v225
    v_mfma_f32_16x16x32_bf16 a[24:27], v[112:115], a[180:183], a[24:27]
    ds_read_b128 a[156:159], v29 offset:24576
    v_cvt_f32_i32 v229, v229
    buffer_load_dwordx4 v[160:163], v4, s[8:11], s55 offen
    v_add_f32 v225, v225, v25
    v_mfma_f32_16x16x32_bf16 a[28:31], v[116:119], a[180:183], a[28:31]
    s_waitcnt lgkmcnt(4)
    v_add_f32 v229, v229, v25
    v_cvt_pk_bf16_f32 v225, v225, v229
    v_and_b32 v229, 0xffff0000, v225
    v_mfma_f32_16x16x32_bf16 a[32:35], v[112:115], a[184:187], a[32:35]
    ds_read_b128 a[160:163], v29 offset:17408
    v_lshlrev_b32 v225, 16, v225
    v_mul_f32 v225, v225, v21
    v_mul_f32 v229, v229, v21
    v_mfma_f32_16x16x32_bf16 a[36:39], v[116:119], a[184:187], a[36:39]
    v_cvt_pk_bf16_f32 v225, v225, v229
    v_cvt_f32_i32 v226, v226
    v_cvt_f32_i32 v230, v230
    v_add_f32 v226, v226, v26
    v_mfma_f32_16x16x32_bf16 a[40:43], v[112:115], a[188:191], a[40:43]
    ds_read_b128 a[164:167], v29 offset:25600
    v_add_f32 v230, v230, v26
    v_cvt_pk_bf16_f32 v226, v226, v230
    v_and_b32 v230, 0xffff0000, v226
    v_mfma_f32_16x16x32_bf16 a[44:47], v[116:119], a[188:191], a[44:47]
    s_waitcnt lgkmcnt(4)
    v_lshlrev_b32 v226, 16, v226
    v_mul_f32 v226, v226, v22
    v_mul_f32 v230, v230, v22
    v_mfma_f32_16x16x32_bf16 a[48:51], v[112:115], a[192:195], a[48:51]
    ds_read_b128 a[168:171], v29 offset:18432
    v_cvt_pk_bf16_f32 v226, v226, v230
    buffer_load_dwordx4 v14, s[4:7], s39 offen offset:1024 lds
    v_cvt_f32_i32 v227, v227
    v_mfma_f32_16x16x32_bf16 a[52:55], v[116:119], a[192:195], a[52:55]
    v_cvt_f32_i32 v231, v231
    v_add_f32 v227, v227, v27
    v_add_f32 v231, v231, v27
    v_cvt_pk_bf16_f32 v227, v227, v231
    v_mfma_f32_16x16x32_bf16 a[56:59], v[112:115], a[196:199], a[56:59]
    ds_read_b128 a[172:175], v29 offset:26624
    buffer_load_dwordx4 v[164:167], v5, s[8:11], s55 offen
    v_and_b32 v231, 0xffff0000, v227
    v_lshlrev_b32 v227, 16, v227
    v_mfma_f32_16x16x32_bf16 a[60:63], v[116:119], a[196:199], a[60:63]
    s_waitcnt lgkmcnt(4)
    v_mul_f32 v227, v227, v23
    v_mul_f32 v231, v231, v23
    v_cvt_pk_bf16_f32 v227, v227, v231
    v_mfma_f32_16x16x32_bf16 a[64:67], v[112:115], a[152:155], a[64:67]
    ds_read_b128 a[176:179], v30 offset:0
    s_waitcnt vmcnt(12)
    v_cvt_f32_i32 v232, v232
    v_cvt_f32_i32 v236, v236
    v_add_f32 v232, v232, v24
    v_mfma_f32_16x16x32_bf16 a[68:71], v[116:119], a[152:155], a[68:71]
    v_add_f32 v236, v236, v24
    v_cvt_pk_bf16_f32 v232, v232, v236
    v_and_b32 v236, 0xffff0000, v232
    v_lshlrev_b32 v232, 16, v232
    v_mfma_f32_16x16x32_bf16 a[72:75], v[112:115], a[156:159], a[72:75]
    ds_read_b128 a[180:183], v30 offset:8192
    v_mul_f32 v232, v232, v20
    v_mul_f32 v236, v236, v20
    v_cvt_pk_bf16_f32 v232, v232, v236
    v_mfma_f32_16x16x32_bf16 a[76:79], v[116:119], a[156:159], a[76:79]
    s_waitcnt lgkmcnt(4)
    v_cvt_f32_i32 v233, v233
    v_cvt_f32_i32 v237, v237
    v_add_f32 v233, v233, v25
    v_mfma_f32_16x16x32_bf16 a[80:83], v[112:115], a[160:163], a[80:83]
    ds_read_b128 a[184:187], v30 offset:1024
    v_add_f32 v237, v237, v25
    v_cvt_pk_bf16_f32 v233, v233, v237
    v_and_b32 v237, 0xffff0000, v233
    v_mfma_f32_16x16x32_bf16 a[84:87], v[116:119], a[160:163], a[84:87]
    v_lshlrev_b32 v233, 16, v233
    buffer_load_dwordx4 v14, s[4:7], s40 offen offset:2048 lds
    v_mul_f32 v233, v233, v21
    v_mul_f32 v237, v237, v21
    v_mfma_f32_16x16x32_bf16 a[88:91], v[112:115], a[164:167], a[88:91]
    ds_read_b128 a[188:191], v30 offset:9216
    buffer_load_dwordx4 v[168:171], v6, s[8:11], s55 offen
    v_cvt_pk_bf16_f32 v233, v233, v237
    v_cvt_f32_i32 v234, v234
    v_mfma_f32_16x16x32_bf16 a[92:95], v[116:119], a[164:167], a[92:95]
    s_waitcnt lgkmcnt(4)
    v_cvt_f32_i32 v238, v238
    v_add_f32 v234, v234, v26
    v_add_f32 v238, v238, v26
    v_mfma_f32_16x16x32_bf16 a[96:99], v[112:115], a[168:171], a[96:99]
    ds_read_b128 a[192:195], v30 offset:2048
    v_cvt_pk_bf16_f32 v234, v234, v238
    v_and_b32 v238, 0xffff0000, v234
    v_lshlrev_b32 v234, 16, v234
    v_mfma_f32_16x16x32_bf16 a[100:103], v[116:119], a[168:171], a[100:103]
    v_mul_f32 v234, v234, v22
    v_mul_f32 v238, v238, v22
    v_cvt_pk_bf16_f32 v234, v234, v238
    v_cvt_f32_i32 v235, v235
    v_mfma_f32_16x16x32_bf16 a[104:107], v[112:115], a[172:175], a[104:107]
    ds_read_b128 a[196:199], v30 offset:10240
    v_cvt_f32_i32 v239, v239
    v_add_f32 v235, v235, v27
    v_add_f32 v239, v239, v27
    v_mfma_f32_16x16x32_bf16 a[108:111], v[116:119], a[172:175], a[108:111]
    s_waitcnt lgkmcnt(4)
    v_cvt_pk_bf16_f32 v235, v235, v239
    v_and_b32 v239, 0xffff0000, v235
    v_lshlrev_b32 v235, 16, v235
    v_mfma_f32_16x16x32_bf16 a[0:3], v[120:123], a[176:179], a[0:3]
    ds_read_b128 a[152:155], v30 offset:3072
    v_mul_f32 v235, v235, v23
    v_mul_f32 v239, v239, v23
    v_cvt_pk_bf16_f32 v235, v235, v239
    v_mfma_f32_16x16x32_bf16 a[4:7], v[124:127], a[176:179], a[4:7]
    s_waitcnt vmcnt(10)
    v_cvt_f32_i32 v240, v240
    v_cvt_f32_i32 v244, v244
    buffer_load_dwordx4 v[172:175], v7, s[8:11], s55 offen
    v_add_f32 v240, v240, v24
    v_mfma_f32_16x16x32_bf16 a[8:11], v[120:123], a[180:183], a[8:11]
    ds_read_b128 a[156:159], v30 offset:11264
    v_add_f32 v244, v244, v24
    buffer_load_dwordx4 v14, s[4:7], s41 offen offset:3072 lds
    v_cvt_pk_bf16_f32 v240, v240, v244
    v_mfma_f32_16x16x32_bf16 a[12:15], v[124:127], a[180:183], a[12:15]
    s_waitcnt lgkmcnt(4)
    v_and_b32 v244, 0xffff0000, v240
    v_lshlrev_b32 v240, 16, v240
    v_mul_f32 v240, v240, v20
    v_mfma_f32_16x16x32_bf16 a[16:19], v[120:123], a[184:187], a[16:19]
    ds_read_b128 a[160:163], v30 offset:16384
    v_mul_f32 v244, v244, v20
    v_cvt_pk_bf16_f32 v240, v240, v244
    v_cvt_f32_i32 v241, v241
    v_mfma_f32_16x16x32_bf16 a[20:23], v[124:127], a[184:187], a[20:23]
    v_cvt_f32_i32 v245, v245
    v_add_f32 v241, v241, v25
    v_add_f32 v245, v245, v25
    v_cvt_pk_bf16_f32 v241, v241, v245
    v_mfma_f32_16x16x32_bf16 a[24:27], v[120:123], a[188:191], a[24:27]
    ds_read_b128 a[164:167], v30 offset:24576
    v_and_b32 v245, 0xffff0000, v241
    v_lshlrev_b32 v241, 16, v241
    v_mul_f32 v241, v241, v21
    v_mfma_f32_16x16x32_bf16 a[28:31], v[124:127], a[188:191], a[28:31]
    s_waitcnt lgkmcnt(4)
    v_mul_f32 v245, v245, v21
    v_cvt_pk_bf16_f32 v241, v241, v245
    v_cvt_f32_i32 v242, v242
    v_mfma_f32_16x16x32_bf16 a[32:35], v[120:123], a[192:195], a[32:35]
    ds_read_b128 a[168:171], v30 offset:17408
    v_cvt_f32_i32 v246, v246
    v_add_f32 v242, v242, v26
    v_add_f32 v246, v246, v26
    v_mfma_f32_16x16x32_bf16 a[36:39], v[124:127], a[192:195], a[36:39]
    v_cvt_pk_bf16_f32 v242, v242, v246
    buffer_load_dwordx4 v[176:179], v8, s[8:11], s55 offen
    v_and_b32 v246, 0xffff0000, v242
    v_lshlrev_b32 v242, 16, v242
    v_mfma_f32_16x16x32_bf16 a[40:43], v[120:123], a[196:199], a[40:43]
    ds_read_b128 a[172:175], v30 offset:25600
    v_mul_f32 v242, v242, v22
    v_mul_f32 v246, v246, v22
    v_cvt_pk_bf16_f32 v242, v242, v246
    v_mfma_f32_16x16x32_bf16 a[44:47], v[124:127], a[196:199], a[44:47]
    s_waitcnt lgkmcnt(4)
    s_add_u32 m0, s67, 81920
    s_nop 0
    buffer_load_dwordx4 v14, s[4:7], s42 offen offset:0 lds
    v_cvt_f32_i32 v243, v243
    v_mfma_f32_16x16x32_bf16 a[48:51], v[120:123], a[152:155], a[48:51]
    ds_read_b128 a[176:179], v30 offset:18432
    v_cvt_f32_i32 v247, v247
    v_add_f32 v243, v243, v27
    v_add_f32 v247, v247, v27
    v_mfma_f32_16x16x32_bf16 a[52:55], v[124:127], a[152:155], a[52:55]
    v_cvt_pk_bf16_f32 v243, v243, v247
    v_and_b32 v247, 0xffff0000, v243
    v_lshlrev_b32 v243, 16, v243
    v_mul_f32 v243, v243, v23
    v_mfma_f32_16x16x32_bf16 a[56:59], v[120:123], a[156:159], a[56:59]
    ds_read_b128 a[180:183], v30 offset:26624
    v_mul_f32 v247, v247, v23
    v_cvt_pk_bf16_f32 v243, v243, v247
    s_waitcnt vmcnt(11)
    v_cvt_f32_i32 v248, v248
    v_mfma_f32_16x16x32_bf16 a[60:63], v[124:127], a[156:159], a[60:63]
    s_waitcnt lgkmcnt(4)
    v_cvt_f32_i32 v252, v252
    v_add_f32 v248, v248, v24
    v_add_f32 v252, v252, v24
    v_mfma_f32_16x16x32_bf16 a[64:67], v[120:123], a[160:163], a[64:67]
    s_waitcnt vmcnt(10)
    s_barrier
    ds_read_b128 a[184:187], v29 offset:32768
    v_cvt_pk_bf16_f32 v248, v248, v252
    v_mfma_f32_16x16x32_bf16 a[68:71], v[124:127], a[160:163], a[68:71]
    v_and_b32 v252, 0xffff0000, v248
    v_lshlrev_b32 v248, 16, v248
    v_mul_f32 v248, v248, v20
    buffer_load_dwordx4 v[180:183], v9, s[8:11], s55 offen
    v_mfma_f32_16x16x32_bf16 a[72:75], v[120:123], a[164:167], a[72:75]
    ds_read_b128 a[188:191], v29 offset:40960
    v_mul_f32 v252, v252, v20
    v_cvt_pk_bf16_f32 v248, v248, v252
    v_cvt_f32_i32 v249, v249
    v_mfma_f32_16x16x32_bf16 a[76:79], v[124:127], a[164:167], a[76:79]
    s_waitcnt lgkmcnt(4)
    v_cvt_f32_i32 v253, v253
    v_add_f32 v249, v249, v25
    v_add_f32 v253, v253, v25
    v_mfma_f32_16x16x32_bf16 a[80:83], v[120:123], a[168:171], a[80:83]
    ds_read_b128 a[192:195], v29 offset:33792
    v_cvt_pk_bf16_f32 v249, v249, v253
    v_and_b32 v253, 0xffff0000, v249
    v_lshlrev_b32 v249, 16, v249
    v_mfma_f32_16x16x32_bf16 a[84:87], v[124:127], a[168:171], a[84:87]
    buffer_load_dwordx4 v14, s[4:7], s43 offen offset:1024 lds
    v_mul_f32 v249, v249, v21
    v_mul_f32 v253, v253, v21
    v_cvt_pk_bf16_f32 v249, v249, v253
    v_mfma_f32_16x16x32_bf16 a[88:91], v[120:123], a[172:175], a[88:91]
    ds_read_b128 a[196:199], v29 offset:41984
    v_cvt_f32_i32 v250, v250
    v_cvt_f32_i32 v254, v254
    v_add_f32 v250, v250, v26
    v_mfma_f32_16x16x32_bf16 a[92:95], v[124:127], a[172:175], a[92:95]
    s_waitcnt lgkmcnt(4)
    v_add_f32 v254, v254, v26
    v_cvt_pk_bf16_f32 v250, v250, v254
    v_and_b32 v254, 0xffff0000, v250
    v_mfma_f32_16x16x32_bf16 a[96:99], v[120:123], a[176:179], a[96:99]
    ds_read_b128 a[152:155], v29 offset:34816
    v_lshlrev_b32 v250, 16, v250
    v_mul_f32 v250, v250, v22
    v_mul_f32 v254, v254, v22
    v_mfma_f32_16x16x32_bf16 a[100:103], v[124:127], a[176:179], a[100:103]
    v_cvt_pk_bf16_f32 v250, v250, v254
    v_cvt_f32_i32 v251, v251
    v_cvt_f32_i32 v255, v255
    buffer_load_dwordx4 v[184:187], v10, s[8:11], s55 offen
    v_mfma_f32_16x16x32_bf16 a[104:107], v[120:123], a[180:183], a[104:107]
    ds_read_b128 a[156:159], v29 offset:43008
    v_add_f32 v251, v251, v27
    v_add_f32 v255, v255, v27
    v_cvt_pk_bf16_f32 v251, v251, v255
    v_and_b32 v255, 0xffff0000, v251
    v_lshlrev_b32 v251, 16, v251
    v_mul_f32 v251, v251, v23
    v_mul_f32 v255, v255, v23
    v_cvt_pk_bf16_f32 v251, v251, v255
    s_not_b64 vcc, vcc
    v_cndmask_b32_dpp v128, v226, v224, vcc row_ror:8 row_mask:0xf bank_mask:0xf
    v_cndmask_b32_dpp v129, v234, v232, vcc row_ror:8 row_mask:0xf bank_mask:0xf
    v_cndmask_b32_dpp v130, v242, v240, vcc row_ror:8 row_mask:0xf bank_mask:0xf
    v_cndmask_b32_dpp v131, v250, v248, vcc row_ror:8 row_mask:0xf bank_mask:0xf
    v_cndmask_b32_dpp v132, v227, v225, vcc row_ror:8 row_mask:0xf bank_mask:0xf
    v_cndmask_b32_dpp v133, v235, v233, vcc row_ror:8 row_mask:0xf bank_mask:0xf
    v_cndmask_b32_dpp v134, v243, v241, vcc row_ror:8 row_mask:0xf bank_mask:0xf
    v_cndmask_b32_dpp v135, v251, v249, vcc row_ror:8 row_mask:0xf bank_mask:0xf
    buffer_load_dwordx4 v[188:191], v11, s[8:11], s55 offen
    v_mfma_f32_16x16x32_bf16 a[108:111], v[124:127], a[180:183], a[108:111]
    s_waitcnt lgkmcnt(4)
    buffer_load_dwordx4 v14, s[4:7], s44 offen offset:2048 lds
    s_not_b64 vcc, vcc
    v_cndmask_b32_dpp v136, v224, v226, vcc row_ror:8 row_mask:0xf bank_mask:0xf
    v_mfma_f32_16x16x32_bf16 a[0:3], v[128:131], a[184:187], a[0:3]
    ds_read_b128 a[160:163], v29 offset:35840
    v_cndmask_b32_dpp v137, v232, v234, vcc row_ror:8 row_mask:0xf bank_mask:0xf
    v_cndmask_b32_dpp v138, v240, v242, vcc row_ror:8 row_mask:0xf bank_mask:0xf
    v_cndmask_b32_dpp v139, v248, v250, vcc row_ror:8 row_mask:0xf bank_mask:0xf
    v_mfma_f32_16x16x32_bf16 a[4:7], v[132:135], a[184:187], a[4:7]
    v_cndmask_b32_dpp v140, v225, v227, vcc row_ror:8 row_mask:0xf bank_mask:0xf
    v_cndmask_b32_dpp v141, v233, v235, vcc row_ror:8 row_mask:0xf bank_mask:0xf
    v_cndmask_b32_dpp v142, v241, v243, vcc row_ror:8 row_mask:0xf bank_mask:0xf
    v_cndmask_b32_dpp v143, v249, v251, vcc row_ror:8 row_mask:0xf bank_mask:0xf
    v_mfma_f32_16x16x32_bf16 a[8:11], v[128:131], a[188:191], a[8:11]
    ds_read_b128 a[164:167], v29 offset:44032
    s_waitcnt vmcnt(11)
    v_cvt_f32_i32 v160, v160
    v_cvt_f32_i32 v164, v164
    v_add_f32 v160, v160, v24
    v_mfma_f32_16x16x32_bf16 a[12:15], v[132:135], a[188:191], a[12:15]
    s_waitcnt lgkmcnt(4)
    v_add_f32 v164, v164, v24
    s_add_u32 m0, s67, 98304
    v_add_u32 v14, s65, v12
    buffer_load_dwordx4 v14, s[4:7], s38 offen offset:0 lds
    v_mfma_f32_16x16x32_bf16 a[16:19], v[128:131], a[192:195], a[16:19]
    ds_read_b128 a[168:171], v29 offset:49152
    v_cvt_pk_bf16_f32 v160, v160, v164
    v_and_b32 v164, 0xffff0000, v160
    v_lshlrev_b32 v160, 16, v160
    v_mfma_f32_16x16x32_bf16 a[20:23], v[132:135], a[192:195], a[20:23]
    v_mul_f32 v160, v160, v20
    v_mul_f32 v164, v164, v20
    v_cvt_pk_bf16_f32 v160, v160, v164
    v_cvt_f32_i32 v161, v161
    v_mfma_f32_16x16x32_bf16 a[24:27], v[128:131], a[196:199], a[24:27]
    ds_read_b128 a[172:175], v29 offset:57344
    v_cvt_f32_i32 v165, v165
    buffer_load_dwordx4 v[192:195], v4, s[8:11], s56 offen
    v_add_f32 v161, v161, v25
    v_mfma_f32_16x16x32_bf16 a[28:31], v[132:135], a[196:199], a[28:31]
    s_waitcnt lgkmcnt(4)
    v_add_f32 v165, v165, v25
    v_cvt_pk_bf16_f32 v161, v161, v165
    v_and_b32 v165, 0xffff0000, v161
    v_mfma_f32_16x16x32_bf16 a[32:35], v[128:131], a[152:155], a[32:35]
    ds_read_b128 a[176:179], v29 offset:50176
    v_lshlrev_b32 v161, 16, v161
    v_mul_f32 v161, v161, v21
    v_mul_f32 v165, v165, v21
    v_mfma_f32_16x16x32_bf16 a[36:39], v[132:135], a[152:155], a[36:39]
    v_cvt_pk_bf16_f32 v161, v161, v165
    v_cvt_f32_i32 v162, v162
    v_cvt_f32_i32 v166, v166
    v_add_f32 v162, v162, v26
    v_mfma_f32_16x16x32_bf16 a[40:43], v[128:131], a[156:159], a[40:43]
    ds_read_b128 a[180:183], v29 offset:58368
    v_add_f32 v166, v166, v26
    v_cvt_pk_bf16_f32 v162, v162, v166
    v_and_b32 v166, 0xffff0000, v162
    v_mfma_f32_16x16x32_bf16 a[44:47], v[132:135], a[156:159], a[44:47]
    s_waitcnt lgkmcnt(4)
    v_lshlrev_b32 v162, 16, v162
    v_mul_f32 v162, v162, v22
    v_mul_f32 v166, v166, v22
    v_mfma_f32_16x16x32_bf16 a[48:51], v[128:131], a[160:163], a[48:51]
    ds_read_b128 a[184:187], v29 offset:51200
    v_cvt_pk_bf16_f32 v162, v162, v166
    buffer_load_dwordx4 v14, s[4:7], s39 offen offset:1024 lds
    v_cvt_f32_i32 v163, v163
    v_mfma_f32_16x16x32_bf16 a[52:55], v[132:135], a[160:163], a[52:55]
    v_cvt_f32_i32 v167, v167
    v_add_f32 v163, v163, v27
    v_add_f32 v167, v167, v27
    v_cvt_pk_bf16_f32 v163, v163, v167
    v_mfma_f32_16x16x32_bf16 a[56:59], v[128:131], a[164:167], a[56:59]
    ds_read_b128 a[188:191], v29 offset:59392
    buffer_load_dwordx4 v[196:199], v5, s[8:11], s56 offen
    v_and_b32 v167, 0xffff0000, v163
    v_lshlrev_b32 v163, 16, v163
    v_mfma_f32_16x16x32_bf16 a[60:63], v[132:135], a[164:167], a[60:63]
    s_waitcnt lgkmcnt(4)
    v_mul_f32 v163, v163, v23
    v_mul_f32 v167, v167, v23
    v_cvt_pk_bf16_f32 v163, v163, v167
    v_mfma_f32_16x16x32_bf16 a[64:67], v[128:131], a[168:171], a[64:67]
    ds_read_b128 a[192:195], v30 offset:32768
    s_waitcnt vmcnt(12)
    v_cvt_f32_i32 v168, v168
    v_cvt_f32_i32 v172, v172
    v_add_f32 v168, v168, v24
    v_mfma_f32_16x16x32_bf16 a[68:71], v[132:135], a[168:171], a[68:71]
    v_add_f32 v172, v172, v24
    v_cvt_pk_bf16_f32 v168, v168, v172
    v_and_b32 v172, 0xffff0000, v168
    v_lshlrev_b32 v168, 16, v168
    v_mfma_f32_16x16x32_bf16 a[72:75], v[128:131], a[172:175], a[72:75]
    ds_read_b128 a[196:199], v30 offset:40960
    v_mul_f32 v168, v168, v20
    v_mul_f32 v172, v172, v20
    v_cvt_pk_bf16_f32 v168, v168, v172
    v_mfma_f32_16x16x32_bf16 a[76:79], v[132:135], a[172:175], a[76:79]
    s_waitcnt lgkmcnt(4)
    v_cvt_f32_i32 v169, v169
    v_cvt_f32_i32 v173, v173
    v_add_f32 v169, v169, v25
    v_mfma_f32_16x16x32_bf16 a[80:83], v[128:131], a[176:179], a[80:83]
    ds_read_b128 a[152:155], v30 offset:33792
    v_add_f32 v173, v173, v25
    v_cvt_pk_bf16_f32 v169, v169, v173
    v_and_b32 v173, 0xffff0000, v169
    v_mfma_f32_16x16x32_bf16 a[84:87], v[132:135], a[176:179], a[84:87]
    v_lshlrev_b32 v169, 16, v169
    buffer_load_dwordx4 v14, s[4:7], s40 offen offset:2048 lds
    v_mul_f32 v169, v169, v21
    v_mul_f32 v173, v173, v21
    v_mfma_f32_16x16x32_bf16 a[88:91], v[128:131], a[180:183], a[88:91]
    ds_read_b128 a[156:159], v30 offset:41984
    buffer_load_dwordx4 v[200:203], v6, s[8:11], s56 offen
    v_cvt_pk_bf16_f32 v169, v169, v173
    v_cvt_f32_i32 v170, v170
    v_mfma_f32_16x16x32_bf16 a[92:95], v[132:135], a[180:183], a[92:95]
    s_waitcnt lgkmcnt(4)
    v_cvt_f32_i32 v174, v174
    v_add_f32 v170, v170, v26
    v_add_f32 v174, v174, v26
    v_mfma_f32_16x16x32_bf16 a[96:99], v[128:131], a[184:187], a[96:99]
    ds_read_b128 a[160:163], v30 offset:34816
    v_cvt_pk_bf16_f32 v170, v170, v174
    v_and_b32 v174, 0xffff0000, v170
    v_lshlrev_b32 v170, 16, v170
    v_mfma_f32_16x16x32_bf16 a[100:103], v[132:135], a[184:187], a[100:103]
    v_mul_f32 v170, v170, v22
    v_mul_f32 v174, v174, v22
    v_cvt_pk_bf16_f32 v170, v170, v174
    v_cvt_f32_i32 v171, v171
    v_mfma_f32_16x16x32_bf16 a[104:107], v[128:131], a[188:191], a[104:107]
    ds_read_b128 a[164:167], v30 offset:43008
    v_cvt_f32_i32 v175, v175
    v_add_f32 v171, v171, v27
    v_add_f32 v175, v175, v27
    v_mfma_f32_16x16x32_bf16 a[108:111], v[132:135], a[188:191], a[108:111]
    s_waitcnt lgkmcnt(4)
    v_cvt_pk_bf16_f32 v171, v171, v175
    v_and_b32 v175, 0xffff0000, v171
    v_lshlrev_b32 v171, 16, v171
    v_mfma_f32_16x16x32_bf16 a[0:3], v[136:139], a[192:195], a[0:3]
    ds_read_b128 a[168:171], v30 offset:35840
    v_mul_f32 v171, v171, v23
    v_mul_f32 v175, v175, v23
    v_cvt_pk_bf16_f32 v171, v171, v175
    v_mfma_f32_16x16x32_bf16 a[4:7], v[140:143], a[192:195], a[4:7]
    s_waitcnt vmcnt(10)
    v_cvt_f32_i32 v176, v176
    v_cvt_f32_i32 v180, v180
    buffer_load_dwordx4 v[204:207], v7, s[8:11], s56 offen
    v_add_f32 v176, v176, v24
    v_mfma_f32_16x16x32_bf16 a[8:11], v[136:139], a[196:199], a[8:11]
    ds_read_b128 a[172:175], v30 offset:44032
    v_add_f32 v180, v180, v24
    buffer_load_dwordx4 v14, s[4:7], s41 offen offset:3072 lds
    v_cvt_pk_bf16_f32 v176, v176, v180
    v_mfma_f32_16x16x32_bf16 a[12:15], v[140:143], a[196:199], a[12:15]
    s_waitcnt lgkmcnt(4)
    v_and_b32 v180, 0xffff0000, v176
    v_lshlrev_b32 v176, 16, v176
    v_mul_f32 v176, v176, v20
    v_mfma_f32_16x16x32_bf16 a[16:19], v[136:139], a[152:155], a[16:19]
    ds_read_b128 a[176:179], v30 offset:49152
    v_mul_f32 v180, v180, v20
    v_cvt_pk_bf16_f32 v176, v176, v180
    v_cvt_f32_i32 v177, v177
    v_mfma_f32_16x16x32_bf16 a[20:23], v[140:143], a[152:155], a[20:23]
    v_cvt_f32_i32 v181, v181
    v_add_f32 v177, v177, v25
    v_add_f32 v181, v181, v25
    v_cvt_pk_bf16_f32 v177, v177, v181
    v_mfma_f32_16x16x32_bf16 a[24:27], v[136:139], a[156:159], a[24:27]
    ds_read_b128 a[180:183], v30 offset:57344
    v_and_b32 v181, 0xffff0000, v177
    v_lshlrev_b32 v177, 16, v177
    v_mul_f32 v177, v177, v21
    v_mfma_f32_16x16x32_bf16 a[28:31], v[140:143], a[156:159], a[28:31]
    s_waitcnt lgkmcnt(4)
    v_mul_f32 v181, v181, v21
    v_cvt_pk_bf16_f32 v177, v177, v181
    v_cvt_f32_i32 v178, v178
    v_mfma_f32_16x16x32_bf16 a[32:35], v[136:139], a[160:163], a[32:35]
    ds_read_b128 a[184:187], v30 offset:50176
    v_cvt_f32_i32 v182, v182
    v_add_f32 v178, v178, v26
    v_add_f32 v182, v182, v26
    v_mfma_f32_16x16x32_bf16 a[36:39], v[140:143], a[160:163], a[36:39]
    v_cvt_pk_bf16_f32 v178, v178, v182
    buffer_load_dwordx4 v[208:211], v8, s[8:11], s56 offen
    v_and_b32 v182, 0xffff0000, v178
    v_lshlrev_b32 v178, 16, v178
    v_mfma_f32_16x16x32_bf16 a[40:43], v[136:139], a[164:167], a[40:43]
    ds_read_b128 a[188:191], v30 offset:58368
    v_mul_f32 v178, v178, v22
    v_mul_f32 v182, v182, v22
    v_cvt_pk_bf16_f32 v178, v178, v182
    v_mfma_f32_16x16x32_bf16 a[44:47], v[140:143], a[164:167], a[44:47]
    s_waitcnt lgkmcnt(4)
    s_add_u32 m0, s67, 114688
    s_nop 0
    buffer_load_dwordx4 v14, s[4:7], s42 offen offset:0 lds
    v_cvt_f32_i32 v179, v179
    v_mfma_f32_16x16x32_bf16 a[48:51], v[136:139], a[168:171], a[48:51]
    ds_read_b128 a[192:195], v30 offset:51200
    v_cvt_f32_i32 v183, v183
    v_add_f32 v179, v179, v27
    v_add_f32 v183, v183, v27
    v_mfma_f32_16x16x32_bf16 a[52:55], v[140:143], a[168:171], a[52:55]
    v_cvt_pk_bf16_f32 v179, v179, v183
    v_and_b32 v183, 0xffff0000, v179
    v_lshlrev_b32 v179, 16, v179
    v_mul_f32 v179, v179, v23
    v_mfma_f32_16x16x32_bf16 a[56:59], v[136:139], a[172:175], a[56:59]
    ds_read_b128 a[196:199], v30 offset:59392
    v_mul_f32 v183, v183, v23
    v_cvt_pk_bf16_f32 v179, v179, v183
    s_waitcnt vmcnt(11)
    v_cvt_f32_i32 v184, v184
    v_mfma_f32_16x16x32_bf16 a[60:63], v[140:143], a[172:175], a[60:63]
    s_waitcnt lgkmcnt(4)
    v_cvt_f32_i32 v188, v188
    v_add_f32 v184, v184, v24
    v_add_f32 v188, v188, v24
    v_mfma_f32_16x16x32_bf16 a[64:67], v[136:139], a[176:179], a[64:67]
    s_waitcnt vmcnt(10)
    s_barrier
    ds_read_b128 a[152:155], v31 offset:0
    v_cvt_pk_bf16_f32 v184, v184, v188
    v_mfma_f32_16x16x32_bf16 a[68:71], v[140:143], a[176:179], a[68:71]
    v_and_b32 v188, 0xffff0000, v184
    v_lshlrev_b32 v184, 16, v184
    v_mul_f32 v184, v184, v20
    buffer_load_dwordx4 v[212:215], v9, s[8:11], s56 offen
    v_mfma_f32_16x16x32_bf16 a[72:75], v[136:139], a[180:183], a[72:75]
    ds_read_b128 a[156:159], v31 offset:8192
    v_mul_f32 v188, v188, v20
    v_cvt_pk_bf16_f32 v184, v184, v188
    v_cvt_f32_i32 v185, v185
    v_mfma_f32_16x16x32_bf16 a[76:79], v[140:143], a[180:183], a[76:79]
    s_waitcnt lgkmcnt(4)
    v_cvt_f32_i32 v189, v189
    v_add_f32 v185, v185, v25
    v_add_f32 v189, v189, v25
    v_mfma_f32_16x16x32_bf16 a[80:83], v[136:139], a[184:187], a[80:83]
    ds_read_b128 a[160:163], v31 offset:1024
    v_cvt_pk_bf16_f32 v185, v185, v189
    v_and_b32 v189, 0xffff0000, v185
    v_lshlrev_b32 v185, 16, v185
    v_mfma_f32_16x16x32_bf16 a[84:87], v[140:143], a[184:187], a[84:87]
    buffer_load_dwordx4 v14, s[4:7], s43 offen offset:1024 lds
    v_mul_f32 v185, v185, v21
    v_mul_f32 v189, v189, v21
    v_cvt_pk_bf16_f32 v185, v185, v189
    v_mfma_f32_16x16x32_bf16 a[88:91], v[136:139], a[188:191], a[88:91]
    ds_read_b128 a[164:167], v31 offset:9216
    v_cvt_f32_i32 v186, v186
    v_cvt_f32_i32 v190, v190
    v_add_f32 v186, v186, v26
    v_mfma_f32_16x16x32_bf16 a[92:95], v[140:143], a[188:191], a[92:95]
    s_waitcnt lgkmcnt(4)
    v_add_f32 v190, v190, v26
    v_cvt_pk_bf16_f32 v186, v186, v190
    v_and_b32 v190, 0xffff0000, v186
    v_mfma_f32_16x16x32_bf16 a[96:99], v[136:139], a[192:195], a[96:99]
    ds_read_b128 a[168:171], v31 offset:2048
    v_lshlrev_b32 v186, 16, v186
    v_mul_f32 v186, v186, v22
    v_mul_f32 v190, v190, v22
    v_mfma_f32_16x16x32_bf16 a[100:103], v[140:143], a[192:195], a[100:103]
    v_cvt_pk_bf16_f32 v186, v186, v190
    v_cvt_f32_i32 v187, v187
    v_cvt_f32_i32 v191, v191
    buffer_load_dwordx4 v[216:219], v10, s[8:11], s56 offen
    v_mfma_f32_16x16x32_bf16 a[104:107], v[136:139], a[196:199], a[104:107]
    ds_read_b128 a[172:175], v31 offset:10240
    v_add_f32 v187, v187, v27
    v_add_f32 v191, v191, v27
    v_cvt_pk_bf16_f32 v187, v187, v191
    v_and_b32 v191, 0xffff0000, v187
    v_lshlrev_b32 v187, 16, v187
    v_mul_f32 v187, v187, v23
    v_mul_f32 v191, v191, v23
    v_cvt_pk_bf16_f32 v187, v187, v191
    s_not_b64 vcc, vcc
    v_cndmask_b32_dpp v144, v162, v160, vcc row_ror:8 row_mask:0xf bank_mask:0xf
    v_cndmask_b32_dpp v145, v170, v168, vcc row_ror:8 row_mask:0xf bank_mask:0xf
    v_cndmask_b32_dpp v146, v178, v176, vcc row_ror:8 row_mask:0xf bank_mask:0xf
    v_cndmask_b32_dpp v147, v186, v184, vcc row_ror:8 row_mask:0xf bank_mask:0xf
    v_cndmask_b32_dpp v148, v163, v161, vcc row_ror:8 row_mask:0xf bank_mask:0xf
    v_cndmask_b32_dpp v149, v171, v169, vcc row_ror:8 row_mask:0xf bank_mask:0xf
    v_cndmask_b32_dpp v150, v179, v177, vcc row_ror:8 row_mask:0xf bank_mask:0xf
    v_cndmask_b32_dpp v151, v187, v185, vcc row_ror:8 row_mask:0xf bank_mask:0xf
    buffer_load_dwordx4 v[220:223], v11, s[8:11], s56 offen
    v_mfma_f32_16x16x32_bf16 a[108:111], v[140:143], a[196:199], a[108:111]
    s_waitcnt lgkmcnt(4)
    buffer_load_dwordx4 v14, s[4:7], s44 offen offset:2048 lds
    s_not_b64 vcc, vcc
    v_cndmask_b32_dpp v152, v160, v162, vcc row_ror:8 row_mask:0xf bank_mask:0xf
    v_mfma_f32_16x16x32_bf16 a[0:3], v[144:147], a[152:155], a[0:3]
    ds_read_b128 a[176:179], v31 offset:3072
    v_cndmask_b32_dpp v153, v168, v170, vcc row_ror:8 row_mask:0xf bank_mask:0xf
    v_cndmask_b32_dpp v154, v176, v178, vcc row_ror:8 row_mask:0xf bank_mask:0xf
    v_cndmask_b32_dpp v155, v184, v186, vcc row_ror:8 row_mask:0xf bank_mask:0xf
    v_mfma_f32_16x16x32_bf16 a[4:7], v[148:151], a[152:155], a[4:7]
    v_cndmask_b32_dpp v156, v161, v163, vcc row_ror:8 row_mask:0xf bank_mask:0xf
    v_cndmask_b32_dpp v157, v169, v171, vcc row_ror:8 row_mask:0xf bank_mask:0xf
    v_cndmask_b32_dpp v158, v177, v179, vcc row_ror:8 row_mask:0xf bank_mask:0xf
    v_cndmask_b32_dpp v159, v185, v187, vcc row_ror:8 row_mask:0xf bank_mask:0xf
    v_mfma_f32_16x16x32_bf16 a[8:11], v[144:147], a[156:159], a[8:11]
    ds_read_b128 a[180:183], v31 offset:11264
    s_waitcnt vmcnt(11)
    v_cvt_f32_i32 v192, v192
    v_cvt_f32_i32 v196, v196
    v_add_f32 v192, v192, v24
    v_mfma_f32_16x16x32_bf16 a[12:15], v[148:151], a[156:159], a[12:15]
    s_waitcnt lgkmcnt(4)
    v_add_f32 v196, v196, v24
    s_add_u32 m0, s67, 0
    v_add_u32 v14, s66, v12
    buffer_load_dwordx4 v14, s[4:7], s38 offen offset:0 lds
    v_mfma_f32_16x16x32_bf16 a[16:19], v[144:147], a[160:163], a[16:19]
    ds_read_b128 a[184:187], v31 offset:16384
    v_cvt_pk_bf16_f32 v192, v192, v196
    v_and_b32 v196, 0xffff0000, v192
    v_lshlrev_b32 v192, 16, v192
    v_mfma_f32_16x16x32_bf16 a[20:23], v[148:151], a[160:163], a[20:23]
    v_mul_f32 v192, v192, v20
    v_mul_f32 v196, v196, v20
    v_cvt_pk_bf16_f32 v192, v192, v196
    v_cvt_f32_i32 v193, v193
    v_mfma_f32_16x16x32_bf16 a[24:27], v[144:147], a[164:167], a[24:27]
    ds_read_b128 a[188:191], v31 offset:24576
    v_cvt_f32_i32 v197, v197
    buffer_load_dwordx4 v[224:227], v4, s[8:11], s57 offen
    v_add_f32 v193, v193, v25
    v_mfma_f32_16x16x32_bf16 a[28:31], v[148:151], a[164:167], a[28:31]
    s_waitcnt lgkmcnt(4)
    v_add_f32 v197, v197, v25
    v_cvt_pk_bf16_f32 v193, v193, v197
    v_and_b32 v197, 0xffff0000, v193
    v_mfma_f32_16x16x32_bf16 a[32:35], v[144:147], a[168:171], a[32:35]
    ds_read_b128 a[192:195], v31 offset:17408
    v_lshlrev_b32 v193, 16, v193
    v_mul_f32 v193, v193, v21
    v_mul_f32 v197, v197, v21
    v_mfma_f32_16x16x32_bf16 a[36:39], v[148:151], a[168:171], a[36:39]
    v_cvt_pk_bf16_f32 v193, v193, v197
    v_cvt_f32_i32 v194, v194
    v_cvt_f32_i32 v198, v198
    v_add_f32 v194, v194, v26
    v_mfma_f32_16x16x32_bf16 a[40:43], v[144:147], a[172:175], a[40:43]
    ds_read_b128 a[196:199], v31 offset:25600
    v_add_f32 v198, v198, v26
    v_cvt_pk_bf16_f32 v194, v194, v198
    v_and_b32 v198, 0xffff0000, v194
    v_mfma_f32_16x16x32_bf16 a[44:47], v[148:151], a[172:175], a[44:47]
    s_waitcnt lgkmcnt(4)
    v_lshlrev_b32 v194, 16, v194
    v_mul_f32 v194, v194, v22
    v_mul_f32 v198, v198, v22
    v_mfma_f32_16x16x32_bf16 a[48:51], v[144:147], a[176:179], a[48:51]
    ds_read_b128 a[152:155], v31 offset:18432
    v_cvt_pk_bf16_f32 v194, v194, v198
    buffer_load_dwordx4 v14, s[4:7], s39 offen offset:1024 lds
    v_cvt_f32_i32 v195, v195
    v_mfma_f32_16x16x32_bf16 a[52:55], v[148:151], a[176:179], a[52:55]
    v_cvt_f32_i32 v199, v199
    v_add_f32 v195, v195, v27
    v_add_f32 v199, v199, v27
    v_cvt_pk_bf16_f32 v195, v195, v199
    v_mfma_f32_16x16x32_bf16 a[56:59], v[144:147], a[180:183], a[56:59]
    ds_read_b128 a[156:159], v31 offset:26624
    buffer_load_dwordx4 v[228:231], v5, s[8:11], s57 offen
    v_and_b32 v199, 0xffff0000, v195
    v_lshlrev_b32 v195, 16, v195
    v_mfma_f32_16x16x32_bf16 a[60:63], v[148:151], a[180:183], a[60:63]
    s_waitcnt lgkmcnt(4)
    v_mul_f32 v195, v195, v23
    v_mul_f32 v199, v199, v23
    v_cvt_pk_bf16_f32 v195, v195, v199
    v_mfma_f32_16x16x32_bf16 a[64:67], v[144:147], a[184:187], a[64:67]
    ds_read_b128 a[160:163], v32 offset:0
    s_waitcnt vmcnt(12)
    v_cvt_f32_i32 v200, v200
    v_cvt_f32_i32 v204, v204
    v_add_f32 v200, v200, v24
    v_mfma_f32_16x16x32_bf16 a[68:71], v[148:151], a[184:187], a[68:71]
    v_add_f32 v204, v204, v24
    v_cvt_pk_bf16_f32 v200, v200, v204
    v_and_b32 v204, 0xffff0000, v200
    v_lshlrev_b32 v200, 16, v200
    v_mfma_f32_16x16x32_bf16 a[72:75], v[144:147], a[188:191], a[72:75]
    ds_read_b128 a[164:167], v32 offset:8192
    v_mul_f32 v200, v200, v20
    v_mul_f32 v204, v204, v20
    v_cvt_pk_bf16_f32 v200, v200, v204
    v_mfma_f32_16x16x32_bf16 a[76:79], v[148:151], a[188:191], a[76:79]
    s_waitcnt lgkmcnt(4)
    v_cvt_f32_i32 v201, v201
    v_cvt_f32_i32 v205, v205
    v_add_f32 v201, v201, v25
    v_mfma_f32_16x16x32_bf16 a[80:83], v[144:147], a[192:195], a[80:83]
    ds_read_b128 a[168:171], v32 offset:1024
    v_add_f32 v205, v205, v25
    v_cvt_pk_bf16_f32 v201, v201, v205
    v_and_b32 v205, 0xffff0000, v201
    v_mfma_f32_16x16x32_bf16 a[84:87], v[148:151], a[192:195], a[84:87]
    v_lshlrev_b32 v201, 16, v201
    buffer_load_dwordx4 v14, s[4:7], s40 offen offset:2048 lds
    v_mul_f32 v201, v201, v21
    v_mul_f32 v205, v205, v21
    v_mfma_f32_16x16x32_bf16 a[88:91], v[144:147], a[196:199], a[88:91]
    ds_read_b128 a[172:175], v32 offset:9216
    buffer_load_dwordx4 v[232:235], v6, s[8:11], s57 offen
    v_cvt_pk_bf16_f32 v201, v201, v205
    v_cvt_f32_i32 v202, v202
    v_mfma_f32_16x16x32_bf16 a[92:95], v[148:151], a[196:199], a[92:95]
    s_waitcnt lgkmcnt(4)
    v_cvt_f32_i32 v206, v206
    v_add_f32 v202, v202, v26
    v_add_f32 v206, v206, v26
    v_mfma_f32_16x16x32_bf16 a[96:99], v[144:147], a[152:155], a[96:99]
    ds_read_b128 a[176:179], v32 offset:2048
    v_cvt_pk_bf16_f32 v202, v202, v206
    v_and_b32 v206, 0xffff0000, v202
    v_lshlrev_b32 v202, 16, v202
    v_mfma_f32_16x16x32_bf16 a[100:103], v[148:151], a[152:155], a[100:103]
    v_mul_f32 v202, v202, v22
    v_mul_f32 v206, v206, v22
    v_cvt_pk_bf16_f32 v202, v202, v206
    v_cvt_f32_i32 v203, v203
    v_mfma_f32_16x16x32_bf16 a[104:107], v[144:147], a[156:159], a[104:107]
    ds_read_b128 a[180:183], v32 offset:10240
    v_cvt_f32_i32 v207, v207
    v_add_f32 v203, v203, v27
    v_add_f32 v207, v207, v27
    v_mfma_f32_16x16x32_bf16 a[108:111], v[148:151], a[156:159], a[108:111]
    s_waitcnt lgkmcnt(4)
    v_cvt_pk_bf16_f32 v203, v203, v207
    v_and_b32 v207, 0xffff0000, v203
    v_lshlrev_b32 v203, 16, v203
    v_mfma_f32_16x16x32_bf16 a[0:3], v[152:155], a[160:163], a[0:3]
    ds_read_b128 a[184:187], v32 offset:3072
    v_mul_f32 v203, v203, v23
    v_mul_f32 v207, v207, v23
    v_cvt_pk_bf16_f32 v203, v203, v207
    v_mfma_f32_16x16x32_bf16 a[4:7], v[156:159], a[160:163], a[4:7]
    s_waitcnt vmcnt(10)
    v_cvt_f32_i32 v208, v208
    v_cvt_f32_i32 v212, v212
    buffer_load_dwordx4 v[236:239], v7, s[8:11], s57 offen
    v_add_f32 v208, v208, v24
    v_mfma_f32_16x16x32_bf16 a[8:11], v[152:155], a[164:167], a[8:11]
    ds_read_b128 a[188:191], v32 offset:11264
    v_add_f32 v212, v212, v24
    buffer_load_dwordx4 v14, s[4:7], s41 offen offset:3072 lds
    v_cvt_pk_bf16_f32 v208, v208, v212
    v_mfma_f32_16x16x32_bf16 a[12:15], v[156:159], a[164:167], a[12:15]
    s_waitcnt lgkmcnt(4)
    v_and_b32 v212, 0xffff0000, v208
    v_lshlrev_b32 v208, 16, v208
    v_mul_f32 v208, v208, v20
    v_mfma_f32_16x16x32_bf16 a[16:19], v[152:155], a[168:171], a[16:19]
    ds_read_b128 a[192:195], v32 offset:16384
    v_mul_f32 v212, v212, v20
    v_cvt_pk_bf16_f32 v208, v208, v212
    v_cvt_f32_i32 v209, v209
    v_mfma_f32_16x16x32_bf16 a[20:23], v[156:159], a[168:171], a[20:23]
    v_cvt_f32_i32 v213, v213
    v_add_f32 v209, v209, v25
    v_add_f32 v213, v213, v25
    v_cvt_pk_bf16_f32 v209, v209, v213
    v_mfma_f32_16x16x32_bf16 a[24:27], v[152:155], a[172:175], a[24:27]
    ds_read_b128 a[196:199], v32 offset:24576
    v_and_b32 v213, 0xffff0000, v209
    v_lshlrev_b32 v209, 16, v209
    v_mul_f32 v209, v209, v21
    v_mfma_f32_16x16x32_bf16 a[28:31], v[156:159], a[172:175], a[28:31]
    s_waitcnt lgkmcnt(4)
    v_mul_f32 v213, v213, v21
    v_cvt_pk_bf16_f32 v209, v209, v213
    v_cvt_f32_i32 v210, v210
    v_mfma_f32_16x16x32_bf16 a[32:35], v[152:155], a[176:179], a[32:35]
    ds_read_b128 a[152:155], v32 offset:17408
    v_cvt_f32_i32 v214, v214
    v_add_f32 v210, v210, v26
    v_add_f32 v214, v214, v26
    v_mfma_f32_16x16x32_bf16 a[36:39], v[156:159], a[176:179], a[36:39]
    v_cvt_pk_bf16_f32 v210, v210, v214
    buffer_load_dwordx4 v[240:243], v8, s[8:11], s57 offen
    v_and_b32 v214, 0xffff0000, v210
    v_lshlrev_b32 v210, 16, v210
    v_mfma_f32_16x16x32_bf16 a[40:43], v[152:155], a[180:183], a[40:43]
    ds_read_b128 a[156:159], v32 offset:25600
    v_mul_f32 v210, v210, v22
    v_mul_f32 v214, v214, v22
    v_cvt_pk_bf16_f32 v210, v210, v214
    v_mfma_f32_16x16x32_bf16 a[44:47], v[156:159], a[180:183], a[44:47]
    s_waitcnt lgkmcnt(4)
    s_add_u32 m0, s67, 16384
    s_nop 0
    buffer_load_dwordx4 v14, s[4:7], s42 offen offset:0 lds
    v_cvt_f32_i32 v211, v211
    v_mfma_f32_16x16x32_bf16 a[48:51], v[152:155], a[184:187], a[48:51]
    ds_read_b128 a[160:163], v32 offset:18432
    v_cvt_f32_i32 v215, v215
    v_add_f32 v211, v211, v27
    v_add_f32 v215, v215, v27
    v_mfma_f32_16x16x32_bf16 a[52:55], v[156:159], a[184:187], a[52:55]
    v_cvt_pk_bf16_f32 v211, v211, v215
    v_and_b32 v215, 0xffff0000, v211
    v_lshlrev_b32 v211, 16, v211
    v_mul_f32 v211, v211, v23
    v_mfma_f32_16x16x32_bf16 a[56:59], v[152:155], a[188:191], a[56:59]
    ds_read_b128 a[164:167], v32 offset:26624
    v_mul_f32 v215, v215, v23
    v_cvt_pk_bf16_f32 v211, v211, v215
    s_waitcnt vmcnt(11)
    v_cvt_f32_i32 v216, v216
    v_mfma_f32_16x16x32_bf16 a[60:63], v[156:159], a[188:191], a[60:63]
    s_waitcnt lgkmcnt(4)
    v_cvt_f32_i32 v220, v220
    v_add_f32 v216, v216, v24
    v_add_f32 v220, v220, v24
    v_mfma_f32_16x16x32_bf16 a[64:67], v[152:155], a[192:195], a[64:67]
    s_waitcnt vmcnt(10)
    s_barrier
    ds_read_b128 a[168:171], v31 offset:32768
    v_cvt_pk_bf16_f32 v216, v216, v220
    v_mfma_f32_16x16x32_bf16 a[68:71], v[156:159], a[192:195], a[68:71]
    v_and_b32 v220, 0xffff0000, v216
    v_lshlrev_b32 v216, 16, v216
    v_mul_f32 v216, v216, v20
    buffer_load_dwordx4 v[244:247], v9, s[8:11], s57 offen
    v_mfma_f32_16x16x32_bf16 a[72:75], v[152:155], a[196:199], a[72:75]
    ds_read_b128 a[172:175], v31 offset:40960
    v_mul_f32 v220, v220, v20
    v_cvt_pk_bf16_f32 v216, v216, v220
    v_cvt_f32_i32 v217, v217
    v_mfma_f32_16x16x32_bf16 a[76:79], v[156:159], a[196:199], a[76:79]
    s_waitcnt lgkmcnt(4)
    v_cvt_f32_i32 v221, v221
    v_add_f32 v217, v217, v25
    v_add_f32 v221, v221, v25
    v_mfma_f32_16x16x32_bf16 a[80:83], v[152:155], a[152:155], a[80:83]
    ds_read_b128 a[176:179], v31 offset:33792
    v_cvt_pk_bf16_f32 v217, v217, v221
    v_and_b32 v221, 0xffff0000, v217
    v_lshlrev_b32 v217, 16, v217
    v_mfma_f32_16x16x32_bf16 a[84:87], v[156:159], a[152:155], a[84:87]
    buffer_load_dwordx4 v14, s[4:7], s43 offen offset:1024 lds
    v_mul_f32 v217, v217, v21
    v_mul_f32 v221, v221, v21
    v_cvt_pk_bf16_f32 v217, v217, v221
    v_mfma_f32_16x16x32_bf16 a[88:91], v[152:155], a[156:159], a[88:91]
    ds_read_b128 a[180:183], v31 offset:41984
    v_cvt_f32_i32 v218, v218
    v_cvt_f32_i32 v222, v222
    v_add_f32 v218, v218, v26
    v_mfma_f32_16x16x32_bf16 a[92:95], v[156:159], a[156:159], a[92:95]
    s_waitcnt lgkmcnt(4)
    v_add_f32 v222, v222, v26
    v_cvt_pk_bf16_f32 v218, v218, v222
    v_and_b32 v222, 0xffff0000, v218
    v_mfma_f32_16x16x32_bf16 a[96:99], v[152:155], a[160:163], a[96:99]
    ds_read_b128 a[184:187], v31 offset:34816
    v_lshlrev_b32 v218, 16, v218
    v_mul_f32 v218, v218, v22
    v_mul_f32 v222, v222, v22
    v_mfma_f32_16x16x32_bf16 a[100:103], v[156:159], a[160:163], a[100:103]
    v_cvt_pk_bf16_f32 v218, v218, v222
    v_cvt_f32_i32 v219, v219
    v_cvt_f32_i32 v223, v223
    buffer_load_dwordx4 v[248:251], v10, s[8:11], s57 offen
    v_mfma_f32_16x16x32_bf16 a[104:107], v[152:155], a[164:167], a[104:107]
    ds_read_b128 a[188:191], v31 offset:43008
    v_add_f32 v219, v219, v27
    v_add_f32 v223, v223, v27
    v_cvt_pk_bf16_f32 v219, v219, v223
    v_and_b32 v223, 0xffff0000, v219
    v_lshlrev_b32 v219, 16, v219
    v_mul_f32 v219, v219, v23
    v_mul_f32 v223, v223, v23
    v_cvt_pk_bf16_f32 v219, v219, v223
    s_not_b64 vcc, vcc
    v_cndmask_b32_dpp v160, v194, v192, vcc row_ror:8 row_mask:0xf bank_mask:0xf
    v_cndmask_b32_dpp v161, v202, v200, vcc row_ror:8 row_mask:0xf bank_mask:0xf
    v_cndmask_b32_dpp v162, v210, v208, vcc row_ror:8 row_mask:0xf bank_mask:0xf
    v_cndmask_b32_dpp v163, v218, v216, vcc row_ror:8 row_mask:0xf bank_mask:0xf
    v_cndmask_b32_dpp v164, v195, v193, vcc row_ror:8 row_mask:0xf bank_mask:0xf
    v_cndmask_b32_dpp v165, v203, v201, vcc row_ror:8 row_mask:0xf bank_mask:0xf
    v_cndmask_b32_dpp v166, v211, v209, vcc row_ror:8 row_mask:0xf bank_mask:0xf
    v_cndmask_b32_dpp v167, v219, v217, vcc row_ror:8 row_mask:0xf bank_mask:0xf
    buffer_load_dwordx4 v[252:255], v11, s[8:11], s57 offen
    v_mfma_f32_16x16x32_bf16 a[108:111], v[156:159], a[164:167], a[108:111]
    s_waitcnt lgkmcnt(4)
    buffer_load_dwordx4 v14, s[4:7], s44 offen offset:2048 lds
    s_not_b64 vcc, vcc
    v_cndmask_b32_dpp v168, v192, v194, vcc row_ror:8 row_mask:0xf bank_mask:0xf
    v_mfma_f32_16x16x32_bf16 a[0:3], v[160:163], a[168:171], a[0:3]
    ds_read_b128 a[192:195], v31 offset:35840
    v_cndmask_b32_dpp v169, v200, v202, vcc row_ror:8 row_mask:0xf bank_mask:0xf
    v_cndmask_b32_dpp v170, v208, v210, vcc row_ror:8 row_mask:0xf bank_mask:0xf
    v_cndmask_b32_dpp v171, v216, v218, vcc row_ror:8 row_mask:0xf bank_mask:0xf
    v_mfma_f32_16x16x32_bf16 a[4:7], v[164:167], a[168:171], a[4:7]
    v_cndmask_b32_dpp v172, v193, v195, vcc row_ror:8 row_mask:0xf bank_mask:0xf
    v_cndmask_b32_dpp v173, v201, v203, vcc row_ror:8 row_mask:0xf bank_mask:0xf
    v_cndmask_b32_dpp v174, v209, v211, vcc row_ror:8 row_mask:0xf bank_mask:0xf
    v_mfma_f32_16x16x32_bf16 a[8:11], v[160:163], a[172:175], a[8:11]
    ds_read_b128 a[196:199], v31 offset:44032
    v_cndmask_b32_dpp v175, v217, v219, vcc row_ror:8 row_mask:0xf bank_mask:0xf
    s_waitcnt vmcnt(11)
    v_cvt_f32_i32 v224, v224
    v_cvt_f32_i32 v228, v228
    v_mfma_f32_16x16x32_bf16 a[12:15], v[164:167], a[172:175], a[12:15]
    s_waitcnt lgkmcnt(4)
    v_add_f32 v224, v224, v24
    v_add_f32 v228, v228, v24
    v_cvt_pk_bf16_f32 v224, v224, v228
    v_mfma_f32_16x16x32_bf16 a[16:19], v[160:163], a[176:179], a[16:19]
    ds_read_b128 a[152:155], v31 offset:49152
    v_and_b32 v228, 0xffff0000, v224
    v_lshlrev_b32 v224, 16, v224
    v_mul_f32 v224, v224, v20
    v_mfma_f32_16x16x32_bf16 a[20:23], v[164:167], a[176:179], a[20:23]
    v_mul_f32 v228, v228, v20
    v_add_u32 v16, 258048, v12
    v_add_u32 v17, 257024, v12
    v_add_u32 v18, 256000, v12
    v_add_u32 v19, 254976, v12
    buffer_load_dwordx4 v19, s[4:7], s58 offen offset:3072 lds
    v_mfma_f32_16x16x32_bf16 a[24:27], v[160:163], a[180:183], a[24:27]
    ds_read_b128 a[156:159], v31 offset:57344
    v_cvt_pk_bf16_f32 v224, v224, v228
    v_cvt_f32_i32 v225, v225
    v_cvt_f32_i32 v229, v229
    v_mfma_f32_16x16x32_bf16 a[28:31], v[164:167], a[180:183], a[28:31]
    s_waitcnt lgkmcnt(4)
    v_add_f32 v225, v225, v25
    v_add_f32 v229, v229, v25
    v_cvt_pk_bf16_f32 v225, v225, v229
    v_mfma_f32_16x16x32_bf16 a[32:35], v[160:163], a[184:187], a[32:35]
    ds_read_b128 a[160:163], v31 offset:50176
    v_and_b32 v229, 0xffff0000, v225
    v_lshlrev_b32 v225, 16, v225
    v_mul_f32 v225, v225, v21
    v_mfma_f32_16x16x32_bf16 a[36:39], v[164:167], a[184:187], a[36:39]
    v_mul_f32 v229, v229, v21
    v_cvt_pk_bf16_f32 v225, v225, v229
    v_cvt_f32_i32 v226, v226
    v_cvt_f32_i32 v230, v230
    v_mfma_f32_16x16x32_bf16 a[40:43], v[160:163], a[188:191], a[40:43]
    ds_read_b128 a[164:167], v31 offset:58368
    v_add_f32 v226, v226, v26
    v_add_f32 v230, v230, v26
    v_cvt_pk_bf16_f32 v226, v226, v230
    v_mfma_f32_16x16x32_bf16 a[44:47], v[164:167], a[188:191], a[44:47]
    s_waitcnt lgkmcnt(4)
    v_and_b32 v230, 0xffff0000, v226
    v_lshlrev_b32 v226, 16, v226
    v_mul_f32 v226, v226, v22
    v_mfma_f32_16x16x32_bf16 a[48:51], v[160:163], a[192:195], a[48:51]
    ds_read_b128 a[168:171], v31 offset:51200
    v_mul_f32 v230, v230, v22
    v_cvt_pk_bf16_f32 v226, v226, v230
    v_cvt_f32_i32 v227, v227
    v_mfma_f32_16x16x32_bf16 a[52:55], v[164:167], a[192:195], a[52:55]
    v_cvt_f32_i32 v231, v231
    v_add_f32 v227, v227, v27
    v_add_f32 v231, v231, v27
    v_cvt_pk_bf16_f32 v227, v227, v231
    v_mfma_f32_16x16x32_bf16 a[56:59], v[160:163], a[196:199], a[56:59]
    ds_read_b128 a[172:175], v31 offset:59392
    v_and_b32 v231, 0xffff0000, v227
    v_lshlrev_b32 v227, 16, v227
    v_mul_f32 v227, v227, v23
    v_mfma_f32_16x16x32_bf16 a[60:63], v[164:167], a[196:199], a[60:63]
    s_waitcnt lgkmcnt(4)
    v_mul_f32 v231, v231, v23
    v_cvt_pk_bf16_f32 v227, v227, v231
    s_waitcnt vmcnt(9)
    v_cvt_f32_i32 v232, v232
    v_mfma_f32_16x16x32_bf16 a[64:67], v[160:163], a[152:155], a[64:67]
    ds_read_b128 a[176:179], v32 offset:32768
    v_cvt_f32_i32 v236, v236
    v_add_f32 v232, v232, v24
    v_add_f32 v236, v236, v24
    v_mfma_f32_16x16x32_bf16 a[68:71], v[164:167], a[152:155], a[68:71]
    v_cvt_pk_bf16_f32 v232, v232, v236
    v_and_b32 v236, 0xffff0000, v232
    s_add_u32 m0, s67, 49152
    s_nop 0
    buffer_load_dwordx4 v19, s[4:7], s59 offen offset:3072 lds
    v_mfma_f32_16x16x32_bf16 a[72:75], v[160:163], a[156:159], a[72:75]
    ds_read_b128 a[180:183], v32 offset:40960
    v_lshlrev_b32 v232, 16, v232
    v_mul_f32 v232, v232, v20
    v_mul_f32 v236, v236, v20
    v_mfma_f32_16x16x32_bf16 a[76:79], v[164:167], a[156:159], a[76:79]
    s_waitcnt lgkmcnt(4)
    v_cvt_pk_bf16_f32 v232, v232, v236
    v_cvt_f32_i32 v233, v233
    v_cvt_f32_i32 v237, v237
    v_mfma_f32_16x16x32_bf16 a[80:83], v[160:163], a[160:163], a[80:83]
    ds_read_b128 a[184:187], v32 offset:33792
    v_add_f32 v233, v233, v25
    v_add_f32 v237, v237, v25
    v_cvt_pk_bf16_f32 v233, v233, v237
    v_mfma_f32_16x16x32_bf16 a[84:87], v[164:167], a[160:163], a[84:87]
    v_and_b32 v237, 0xffff0000, v233
    v_lshlrev_b32 v233, 16, v233
    v_mul_f32 v233, v233, v21
    v_mul_f32 v237, v237, v21
    v_mfma_f32_16x16x32_bf16 a[88:91], v[160:163], a[164:167], a[88:91]
    ds_read_b128 a[188:191], v32 offset:41984
    v_cvt_pk_bf16_f32 v233, v233, v237
    v_cvt_f32_i32 v234, v234
    v_cvt_f32_i32 v238, v238
    v_mfma_f32_16x16x32_bf16 a[92:95], v[164:167], a[164:167], a[92:95]
    s_waitcnt lgkmcnt(4)
    v_add_f32 v234, v234, v26
    v_add_f32 v238, v238, v26
    v_cvt_pk_bf16_f32 v234, v234, v238
    v_mfma_f32_16x16x32_bf16 a[96:99], v[160:163], a[168:171], a[96:99]
    ds_read_b128 a[192:195], v32 offset:34816
    v_and_b32 v238, 0xffff0000, v234
    v_lshlrev_b32 v234, 16, v234
    v_mul_f32 v234, v234, v22
    v_mfma_f32_16x16x32_bf16 a[100:103], v[164:167], a[168:171], a[100:103]
    v_mul_f32 v238, v238, v22
    v_cvt_pk_bf16_f32 v234, v234, v238
    s_add_u32 m0, s67, 81920
    s_nop 0
    buffer_load_dwordx4 v19, s[4:7], s60 offen offset:3072 lds
    v_mfma_f32_16x16x32_bf16 a[104:107], v[160:163], a[172:175], a[104:107]
    ds_read_b128 a[196:199], v32 offset:43008
    v_cvt_f32_i32 v235, v235
    v_cvt_f32_i32 v239, v239
    v_add_f32 v235, v235, v27
    v_mfma_f32_16x16x32_bf16 a[108:111], v[164:167], a[172:175], a[108:111]
    s_waitcnt lgkmcnt(4)
    v_add_f32 v239, v239, v27
    v_cvt_pk_bf16_f32 v235, v235, v239
    v_and_b32 v239, 0xffff0000, v235
    v_mfma_f32_16x16x32_bf16 a[0:3], v[168:171], a[176:179], a[0:3]
    ds_read_b128 a[152:155], v32 offset:35840
    v_lshlrev_b32 v235, 16, v235
    v_mul_f32 v235, v235, v23
    v_mul_f32 v239, v239, v23
    v_mfma_f32_16x16x32_bf16 a[4:7], v[172:175], a[176:179], a[4:7]
    v_cvt_pk_bf16_f32 v235, v235, v239
    s_waitcnt vmcnt(7)
    v_cvt_f32_i32 v240, v240
    v_cvt_f32_i32 v244, v244
    v_add_f32 v240, v240, v24
    v_mfma_f32_16x16x32_bf16 a[8:11], v[168:171], a[180:183], a[8:11]
    ds_read_b128 a[156:159], v32 offset:44032
    v_add_f32 v244, v244, v24
    v_cvt_pk_bf16_f32 v240, v240, v244
    v_and_b32 v244, 0xffff0000, v240
    v_mfma_f32_16x16x32_bf16 a[12:15], v[172:175], a[180:183], a[12:15]
    s_waitcnt lgkmcnt(4)
    v_lshlrev_b32 v240, 16, v240
    s_add_u32 m0, s67, 114688
    s_nop 0
    buffer_load_dwordx4 v19, s[4:7], s61 offen offset:3072 lds
    v_mfma_f32_16x16x32_bf16 a[16:19], v[168:171], a[184:187], a[16:19]
    ds_read_b128 a[160:163], v32 offset:49152
    v_mul_f32 v240, v240, v20
    v_mul_f32 v244, v244, v20
    v_cvt_pk_bf16_f32 v240, v240, v244
    v_mfma_f32_16x16x32_bf16 a[20:23], v[172:175], a[184:187], a[20:23]
    v_cvt_f32_i32 v241, v241
    v_cvt_f32_i32 v245, v245
    v_add_f32 v241, v241, v25
    v_add_f32 v245, v245, v25
    v_mfma_f32_16x16x32_bf16 a[24:27], v[168:171], a[188:191], a[24:27]
    ds_read_b128 a[164:167], v32 offset:57344
    v_cvt_pk_bf16_f32 v241, v241, v245
    v_and_b32 v245, 0xffff0000, v241
    v_lshlrev_b32 v241, 16, v241
    v_mfma_f32_16x16x32_bf16 a[28:31], v[172:175], a[188:191], a[28:31]
    s_waitcnt lgkmcnt(4)
    v_mul_f32 v241, v241, v21
    v_mul_f32 v245, v245, v21
    v_cvt_pk_bf16_f32 v241, v241, v245
    v_mfma_f32_16x16x32_bf16 a[32:35], v[168:171], a[192:195], a[32:35]
    ds_read_b128 a[168:171], v32 offset:50176
    v_cvt_f32_i32 v242, v242
    v_cvt_f32_i32 v246, v246
    v_add_f32 v242, v242, v26
    v_mfma_f32_16x16x32_bf16 a[36:39], v[172:175], a[192:195], a[36:39]
    v_add_f32 v246, v246, v26
    v_cvt_pk_bf16_f32 v242, v242, v246
    s_add_u32 m0, s67, 32768
    s_nop 0
    buffer_load_dwordx4 v16, s[4:7], s62 offen offset:0 lds
    v_mfma_f32_16x16x32_bf16 a[40:43], v[168:171], a[196:199], a[40:43]
    ds_read_b128 a[172:175], v32 offset:58368
    v_and_b32 v246, 0xffff0000, v242
    v_lshlrev_b32 v242, 16, v242
    v_mul_f32 v242, v242, v22
    v_mfma_f32_16x16x32_bf16 a[44:47], v[172:175], a[196:199], a[44:47]
    s_waitcnt lgkmcnt(4)
    v_mul_f32 v246, v246, v22
    v_cvt_pk_bf16_f32 v242, v242, v246
    v_cvt_f32_i32 v243, v243
    v_mfma_f32_16x16x32_bf16 a[48:51], v[168:171], a[152:155], a[48:51]
    ds_read_b128 a[176:179], v32 offset:51200
    v_cvt_f32_i32 v247, v247
    v_add_f32 v243, v243, v27
    v_add_f32 v247, v247, v27
    v_mfma_f32_16x16x32_bf16 a[52:55], v[172:175], a[152:155], a[52:55]
    v_cvt_pk_bf16_f32 v243, v243, v247
    v_and_b32 v247, 0xffff0000, v243
    v_lshlrev_b32 v243, 16, v243
    v_mul_f32 v243, v243, v23
    v_mfma_f32_16x16x32_bf16 a[56:59], v[168:171], a[156:159], a[56:59]
    ds_read_b128 a[180:183], v32 offset:59392
    v_mul_f32 v247, v247, v23
    v_cvt_pk_bf16_f32 v243, v243, v247
    s_waitcnt vmcnt(6)
    v_cvt_f32_i32 v248, v248
    v_mfma_f32_16x16x32_bf16 a[60:63], v[172:175], a[156:159], a[60:63]
    s_waitcnt lgkmcnt(4)
    v_cvt_f32_i32 v252, v252
    buffer_load_dwordx4 v17, s[4:7], s63 offen offset:1024 lds
    v_add_f32 v248, v248, v24
    v_mfma_f32_16x16x32_bf16 a[64:67], v[168:171], a[160:163], a[64:67]
    s_waitcnt vmcnt(6)
    s_barrier
    ds_read_b128 a[184:187], v29 offset:0
    v_add_f32 v252, v252, v24
    v_mfma_f32_16x16x32_bf16 a[68:71], v[172:175], a[160:163], a[68:71]
    v_cvt_pk_bf16_f32 v248, v248, v252
    v_and_b32 v252, 0xffff0000, v248
    v_lshlrev_b32 v248, 16, v248
    v_mul_f32 v248, v248, v20
    v_mfma_f32_16x16x32_bf16 a[72:75], v[168:171], a[164:167], a[72:75]
    ds_read_b128 a[188:191], v29 offset:8192
    v_mul_f32 v252, v252, v20
    v_cvt_pk_bf16_f32 v248, v248, v252
    v_cvt_f32_i32 v249, v249
    v_mfma_f32_16x16x32_bf16 a[76:79], v[172:175], a[164:167], a[76:79]
    s_waitcnt lgkmcnt(4)
    v_cvt_f32_i32 v253, v253
    v_add_f32 v249, v249, v25
    v_add_f32 v253, v253, v25
    v_mfma_f32_16x16x32_bf16 a[80:83], v[168:171], a[168:171], a[80:83]
    ds_read_b128 a[192:195], v30 offset:0
    v_cvt_pk_bf16_f32 v249, v249, v253
    v_and_b32 v253, 0xffff0000, v249
    v_lshlrev_b32 v249, 16, v249
    v_mfma_f32_16x16x32_bf16 a[84:87], v[172:175], a[168:171], a[84:87]
    v_mul_f32 v249, v249, v21
    v_mul_f32 v253, v253, v21
    buffer_load_dwordx4 v18, s[4:7], s64 offen offset:2048 lds
    v_cvt_pk_bf16_f32 v249, v249, v253
    v_mfma_f32_16x16x32_bf16 a[88:91], v[168:171], a[172:175], a[88:91]
    ds_read_b128 a[196:199], v29 offset:1024
    v_cvt_f32_i32 v250, v250
    v_cvt_f32_i32 v254, v254
    v_add_f32 v250, v250, v26
    v_mfma_f32_16x16x32_bf16 a[92:95], v[172:175], a[172:175], a[92:95]
    s_waitcnt lgkmcnt(4)
    v_add_f32 v254, v254, v26
    v_cvt_pk_bf16_f32 v250, v250, v254
    v_and_b32 v254, 0xffff0000, v250
    v_mfma_f32_16x16x32_bf16 a[96:99], v[168:171], a[176:179], a[96:99]
    ds_read_b128 a[152:155], v30 offset:8192
    v_lshlrev_b32 v250, 16, v250
    v_mul_f32 v250, v250, v22
    v_mul_f32 v254, v254, v22
    v_mfma_f32_16x16x32_bf16 a[100:103], v[172:175], a[176:179], a[100:103]
    v_cvt_pk_bf16_f32 v250, v250, v254
    v_cvt_f32_i32 v251, v251
    v_cvt_f32_i32 v255, v255
    v_add_f32 v251, v251, v27
    v_mfma_f32_16x16x32_bf16 a[104:107], v[168:171], a[180:183], a[104:107]
    ds_read_b128 a[156:159], v29 offset:9216
    v_add_f32 v255, v255, v27
    v_cvt_pk_bf16_f32 v251, v251, v255
    v_and_b32 v255, 0xffff0000, v251
    v_lshlrev_b32 v251, 16, v251
    v_mul_f32 v251, v251, v23
    v_mul_f32 v255, v255, v23
    v_cvt_pk_bf16_f32 v251, v251, v255
    s_not_b64 vcc, vcc
    v_cndmask_b32_dpp v176, v226, v224, vcc row_ror:8 row_mask:0xf bank_mask:0xf
    v_cndmask_b32_dpp v177, v234, v232, vcc row_ror:8 row_mask:0xf bank_mask:0xf
    v_cndmask_b32_dpp v178, v242, v240, vcc row_ror:8 row_mask:0xf bank_mask:0xf
    v_cndmask_b32_dpp v179, v250, v248, vcc row_ror:8 row_mask:0xf bank_mask:0xf
    v_cndmask_b32_dpp v180, v227, v225, vcc row_ror:8 row_mask:0xf bank_mask:0xf
    v_cndmask_b32_dpp v181, v235, v233, vcc row_ror:8 row_mask:0xf bank_mask:0xf
    v_cndmask_b32_dpp v182, v243, v241, vcc row_ror:8 row_mask:0xf bank_mask:0xf
    v_cndmask_b32_dpp v183, v251, v249, vcc row_ror:8 row_mask:0xf bank_mask:0xf
    v_mfma_f32_16x16x32_bf16 a[108:111], v[172:175], a[180:183], a[108:111]
    s_waitcnt lgkmcnt(4)
    buffer_load_dwordx4 v19, s[4:7], s65 offen offset:3072 lds
    s_not_b64 vcc, vcc
    v_cndmask_b32_dpp v184, v224, v226, vcc row_ror:8 row_mask:0xf bank_mask:0xf
    v_mfma_f32_16x16x32_bf16 a[0:3], v[176:179], a[184:187], a[0:3]
    ds_read_b128 a[160:163], v30 offset:1024
    v_cndmask_b32_dpp v185, v232, v234, vcc row_ror:8 row_mask:0xf bank_mask:0xf
    v_cndmask_b32_dpp v186, v240, v242, vcc row_ror:8 row_mask:0xf bank_mask:0xf
    v_mfma_f32_16x16x32_bf16 a[4:7], v[180:183], a[184:187], a[4:7]
    v_cndmask_b32_dpp v187, v248, v250, vcc row_ror:8 row_mask:0xf bank_mask:0xf
    v_cndmask_b32_dpp v188, v225, v227, vcc row_ror:8 row_mask:0xf bank_mask:0xf
    v_cndmask_b32_dpp v189, v233, v235, vcc row_ror:8 row_mask:0xf bank_mask:0xf
    v_cndmask_b32_dpp v190, v241, v243, vcc row_ror:8 row_mask:0xf bank_mask:0xf
    v_cndmask_b32_dpp v191, v249, v251, vcc row_ror:8 row_mask:0xf bank_mask:0xf
    v_mfma_f32_16x16x32_bf16 a[8:11], v[176:179], a[188:191], a[8:11]
    ds_read_b128 a[164:167], v29 offset:2048
    s_add_u32 m0, s67, 49152
    s_nop 0
    buffer_load_dwordx4 v16, s[4:7], s66 offen offset:0 lds
    v_mfma_f32_16x16x32_bf16 a[12:15], v[180:183], a[188:191], a[12:15]
    s_waitcnt lgkmcnt(4)
    v_add_u32 v16, 294912, v12
    v_add_u32 v17, 293888, v12
    v_add_u32 v18, 292864, v12
    v_add_u32 v19, 291840, v12
    buffer_load_dwordx4 v17, s[4:7], s58 offen offset:1024 lds
    v_mfma_f32_16x16x32_bf16 a[0:3], v[184:187], a[192:195], a[0:3]
    ds_read_b128 a[168:171], v30 offset:9216
    buffer_load_dwordx4 v18, s[4:7], s59 offen offset:2048 lds
    v_mfma_f32_16x16x32_bf16 a[4:7], v[188:191], a[192:195], a[4:7]
    v_mfma_f32_16x16x32_bf16 a[16:19], v[176:179], a[196:199], a[16:19]
    ds_read_b128 a[172:175], v29 offset:10240
    v_mfma_f32_16x16x32_bf16 a[20:23], v[180:183], a[196:199], a[20:23]
    s_waitcnt lgkmcnt(4)
    v_mfma_f32_16x16x32_bf16 a[8:11], v[184:187], a[152:155], a[8:11]
    ds_read_b128 a[176:179], v30 offset:2048
    v_accvgpr_read_b32 v192, a0
    v_mfma_f32_16x16x32_bf16 a[12:15], v[188:191], a[152:155], a[12:15]
    v_accvgpr_read_b32 v196, a4
    v_accvgpr_read_b32 v194, a1
    v_mfma_f32_16x16x32_bf16 a[24:27], v[176:179], a[156:159], a[24:27]
    ds_read_b128 a[180:183], v29 offset:3072
    v_accvgpr_read_b32 v197, a5
    v_mfma_f32_16x16x32_bf16 a[28:31], v[180:183], a[156:159], a[28:31]
    s_waitcnt lgkmcnt(4)
    v_accvgpr_read_b32 v193, a2
    v_mfma_f32_16x16x32_bf16 a[16:19], v[184:187], a[160:163], a[16:19]
    ds_read_b128 a[184:187], v30 offset:10240
    s_add_u32 m0, s67, 65536
    s_nop 0
    buffer_load_dwordx4 v16, s[4:7], s60 offen offset:0 lds
    v_mfma_f32_16x16x32_bf16 a[20:23], v[188:191], a[160:163], a[20:23]
    v_accvgpr_read_b32 v198, a6
    v_accvgpr_read_b32 v195, a3
    v_mfma_f32_16x16x32_bf16 a[32:35], v[176:179], a[164:167], a[32:35]
    ds_read_b128 a[188:191], v29 offset:11264
    v_accvgpr_read_b32 v199, a7
    v_cvt_pk_bf16_f32 v192, v192, v196
    v_mfma_f32_16x16x32_bf16 a[36:39], v[180:183], a[164:167], a[36:39]
    s_waitcnt lgkmcnt(4)
    v_cvt_pk_bf16_f32 v194, v194, v197
    v_cvt_pk_bf16_f32 v193, v193, v198
    v_mfma_f32_16x16x32_bf16 a[24:27], v[184:187], a[168:171], a[24:27]
    ds_read_b128 a[192:195], v30 offset:3072
    v_cvt_pk_bf16_f32 v195, v195, v199
    v_permlane32_swap_b32 v192, v193
    v_mfma_f32_16x16x32_bf16 a[28:31], v[188:191], a[168:171], a[28:31]
    v_permlane32_swap_b32 v194, v195
    ds_write_b128 v37, v[192:195] offset:0
    v_mfma_f32_16x16x32_bf16 a[40:43], v[176:179], a[172:175], a[40:43]
    ds_read_b128 a[196:199], v29 offset:16384
    buffer_load_dwordx4 v17, s[4:7], s61 offen offset:1024 lds
    v_mfma_f32_16x16x32_bf16 a[44:47], v[180:183], a[172:175], a[44:47]
    s_waitcnt lgkmcnt(5)
    v_accvgpr_read_b32 v200, a8
    v_mfma_f32_16x16x32_bf16 a[32:35], v[184:187], a[176:179], a[32:35]
    ds_read_b128 a[152:155], v30 offset:11264
    v_accvgpr_read_b32 v204, a12
    v_accvgpr_read_b32 v202, a9
    v_mfma_f32_16x16x32_bf16 a[36:39], v[188:191], a[176:179], a[36:39]
    v_accvgpr_read_b32 v205, a13
    v_accvgpr_read_b32 v201, a10
    v_accvgpr_read_b32 v206, a14
    v_mfma_f32_16x16x32_bf16 a[48:51], v[176:179], a[180:183], a[48:51]
    ds_read_b128 a[156:159], v29 offset:24576
    v_accvgpr_read_b32 v203, a11
    v_accvgpr_read_b32 v207, a15
    v_mfma_f32_16x16x32_bf16 a[52:55], v[180:183], a[180:183], a[52:55]
    s_waitcnt lgkmcnt(5)
    buffer_load_dwordx4 v18, s[4:7], s62 offen offset:2048 lds
    v_cvt_pk_bf16_f32 v200, v200, v204
    v_mfma_f32_16x16x32_bf16 a[40:43], v[184:187], a[184:187], a[40:43]
    ds_read_b128 a[160:163], v30 offset:16384
    v_cvt_pk_bf16_f32 v202, v202, v205
    v_cvt_pk_bf16_f32 v201, v201, v206
    v_mfma_f32_16x16x32_bf16 a[44:47], v[188:191], a[184:187], a[44:47]
    v_cvt_pk_bf16_f32 v203, v203, v207
    v_permlane32_swap_b32 v200, v201
    v_mfma_f32_16x16x32_bf16 a[56:59], v[176:179], a[188:191], a[56:59]
    ds_read_b128 a[164:167], v29 offset:17408
    v_permlane32_swap_b32 v202, v203
    v_mfma_f32_16x16x32_bf16 a[60:63], v[180:183], a[188:191], a[60:63]
    s_waitcnt lgkmcnt(4)
    ds_write_b128 v37, v[200:203] offset:1024
    v_mfma_f32_16x16x32_bf16 a[48:51], v[184:187], a[192:195], a[48:51]
    ds_read_b128 a[168:171], v30 offset:24576
    buffer_load_dwordx4 v19, s[4:7], s63 offen offset:3072 lds
    v_mfma_f32_16x16x32_bf16 a[52:55], v[188:191], a[192:195], a[52:55]
    v_accvgpr_read_b32 v192, a16
    v_accvgpr_read_b32 v196, a20
    v_mfma_f32_16x16x32_bf16 a[64:67], v[176:179], a[196:199], a[64:67]
    ds_read_b128 a[172:175], v29 offset:25600
    v_accvgpr_read_b32 v194, a17
    v_mfma_f32_16x16x32_bf16 a[68:71], v[180:183], a[196:199], a[68:71]
    s_waitcnt lgkmcnt(5)
    v_accvgpr_read_b32 v197, a21
    v_accvgpr_read_b32 v193, a18
    v_mfma_f32_16x16x32_bf16 a[56:59], v[184:187], a[152:155], a[56:59]
    ds_read_b128 a[176:179], v30 offset:17408
    v_accvgpr_read_b32 v198, a22
    v_accvgpr_read_b32 v195, a19
    v_mfma_f32_16x16x32_bf16 a[60:63], v[188:191], a[152:155], a[60:63]
    v_accvgpr_read_b32 v199, a23
    v_cvt_pk_bf16_f32 v192, v192, v196
    s_add_u32 m0, s67, 81920
    s_nop 0
    buffer_load_dwordx4 v16, s[4:7], s64 offen offset:0 lds
    v_mfma_f32_16x16x32_bf16 a[72:75], v[176:179], a[156:159], a[72:75]
    ds_read_b128 a[180:183], v29 offset:18432
    v_cvt_pk_bf16_f32 v194, v194, v197
    v_cvt_pk_bf16_f32 v193, v193, v198
    v_mfma_f32_16x16x32_bf16 a[76:79], v[180:183], a[156:159], a[76:79]
    s_waitcnt lgkmcnt(5)
    v_cvt_pk_bf16_f32 v195, v195, v199
    v_mfma_f32_16x16x32_bf16 a[64:67], v[184:187], a[160:163], a[64:67]
    ds_read_b128 a[184:187], v30 offset:25600
    v_permlane32_swap_b32 v192, v193
    v_mfma_f32_16x16x32_bf16 a[68:71], v[188:191], a[160:163], a[68:71]
    v_permlane32_swap_b32 v194, v195
    ds_write_b128 v37, v[192:195] offset:2048
    v_mfma_f32_16x16x32_bf16 a[80:83], v[176:179], a[164:167], a[80:83]
    ds_read_b128 a[188:191], v29 offset:26624
    buffer_load_dwordx4 v17, s[4:7], s65 offen offset:1024 lds
    v_mfma_f32_16x16x32_bf16 a[84:87], v[180:183], a[164:167], a[84:87]
    s_waitcnt lgkmcnt(5)
    v_accvgpr_read_b32 v200, a24
    v_mfma_f32_16x16x32_bf16 a[72:75], v[184:187], a[168:171], a[72:75]
    ds_read_b128 a[192:195], v30 offset:18432
    v_accvgpr_read_b32 v204, a28
    v_accvgpr_read_b32 v202, a25
    v_mfma_f32_16x16x32_bf16 a[76:79], v[188:191], a[168:171], a[76:79]
    v_accvgpr_read_b32 v205, a29
    v_accvgpr_read_b32 v201, a26
    v_mfma_f32_16x16x32_bf16 a[88:91], v[176:179], a[172:175], a[88:91]
    ds_read_b128 a[196:199], v30 offset:26624
    v_accvgpr_read_b32 v206, a30
    v_accvgpr_read_b32 v203, a27
    v_mfma_f32_16x16x32_bf16 a[92:95], v[180:183], a[172:175], a[92:95]
    s_waitcnt lgkmcnt(5)
    v_accvgpr_read_b32 v207, a31
    v_cvt_pk_bf16_f32 v200, v200, v204
    v_mfma_f32_16x16x32_bf16 a[80:83], v[184:187], a[176:179], a[80:83]
    s_waitcnt vmcnt(12)
    s_waitcnt lgkmcnt(3)
    s_barrier
    ds_read_b128 a[152:155], v29 offset:19456
    v_mfma_f32_16x16x32_bf16 a[84:87], v[188:191], a[176:179], a[84:87]
    buffer_load_dwordx4 v18, s[4:7], s66 offen offset:2048 lds
    v_cvt_pk_bf16_f32 v202, v202, v205
    v_cvt_pk_bf16_f32 v201, v201, v206
    v_mfma_f32_16x16x32_bf16 a[96:99], v[176:179], a[180:183], a[96:99]
    ds_read_b128 a[156:159], v29 offset:27648
    v_cvt_pk_bf16_f32 v203, v203, v207
    v_permlane32_swap_b32 v200, v201
    v_mfma_f32_16x16x32_bf16 a[100:103], v[180:183], a[180:183], a[100:103]
    s_waitcnt lgkmcnt(4)
    v_permlane32_swap_b32 v202, v203
    v_mfma_f32_16x16x32_bf16 a[88:91], v[184:187], a[184:187], a[88:91]
    ds_read_b128 a[160:163], v30 offset:19456
    ds_read_b128 v[208:211], v38 offset:0
    v_mfma_f32_16x16x32_bf16 a[92:95], v[188:191], a[184:187], a[92:95]
    ds_write_b128 v37, v[200:203] offset:3072
    s_add_u32 m0, s67, 98304
    v_add_u32 v16, 331776, v13
    v_add_u32 v17, 330752, v13
    v_add_u32 v18, 329728, v13
    v_add_u32 v19, 328704, v13
    s_mov_b32 exec_hi, 0
    buffer_load_dwordx4 v16, s[4:7], s58 offen offset:0 lds
    s_mov_b32 exec_hi, -1
    v_mfma_f32_16x16x32_bf16 a[104:107], v[176:179], a[188:191], a[104:107]
    ds_read_b128 a[164:167], v30 offset:27648
    ds_read_b128 v[212:215], v38 offset:1024
    v_mfma_f32_16x16x32_bf16 a[108:111], v[180:183], a[188:191], a[108:111]
    s_waitcnt lgkmcnt(7)
    v_accvgpr_read_b32 v192, a32
    v_accvgpr_read_b32 v196, a36
    v_mfma_f32_16x16x32_bf16 a[96:99], v[184:187], a[192:195], a[96:99]
    ds_read_b128 a[168:171], v29 offset:52224
    s_waitcnt lgkmcnt(4)
    buffer_store_dwordx4 v[208:211], v28, s[12:15], s68 offen sc1
    v_accvgpr_read_b32 v194, a33
    v_mfma_f32_16x16x32_bf16 a[100:103], v[188:191], a[192:195], a[100:103]
    v_accvgpr_read_b32 v197, a37
    v_accvgpr_read_b32 v193, a34
    v_accvgpr_read_b32 v198, a38
    v_mfma_f32_16x16x32_bf16 a[104:107], v[184:187], a[196:199], a[104:107]
    ds_read_b128 a[172:175], v29 offset:60416
    ds_read_b128 v[216:219], v38 offset:2048
    s_mov_b32 exec_hi, 0
    buffer_load_dwordx4 v17, s[4:7], s59 offen offset:1024 lds
    s_mov_b32 exec_hi, -1
    v_mfma_f32_16x16x32_bf16 a[108:111], v[188:191], a[196:199], a[108:111]
    v_accvgpr_read_b32 v195, a35
    v_accvgpr_read_b32 v199, a39
    v_mfma_f32_16x16x32_bf16 a[112:115], v[48:51], a[152:155], 0
    ds_read_b128 a[176:179], v30 offset:52224
    v_cvt_pk_bf16_f32 v192, v192, v196
    v_cvt_pk_bf16_f32 v194, v194, v197
    v_mfma_f32_16x16x32_bf16 a[116:119], v[52:55], a[152:155], 0
    s_waitcnt lgkmcnt(4)
    buffer_store_dwordx4 v[212:215], v28, s[12:15], s69 offen sc1
    v_cvt_pk_bf16_f32 v193, v193, v198
    v_cvt_pk_bf16_f32 v195, v195, v199
    v_mfma_f32_16x16x32_bf16 v[224:227], v[48:51], a[156:159], 0
    ds_read_b128 a[180:183], v30 offset:60416
    v_permlane32_swap_b32 v192, v193
    v_permlane32_swap_b32 v194, v195
    v_mfma_f32_16x16x32_bf16 v[228:231], v[52:55], a[156:159], 0
    ds_write_b128 v37, v[192:195] offset:16384
    v_mfma_f32_16x16x32_bf16 a[112:115], v[56:59], a[160:163], a[112:115]
    ds_read_b128 a[184:187], v31 offset:19456
    s_mov_b32 exec_hi, 0
    buffer_load_dwordx4 v18, s[4:7], s60 offen offset:2048 lds
    s_mov_b32 exec_hi, -1
    v_mfma_f32_16x16x32_bf16 a[116:119], v[60:63], a[160:163], a[116:119]
    s_waitcnt lgkmcnt(4)
    buffer_store_dwordx4 v[216:219], v28, s[12:15], s70 offen sc1
    v_accvgpr_read_b32 v200, a40
    v_mfma_f32_16x16x32_bf16 v[224:227], v[56:59], a[164:167], v[224:227]
    ds_read_b128 a[188:191], v31 offset:27648
    v_accvgpr_read_b32 v204, a44
    v_accvgpr_read_b32 v202, a41
    v_mfma_f32_16x16x32_bf16 v[228:231], v[60:63], a[164:167], v[228:231]
    v_accvgpr_read_b32 v205, a45
    v_accvgpr_read_b32 v201, a42
    v_mfma_f32_16x16x32_bf16 a[112:115], v[64:67], a[168:171], a[112:115]
    ds_read_b128 a[192:195], v32 offset:19456
    v_accvgpr_read_b32 v206, a46
    v_accvgpr_read_b32 v203, a43
    v_mfma_f32_16x16x32_bf16 a[116:119], v[68:71], a[168:171], a[116:119]
    s_mov_b32 exec_hi, 0
    buffer_load_dwordx4 v19, s[4:7], s61 offen offset:3072 lds
    s_mov_b32 exec_hi, -1
    v_mfma_f32_16x16x32_bf16 v[224:227], v[64:67], a[172:175], v[224:227]
    ds_read_b128 a[196:199], v32 offset:27648
    v_accvgpr_read_b32 v207, a47
    v_cvt_pk_bf16_f32 v200, v200, v204
    v_mfma_f32_16x16x32_bf16 v[228:231], v[68:71], a[172:175], v[228:231]
    s_waitcnt lgkmcnt(5)
    v_cvt_pk_bf16_f32 v202, v202, v205
    v_cvt_pk_bf16_f32 v201, v201, v206
    v_mfma_f32_16x16x32_bf16 a[112:115], v[72:75], a[176:179], a[112:115]
    ds_read_b128 a[152:155], v31 offset:52224
    v_cvt_pk_bf16_f32 v203, v203, v207
    v_permlane32_swap_b32 v200, v201
    v_mfma_f32_16x16x32_bf16 a[116:119], v[76:79], a[176:179], a[116:119]
    v_permlane32_swap_b32 v202, v203
    ds_write_b128 v37, v[200:203] offset:17408
    v_mfma_f32_16x16x32_bf16 v[224:227], v[72:75], a[180:183], v[224:227]
    ds_read_b128 a[156:159], v31 offset:60416
    s_add_u32 m0, s67, 0
    s_mov_b32 exec_hi, 0
    buffer_load_dwordx4 v16, s[4:7], s62 offen offset:0 lds
    s_mov_b32 exec_hi, -1
    v_mfma_f32_16x16x32_bf16 v[228:231], v[76:79], a[180:183], v[228:231]
    s_waitcnt lgkmcnt(5)
    v_accvgpr_read_b32 v192, a48
    v_mfma_f32_16x16x32_bf16 a[112:115], v[80:83], a[184:187], a[112:115]
    ds_read_b128 a[160:163], v32 offset:52224
    v_accvgpr_read_b32 v196, a52
    v_mfma_f32_16x16x32_bf16 a[116:119], v[84:87], a[184:187], a[116:119]
    v_accvgpr_read_b32 v194, a49
    v_accvgpr_read_b32 v197, a53
    v_accvgpr_read_b32 v193, a50
    v_mfma_f32_16x16x32_bf16 v[224:227], v[80:83], a[188:191], v[224:227]
    ds_read_b128 a[164:167], v32 offset:60416
    v_accvgpr_read_b32 v198, a54
    v_mfma_f32_16x16x32_bf16 v[228:231], v[84:87], a[188:191], v[228:231]
    s_waitcnt lgkmcnt(5)
    s_mov_b32 exec_hi, 0
    buffer_load_dwordx4 v17, s[4:7], s63 offen offset:1024 lds
    s_mov_b32 exec_hi, -1
    v_mfma_f32_16x16x32_bf16 a[112:115], v[88:91], a[192:195], a[112:115]
    ds_read_b128 a[168:171], v29 offset:32768
    v_accvgpr_read_b32 v195, a51
    v_accvgpr_read_b32 v199, a55
    v_mfma_f32_16x16x32_bf16 a[116:119], v[92:95], a[192:195], a[116:119]
    v_cvt_pk_bf16_f32 v192, v192, v196
    v_cvt_pk_bf16_f32 v194, v194, v197
    v_mfma_f32_16x16x32_bf16 v[224:227], v[88:91], a[196:199], v[224:227]
    ds_read_b128 a[172:175], v29 offset:40960
    v_cvt_pk_bf16_f32 v193, v193, v198
    v_mfma_f32_16x16x32_bf16 v[228:231], v[92:95], a[196:199], v[228:231]
    s_waitcnt lgkmcnt(4)
    v_cvt_pk_bf16_f32 v195, v195, v199
    v_permlane32_swap_b32 v192, v193
    v_mfma_f32_16x16x32_bf16 a[112:115], v[96:99], a[152:155], a[112:115]
    ds_read_b128 a[176:179], v30 offset:32768
    v_permlane32_swap_b32 v194, v195
    v_mfma_f32_16x16x32_bf16 a[116:119], v[100:103], a[152:155], a[116:119]
    s_mov_b32 exec_hi, 0
    buffer_load_dwordx4 v18, s[4:7], s64 offen offset:2048 lds
    s_mov_b32 exec_hi, -1
    v_mfma_f32_16x16x32_bf16 v[224:227], v[96:99], a[156:159], v[224:227]
    ds_read_b128 a[180:183], v30 offset:40960
    ds_write_b128 v37, v[192:195] offset:18432
    v_mfma_f32_16x16x32_bf16 v[228:231], v[100:103], a[156:159], v[228:231]
    s_waitcnt lgkmcnt(5)
    v_accvgpr_read_b32 v200, a56
    v_mfma_f32_16x16x32_bf16 a[112:115], v[104:107], a[160:163], a[112:115]
    s_waitcnt vmcnt(19)
    s_waitcnt lgkmcnt(0)
    s_barrier
    ds_read_b128 a[184:187], v29 offset:33792
    v_mfma_f32_16x16x32_bf16 a[116:119], v[108:111], a[160:163], a[116:119]
    v_accvgpr_read_b32 v204, a60
    s_mov_b32 exec_hi, 0
    buffer_load_dwordx4 v19, s[4:7], s65 offen offset:3072 lds
    s_mov_b32 exec_hi, -1
    v_mfma_f32_16x16x32_bf16 v[224:227], v[104:107], a[164:167], v[224:227]
    ds_read_b128 a[188:191], v29 offset:41984
    v_accvgpr_read_b32 v202, a57
    v_accvgpr_read_b32 v205, a61
    v_mfma_f32_16x16x32_bf16 v[228:231], v[108:111], a[164:167], v[228:231]
    ds_read_b128 v[220:223], v38 offset:3072
    v_accvgpr_read_b32 v201, a58
    v_mfma_f32_16x16x32_bf16 a[112:115], v[112:115], a[168:171], a[112:115]
    ds_read_b128 a[192:195], v30 offset:33792
    v_accvgpr_read_b32 v206, a62
    v_accvgpr_read_b32 v203, a59
    v_mfma_f32_16x16x32_bf16 a[116:119], v[116:119], a[168:171], a[116:119]
    v_accvgpr_read_b32 v207, a63
    v_cvt_pk_bf16_f32 v200, v200, v204
    v_cvt_pk_bf16_f32 v202, v202, v205
    v_mfma_f32_16x16x32_bf16 v[224:227], v[112:115], a[172:175], v[224:227]
    ds_read_b128 a[196:199], v30 offset:41984
    ds_read_b128 v[208:211], v38 offset:16384
    s_add_u32 m0, s67, 16384
    s_mov_b32 exec_hi, 0
    buffer_load_dwordx4 v16, s[4:7], s66 offen offset:0 lds
    s_mov_b32 exec_hi, -1
    v_mfma_f32_16x16x32_bf16 v[228:231], v[116:119], a[172:175], v[228:231]
    v_cvt_pk_bf16_f32 v201, v201, v206
    v_cvt_pk_bf16_f32 v203, v203, v207
    v_mfma_f32_16x16x32_bf16 a[112:115], v[120:123], a[176:179], a[112:115]
    ds_read_b128 a[152:155], v29 offset:34816
    v_permlane32_swap_b32 v200, v201
    s_waitcnt lgkmcnt(4)
    buffer_store_dwordx4 v[220:223], v28, s[12:15], s71 offen sc1
    v_mfma_f32_16x16x32_bf16 a[116:119], v[124:127], a[176:179], a[116:119]
    v_permlane32_swap_b32 v202, v203
    ds_write_b128 v37, v[200:203] offset:19456
    v_mfma_f32_16x16x32_bf16 v[224:227], v[120:123], a[180:183], v[224:227]
    ds_read_b128 a[156:159], v29 offset:43008
    ds_read_b128 v[212:215], v38 offset:17408
    v_mfma_f32_16x16x32_bf16 v[228:231], v[124:127], a[180:183], v[228:231]
    v_accvgpr_read_b32 v192, a64
    v_accvgpr_read_b32 v196, a68
    v_mfma_f32_16x16x32_bf16 a[112:115], v[128:131], a[184:187], a[112:115]
    ds_read_b128 a[160:163], v30 offset:34816
    s_waitcnt lgkmcnt(5)
    buffer_store_dwordx4 v[208:211], v28, s[12:15], s72 offen sc1
    v_accvgpr_read_b32 v194, a65
    v_mfma_f32_16x16x32_bf16 a[116:119], v[132:135], a[184:187], a[116:119]
    v_accvgpr_read_b32 v197, a69
    v_accvgpr_read_b32 v193, a66
    v_mfma_f32_16x16x32_bf16 v[224:227], v[128:131], a[188:191], v[224:227]
    ds_read_b128 a[164:167], v30 offset:43008
    ds_read_b128 v[216:219], v38 offset:18432
    v_accvgpr_read_b32 v198, a70
    v_mfma_f32_16x16x32_bf16 v[228:231], v[132:135], a[188:191], v[228:231]
    v_accvgpr_read_b32 v195, a67
    v_accvgpr_read_b32 v199, a71
    v_mfma_f32_16x16x32_bf16 a[112:115], v[136:139], a[192:195], a[112:115]
    ds_read_b128 a[168:171], v29 offset:35840
    s_waitcnt lgkmcnt(4)
    buffer_store_dwordx4 v[212:215], v28, s[12:15], s73 offen sc1
    v_mfma_f32_16x16x32_bf16 a[116:119], v[140:143], a[192:195], a[116:119]
    v_cvt_pk_bf16_f32 v192, v192, v196
    v_cvt_pk_bf16_f32 v194, v194, v197
    v_mfma_f32_16x16x32_bf16 v[224:227], v[136:139], a[196:199], v[224:227]
    ds_read_b128 a[172:175], v29 offset:44032
    v_cvt_pk_bf16_f32 v193, v193, v198
    v_cvt_pk_bf16_f32 v195, v195, v199
    v_mfma_f32_16x16x32_bf16 v[228:231], v[140:143], a[196:199], v[228:231]
    v_permlane32_swap_b32 v192, v193
    v_mfma_f32_16x16x32_bf16 a[112:115], v[144:147], a[152:155], a[112:115]
    ds_read_b128 a[176:179], v30 offset:35840
    v_permlane32_swap_b32 v194, v195
    v_mfma_f32_16x16x32_bf16 a[116:119], v[148:151], a[152:155], a[116:119]
    s_waitcnt lgkmcnt(3)
    buffer_store_dwordx4 v[216:219], v28, s[12:15], s74 offen sc1
    ds_write_b128 v37, v[192:195] offset:0
    v_mfma_f32_16x16x32_bf16 v[224:227], v[144:147], a[156:159], v[224:227]
    ds_read_b128 a[180:183], v30 offset:44032
    v_accvgpr_read_b32 v200, a72
    v_mfma_f32_16x16x32_bf16 v[228:231], v[148:151], a[156:159], v[228:231]
    v_accvgpr_read_b32 v204, a76
    v_mfma_f32_16x16x32_bf16 a[112:115], v[152:155], a[160:163], a[112:115]
    ds_read_b128 a[184:187], v29 offset:49152
    v_accvgpr_read_b32 v202, a73
    v_mfma_f32_16x16x32_bf16 a[116:119], v[156:159], a[160:163], a[116:119]
    v_accvgpr_read_b32 v205, a77
    v_accvgpr_read_b32 v201, a74
    v_mfma_f32_16x16x32_bf16 v[224:227], v[152:155], a[164:167], v[224:227]
    ds_read_b128 a[188:191], v29 offset:57344
    v_accvgpr_read_b32 v206, a78
    v_mfma_f32_16x16x32_bf16 v[228:231], v[156:159], a[164:167], v[228:231]
    s_waitcnt lgkmcnt(5)
    v_accvgpr_read_b32 v203, a75
    v_mfma_f32_16x16x32_bf16 a[112:115], v[160:163], a[168:171], a[112:115]
    ds_read_b128 a[192:195], v30 offset:49152
    v_accvgpr_read_b32 v207, a79
    v_mfma_f32_16x16x32_bf16 a[116:119], v[164:167], a[168:171], a[116:119]
    v_cvt_pk_bf16_f32 v200, v200, v204
    v_cvt_pk_bf16_f32 v202, v202, v205
    v_mfma_f32_16x16x32_bf16 v[224:227], v[160:163], a[172:175], v[224:227]
    ds_read_b128 a[196:199], v30 offset:57344
    v_cvt_pk_bf16_f32 v201, v201, v206
    v_mfma_f32_16x16x32_bf16 v[228:231], v[164:167], a[172:175], v[228:231]
    s_waitcnt lgkmcnt(4)
    v_cvt_pk_bf16_f32 v203, v203, v207
    v_mfma_f32_16x16x32_bf16 a[112:115], v[168:171], a[176:179], a[112:115]
    s_waitcnt vmcnt(20)
    s_barrier
    ds_read_b128 a[152:155], v29 offset:50176
    v_mfma_f32_16x16x32_bf16 a[116:119], v[172:175], a[176:179], a[116:119]
    v_permlane32_swap_b32 v200, v201
    v_permlane32_swap_b32 v202, v203
    v_mfma_f32_16x16x32_bf16 v[224:227], v[168:171], a[180:183], v[224:227]
    ds_read_b128 a[156:159], v29 offset:58368
    ds_write_b128 v37, v[200:203] offset:1024
    v_mfma_f32_16x16x32_bf16 v[228:231], v[172:175], a[180:183], v[228:231]
    s_waitcnt lgkmcnt(5)
    ds_read_b128 v[220:223], v38 offset:19456
    v_mfma_f32_16x16x32_bf16 a[112:115], v[176:179], a[184:187], a[112:115]
    ds_read_b128 a[160:163], v30 offset:50176
    v_accvgpr_read_b32 v192, a80
    v_accvgpr_read_b32 v196, a84
    v_mfma_f32_16x16x32_bf16 a[116:119], v[180:183], a[184:187], a[116:119]
    v_accvgpr_read_b32 v194, a81
    v_accvgpr_read_b32 v197, a85
    v_mfma_f32_16x16x32_bf16 v[224:227], v[176:179], a[188:191], v[224:227]
    ds_read_b128 a[164:167], v30 offset:58368
    ds_read_b128 v[208:211], v38 offset:0
    v_accvgpr_read_b32 v193, a82
    v_mfma_f32_16x16x32_bf16 v[228:231], v[180:183], a[188:191], v[228:231]
    s_waitcnt lgkmcnt(7)
    v_accvgpr_read_b32 v198, a86
    v_mfma_f32_16x16x32_bf16 a[112:115], v[184:187], a[192:195], a[112:115]
    ds_read_b128 a[168:171], v29 offset:51200
    v_accvgpr_read_b32 v195, a83
    s_waitcnt lgkmcnt(4)
    buffer_store_dwordx4 v[220:223], v28, s[12:15], s75 offen sc1
    v_mfma_f32_16x16x32_bf16 a[116:119], v[188:191], a[192:195], a[116:119]
    v_accvgpr_read_b32 v199, a87
    v_cvt_pk_bf16_f32 v192, v192, v196
    v_mfma_f32_16x16x32_bf16 v[224:227], v[184:187], a[196:199], v[224:227]
    ds_read_b128 a[172:175], v29 offset:59392
    v_cvt_pk_bf16_f32 v194, v194, v197
    v_cvt_pk_bf16_f32 v193, v193, v198
    v_mfma_f32_16x16x32_bf16 v[228:231], v[188:191], a[196:199], v[228:231]
    v_cvt_pk_bf16_f32 v195, v195, v199
    v_mfma_f32_16x16x32_bf16 v[232:235], v[48:51], a[152:155], 0
    ds_read_b128 a[176:179], v30 offset:51200
    v_permlane32_swap_b32 v192, v193
    v_mfma_f32_16x16x32_bf16 v[236:239], v[52:55], a[152:155], 0
    s_waitcnt lgkmcnt(3)
    buffer_store_dwordx4 v[208:211], v28, s[12:15], s76 offen sc1
    v_permlane32_swap_b32 v194, v195
    v_mfma_f32_16x16x32_bf16 v[240:243], v[48:51], a[156:159], 0
    ds_read_b128 a[180:183], v30 offset:59392
    ds_write_b128 v37, v[192:195] offset:2048
    v_mfma_f32_16x16x32_bf16 v[244:247], v[52:55], a[156:159], 0
    v_accvgpr_read_b32 v200, a88
    v_mfma_f32_16x16x32_bf16 v[232:235], v[56:59], a[160:163], v[232:235]
    ds_read_b128 a[184:187], v31 offset:0
    v_accvgpr_read_b32 v204, a92
    v_mfma_f32_16x16x32_bf16 v[236:239], v[60:63], a[160:163], v[236:239]
    v_accvgpr_read_b32 v202, a89
    v_accvgpr_read_b32 v205, a93
    v_mfma_f32_16x16x32_bf16 v[240:243], v[56:59], a[164:167], v[240:243]
    ds_read_b128 a[188:191], v31 offset:8192
    v_accvgpr_read_b32 v201, a90
    v_mfma_f32_16x16x32_bf16 v[244:247], v[60:63], a[164:167], v[244:247]
    s_waitcnt lgkmcnt(5)
    v_accvgpr_read_b32 v206, a94
    v_mfma_f32_16x16x32_bf16 v[232:235], v[64:67], a[168:171], v[232:235]
    ds_read_b128 a[192:195], v32 offset:0
    v_accvgpr_read_b32 v203, a91
    v_mfma_f32_16x16x32_bf16 v[236:239], v[68:71], a[168:171], v[236:239]
    v_accvgpr_read_b32 v207, a95
    v_cvt_pk_bf16_f32 v200, v200, v204
    v_mfma_f32_16x16x32_bf16 v[240:243], v[64:67], a[172:175], v[240:243]
    ds_read_b128 a[196:199], v32 offset:8192
    v_cvt_pk_bf16_f32 v202, v202, v205
    v_mfma_f32_16x16x32_bf16 v[244:247], v[68:71], a[172:175], v[244:247]
    s_waitcnt lgkmcnt(5)
    v_cvt_pk_bf16_f32 v201, v201, v206
    v_mfma_f32_16x16x32_bf16 v[232:235], v[72:75], a[176:179], v[232:235]
    ds_read_b128 a[152:155], v31 offset:1024
    v_cvt_pk_bf16_f32 v203, v203, v207
    v_mfma_f32_16x16x32_bf16 v[236:239], v[76:79], a[176:179], v[236:239]
    v_permlane32_swap_b32 v200, v201
    v_permlane32_swap_b32 v202, v203
    v_mfma_f32_16x16x32_bf16 v[240:243], v[72:75], a[180:183], v[240:243]
    ds_read_b128 a[156:159], v31 offset:9216
    ds_write_b128 v37, v[200:203] offset:3072
    v_mfma_f32_16x16x32_bf16 v[244:247], v[76:79], a[180:183], v[244:247]
    s_waitcnt lgkmcnt(5)
    v_accvgpr_read_b32 v192, a96
    v_mfma_f32_16x16x32_bf16 v[232:235], v[80:83], a[184:187], v[232:235]
    ds_read_b128 a[160:163], v32 offset:1024
    v_accvgpr_read_b32 v196, a100
    v_mfma_f32_16x16x32_bf16 v[236:239], v[84:87], a[184:187], v[236:239]
    v_accvgpr_read_b32 v194, a97
    v_accvgpr_read_b32 v197, a101
    v_mfma_f32_16x16x32_bf16 v[240:243], v[80:83], a[188:191], v[240:243]
    ds_read_b128 a[164:167], v32 offset:9216
    v_accvgpr_read_b32 v193, a98
    v_mfma_f32_16x16x32_bf16 v[244:247], v[84:87], a[188:191], v[244:247]
    s_waitcnt lgkmcnt(5)
    v_accvgpr_read_b32 v198, a102
    v_mfma_f32_16x16x32_bf16 v[232:235], v[88:91], a[192:195], v[232:235]
    ds_read_b128 a[168:171], v31 offset:2048
    v_accvgpr_read_b32 v195, a99
    v_mfma_f32_16x16x32_bf16 v[236:239], v[92:95], a[192:195], v[236:239]
    v_accvgpr_read_b32 v199, a103
    v_cvt_pk_bf16_f32 v192, v192, v196
    v_mfma_f32_16x16x32_bf16 v[240:243], v[88:91], a[196:199], v[240:243]
    ds_read_b128 a[172:175], v31 offset:10240
    v_cvt_pk_bf16_f32 v194, v194, v197
    v_mfma_f32_16x16x32_bf16 v[244:247], v[92:95], a[196:199], v[244:247]
    s_waitcnt lgkmcnt(5)
    v_cvt_pk_bf16_f32 v193, v193, v198
    v_mfma_f32_16x16x32_bf16 v[232:235], v[96:99], a[152:155], v[232:235]
    ds_read_b128 a[176:179], v32 offset:2048
    v_cvt_pk_bf16_f32 v195, v195, v199
    v_mfma_f32_16x16x32_bf16 v[236:239], v[100:103], a[152:155], v[236:239]
    v_permlane32_swap_b32 v192, v193
    v_permlane32_swap_b32 v194, v195
    v_mfma_f32_16x16x32_bf16 v[240:243], v[96:99], a[156:159], v[240:243]
    ds_read_b128 a[180:183], v32 offset:10240
    ds_write_b128 v37, v[192:195] offset:16384
    v_mfma_f32_16x16x32_bf16 v[244:247], v[100:103], a[156:159], v[244:247]
    s_waitcnt lgkmcnt(5)
    v_accvgpr_read_b32 v200, a104
    v_mfma_f32_16x16x32_bf16 v[232:235], v[104:107], a[160:163], v[232:235]
    s_waitcnt vmcnt(18)
    s_waitcnt lgkmcnt(0)
    s_barrier
    ds_read_b128 a[184:187], v31 offset:3072
    v_mfma_f32_16x16x32_bf16 v[236:239], v[108:111], a[160:163], v[236:239]
    v_accvgpr_read_b32 v204, a108
    v_accvgpr_read_b32 v202, a105
    v_mfma_f32_16x16x32_bf16 v[240:243], v[104:107], a[164:167], v[240:243]
    ds_read_b128 a[188:191], v31 offset:11264
    v_accvgpr_read_b32 v205, a109
    ds_read_b128 v[212:215], v38 offset:1024
    v_mfma_f32_16x16x32_bf16 v[244:247], v[108:111], a[164:167], v[244:247]
    v_accvgpr_read_b32 v201, a106
    v_mfma_f32_16x16x32_bf16 v[232:235], v[112:115], a[168:171], v[232:235]
    ds_read_b128 a[192:195], v32 offset:3072
    v_accvgpr_read_b32 v206, a110
    v_accvgpr_read_b32 v203, a107
    v_mfma_f32_16x16x32_bf16 v[236:239], v[116:119], a[168:171], v[236:239]
    v_accvgpr_read_b32 v207, a111
    v_cvt_pk_bf16_f32 v200, v200, v204
    v_mfma_f32_16x16x32_bf16 v[240:243], v[112:115], a[172:175], v[240:243]
    ds_read_b128 a[196:199], v32 offset:11264
    v_cvt_pk_bf16_f32 v202, v202, v205
    ds_read_b128 v[216:219], v38 offset:2048
    v_mfma_f32_16x16x32_bf16 v[244:247], v[116:119], a[172:175], v[244:247]
    v_cvt_pk_bf16_f32 v201, v201, v206
    v_cvt_pk_bf16_f32 v203, v203, v207
    v_mfma_f32_16x16x32_bf16 v[232:235], v[120:123], a[176:179], v[232:235]
    ds_read_b128 a[152:155], v31 offset:16384
    v_permlane32_swap_b32 v200, v201
    s_waitcnt lgkmcnt(4)
    buffer_store_dwordx4 v[212:215], v28, s[12:15], s77 offen sc1
    v_mfma_f32_16x16x32_bf16 v[236:239], v[124:127], a[176:179], v[236:239]
    v_permlane32_swap_b32 v202, v203
    ds_write_b128 v37, v[200:203] offset:17408
    v_mfma_f32_16x16x32_bf16 v[240:243], v[120:123], a[180:183], v[240:243]
    ds_read_b128 a[156:159], v31 offset:24576
    ds_read_b128 v[220:223], v38 offset:3072
    v_mfma_f32_16x16x32_bf16 v[244:247], v[124:127], a[180:183], v[244:247]
    v_accvgpr_read_b32 v192, a112
    v_accvgpr_read_b32 v196, a116
    v_mfma_f32_16x16x32_bf16 v[232:235], v[128:131], a[184:187], v[232:235]
    ds_read_b128 a[160:163], v32 offset:16384
    s_waitcnt lgkmcnt(5)
    buffer_store_dwordx4 v[216:219], v28, s[12:15], s78 offen sc1
    v_accvgpr_read_b32 v194, a113
    v_mfma_f32_16x16x32_bf16 v[236:239], v[132:135], a[184:187], v[236:239]
    v_accvgpr_read_b32 v197, a117
    v_accvgpr_read_b32 v193, a114
    v_mfma_f32_16x16x32_bf16 v[240:243], v[128:131], a[188:191], v[240:243]
    ds_read_b128 a[164:167], v32 offset:24576
    ds_read_b128 v[208:211], v38 offset:16384
    v_accvgpr_read_b32 v198, a118
    v_mfma_f32_16x16x32_bf16 v[244:247], v[132:135], a[188:191], v[244:247]
    v_accvgpr_read_b32 v195, a115
    v_accvgpr_read_b32 v199, a119
    v_mfma_f32_16x16x32_bf16 v[232:235], v[136:139], a[192:195], v[232:235]
    ds_read_b128 a[168:171], v31 offset:17408
    s_waitcnt lgkmcnt(4)
    buffer_store_dwordx4 v[220:223], v28, s[12:15], s79 offen sc1
    v_mfma_f32_16x16x32_bf16 v[236:239], v[140:143], a[192:195], v[236:239]
    v_cvt_pk_bf16_f32 v192, v192, v196
    v_cvt_pk_bf16_f32 v194, v194, v197
    v_mfma_f32_16x16x32_bf16 v[240:243], v[136:139], a[196:199], v[240:243]
    ds_read_b128 a[172:175], v31 offset:25600
    v_cvt_pk_bf16_f32 v193, v193, v198
    v_cvt_pk_bf16_f32 v195, v195, v199
    v_mfma_f32_16x16x32_bf16 v[244:247], v[140:143], a[196:199], v[244:247]
    v_permlane32_swap_b32 v192, v193
    v_mfma_f32_16x16x32_bf16 v[232:235], v[144:147], a[152:155], v[232:235]
    ds_read_b128 a[176:179], v32 offset:17408
    v_permlane32_swap_b32 v194, v195
    v_mfma_f32_16x16x32_bf16 v[236:239], v[148:151], a[152:155], v[236:239]
    s_waitcnt lgkmcnt(3)
    buffer_store_dwordx4 v[208:211], v28, s[12:15], s80 offen sc1
    ds_write_b128 v37, v[192:195] offset:18432
    v_mfma_f32_16x16x32_bf16 v[240:243], v[144:147], a[156:159], v[240:243]
    ds_read_b128 a[180:183], v32 offset:25600
    v_cvt_pk_bf16_f32 v200, v224, v228
    v_mfma_f32_16x16x32_bf16 v[244:247], v[148:151], a[156:159], v[244:247]
    v_cvt_pk_bf16_f32 v202, v225, v229
    v_mfma_f32_16x16x32_bf16 v[232:235], v[152:155], a[160:163], v[232:235]
    ds_read_b128 a[184:187], v31 offset:18432
    v_cvt_pk_bf16_f32 v201, v226, v230
    v_mfma_f32_16x16x32_bf16 v[236:239], v[156:159], a[160:163], v[236:239]
    v_cvt_pk_bf16_f32 v203, v227, v231
    v_permlane32_swap_b32 v200, v201
    v_mfma_f32_16x16x32_bf16 v[240:243], v[152:155], a[164:167], v[240:243]
    ds_read_b128 a[188:191], v31 offset:26624
    v_permlane32_swap_b32 v202, v203
    v_mfma_f32_16x16x32_bf16 v[244:247], v[156:159], a[164:167], v[244:247]
    s_waitcnt lgkmcnt(5)
    ds_write_b128 v37, v[200:203] offset:0
    v_mfma_f32_16x16x32_bf16 v[232:235], v[160:163], a[168:171], v[232:235]
    ds_read_b128 a[192:195], v32 offset:18432
    v_mfma_f32_16x16x32_bf16 v[236:239], v[164:167], a[168:171], v[236:239]
    v_mfma_f32_16x16x32_bf16 v[240:243], v[160:163], a[172:175], v[240:243]
    ds_read_b128 a[196:199], v32 offset:26624
    v_mfma_f32_16x16x32_bf16 v[244:247], v[164:167], a[172:175], v[244:247]
    s_waitcnt lgkmcnt(5)
    v_mfma_f32_16x16x32_bf16 v[232:235], v[168:171], a[176:179], v[232:235]
    s_waitcnt vmcnt(12)
    s_waitcnt lgkmcnt(2)
    s_barrier
    ds_read_b128 a[152:155], v33 offset:32768
    v_mfma_f32_16x16x32_bf16 v[236:239], v[172:175], a[176:179], v[236:239]
    ds_read_b128 v[212:215], v38 offset:17408
    v_mfma_f32_16x16x32_bf16 v[240:243], v[168:171], a[180:183], v[240:243]
    ds_read_b128 a[156:159], v34 offset:32768
    ds_read_b128 v[216:219], v38 offset:18432
    v_mfma_f32_16x16x32_bf16 v[244:247], v[172:175], a[180:183], v[244:247]
    v_mfma_f32_16x16x32_bf16 v[232:235], v[176:179], a[184:187], v[232:235]
    ds_read_b128 a[160:163], v33 offset:33792
    s_waitcnt lgkmcnt(3)
    buffer_store_dwordx4 v[212:215], v28, s[12:15], s81 offen sc1
    v_mfma_f32_16x16x32_bf16 v[236:239], v[180:183], a[184:187], v[236:239]
    v_mfma_f32_16x16x32_bf16 v[240:243], v[176:179], a[188:191], v[240:243]
    ds_read_b128 a[164:167], v34 offset:33792
    ds_read_b128 v[220:223], v38 offset:0
    v_mfma_f32_16x16x32_bf16 v[244:247], v[180:183], a[188:191], v[244:247]
    v_mfma_f32_16x16x32_bf16 v[232:235], v[184:187], a[192:195], v[232:235]
    ds_read_b128 a[168:171], v33 offset:34816
    s_waitcnt lgkmcnt(4)
    buffer_store_dwordx4 v[216:219], v28, s[12:15], s82 offen sc1
    v_mfma_f32_16x16x32_bf16 v[236:239], v[188:191], a[192:195], v[236:239]
    v_mfma_f32_16x16x32_bf16 v[240:243], v[184:187], a[196:199], v[240:243]
    ds_read_b128 a[172:175], v34 offset:34816
    v_mfma_f32_16x16x32_bf16 v[244:247], v[188:191], a[196:199], v[244:247]
    v_mfma_f32_16x16x32_bf16 v[248:251], v[48:51], a[152:155], 0
    ds_read_b128 a[176:179], v33 offset:35840
    s_nop 2
    v_cvt_pk_bf16_f32 v192, v232, v236
    v_mfma_f32_16x16x32_bf16 v[252:255], v[52:55], a[152:155], 0
    v_cvt_pk_bf16_f32 v194, v233, v237
    v_cvt_pk_bf16_f32 v193, v234, v238
    v_mfma_f32_16x16x32_bf16 v[248:251], v[56:59], a[156:159], v[248:251]
    ds_read_b128 a[180:183], v34 offset:35840
    v_cvt_pk_bf16_f32 v195, v235, v239
    v_mfma_f32_16x16x32_bf16 v[252:255], v[60:63], a[156:159], v[252:255]
    s_waitcnt lgkmcnt(5)
    s_waitcnt lgkmcnt(4)
    buffer_store_dwordx4 v[220:223], v28, s[12:15], s83 offen sc1
    v_mfma_f32_16x16x32_bf16 v[248:251], v[64:67], a[160:163], v[248:251]
    ds_read_b128 a[184:187], v35 offset:0
    v_permlane32_swap_b32 v192, v193
    v_mfma_f32_16x16x32_bf16 v[252:255], v[68:71], a[160:163], v[252:255]
    v_permlane32_swap_b32 v194, v195
    ds_write_b128 v37, v[192:195] offset:19456
    v_mfma_f32_16x16x32_bf16 v[248:251], v[72:75], a[164:167], v[248:251]
    ds_read_b128 a[188:191], v36 offset:0
    v_mfma_f32_16x16x32_bf16 v[252:255], v[76:79], a[164:167], v[252:255]
    s_waitcnt lgkmcnt(5)
    v_mfma_f32_16x16x32_bf16 v[248:251], v[80:83], a[168:171], v[248:251]
    ds_read_b128 a[192:195], v35 offset:1024
    v_cvt_pk_bf16_f32 v200, v240, v244
    v_mfma_f32_16x16x32_bf16 v[252:255], v[84:87], a[168:171], v[252:255]
    v_cvt_pk_bf16_f32 v202, v241, v245
    v_mfma_f32_16x16x32_bf16 v[248:251], v[88:91], a[172:175], v[248:251]
    ds_read_b128 a[196:199], v36 offset:1024
    v_cvt_pk_bf16_f32 v201, v242, v246
    v_mfma_f32_16x16x32_bf16 v[252:255], v[92:95], a[172:175], v[252:255]
    s_waitcnt lgkmcnt(5)
    v_cvt_pk_bf16_f32 v203, v243, v247
    v_mfma_f32_16x16x32_bf16 v[248:251], v[96:99], a[176:179], v[248:251]
    ds_read_b128 a[152:155], v35 offset:2048
    v_permlane32_swap_b32 v200, v201
    v_mfma_f32_16x16x32_bf16 v[252:255], v[100:103], a[176:179], v[252:255]
    v_permlane32_swap_b32 v202, v203
    ds_write_b128 v37, v[200:203] offset:1024
    v_mfma_f32_16x16x32_bf16 v[248:251], v[104:107], a[180:183], v[248:251]
    ds_read_b128 a[156:159], v36 offset:2048
    v_mfma_f32_16x16x32_bf16 v[252:255], v[108:111], a[180:183], v[252:255]
    s_waitcnt lgkmcnt(5)
    v_mfma_f32_16x16x32_bf16 v[248:251], v[112:115], a[184:187], v[248:251]
    s_waitcnt vmcnt(13)
    s_waitcnt lgkmcnt(1)
    s_barrier
    ds_read_b128 a[160:163], v35 offset:3072
    v_mfma_f32_16x16x32_bf16 v[252:255], v[116:119], a[184:187], v[252:255]
    ds_read_b128 v[208:211], v38 offset:19456
    v_mfma_f32_16x16x32_bf16 v[248:251], v[120:123], a[188:191], v[248:251]
    ds_read_b128 a[164:167], v36 offset:3072
    ds_read_b128 v[212:215], v38 offset:1024
    v_mfma_f32_16x16x32_bf16 v[252:255], v[124:127], a[188:191], v[252:255]
    v_mfma_f32_16x16x32_bf16 v[248:251], v[128:131], a[192:195], v[248:251]
    ds_read_b128 a[168:171], v35 offset:16384
    s_waitcnt lgkmcnt(3)
    buffer_store_dwordx4 v[208:211], v28, s[12:15], s84 offen sc1
    v_mfma_f32_16x16x32_bf16 v[252:255], v[132:135], a[192:195], v[252:255]
    v_mfma_f32_16x16x32_bf16 v[248:251], v[136:139], a[196:199], v[248:251]
    ds_read_b128 a[172:175], v36 offset:16384
    v_mfma_f32_16x16x32_bf16 v[252:255], v[140:143], a[196:199], v[252:255]
    v_mfma_f32_16x16x32_bf16 v[248:251], v[144:147], a[152:155], v[248:251]
    s_waitcnt lgkmcnt(2)
    buffer_store_dwordx4 v[212:215], v28, s[12:15], s85 offen sc1
    v_mfma_f32_16x16x32_bf16 v[252:255], v[148:151], a[152:155], v[252:255]
    v_mfma_f32_16x16x32_bf16 v[248:251], v[152:155], a[156:159], v[248:251]
    v_mfma_f32_16x16x32_bf16 v[252:255], v[156:159], a[156:159], v[252:255]
    v_mfma_f32_16x16x32_bf16 v[248:251], v[160:163], a[160:163], v[248:251]
    v_mfma_f32_16x16x32_bf16 v[252:255], v[164:167], a[160:163], v[252:255]
    v_mfma_f32_16x16x32_bf16 v[248:251], v[168:171], a[164:167], v[248:251]
    v_mfma_f32_16x16x32_bf16 v[252:255], v[172:175], a[164:167], v[252:255]
    s_waitcnt lgkmcnt(0)
    v_mfma_f32_16x16x32_bf16 v[248:251], v[176:179], a[168:171], v[248:251]
    v_mfma_f32_16x16x32_bf16 v[252:255], v[180:183], a[168:171], v[252:255]
    v_mfma_f32_16x16x32_bf16 v[248:251], v[184:187], a[172:175], v[248:251]
    v_mfma_f32_16x16x32_bf16 v[252:255], v[188:191], a[172:175], v[252:255]
    s_nop 7
    v_cvt_pk_bf16_f32 v192, v248, v252
    v_cvt_pk_bf16_f32 v194, v249, v253
    v_cvt_pk_bf16_f32 v193, v250, v254
    v_cvt_pk_bf16_f32 v195, v251, v255
    s_nop 0
    v_permlane32_swap_b32 v192, v193
    v_permlane32_swap_b32 v194, v195
    ds_write_b128 v37, v[192:195] offset:2048
    s_waitcnt lgkmcnt(0)
    s_barrier
    ds_read_b128 v[216:219], v38 offset:2048
    s_waitcnt lgkmcnt(0)
    buffer_store_dwordx4 v[216:219], v28, s[12:15], s86 offen sc1
L_done:
    s_endpgm
.section .rodata,"a"
.p2align 6
.amdhsa_kernel standalone__w4a16_gemm_dequant__prompt_kernel
  .amdhsa_next_free_vgpr 512
  .amdhsa_next_free_sgpr 102
  .amdhsa_accum_offset 256
  .amdhsa_group_segment_fixed_size 0
  .amdhsa_kernarg_size 56
  .amdhsa_user_sgpr_count 2
  .amdhsa_user_sgpr_kernarg_segment_ptr 1
  .amdhsa_system_sgpr_workgroup_id_x 1
  .amdhsa_float_denorm_mode_32 3
.end_amdhsa_kernel
```
